```python
import torch

def _softmax(x, axis=-1):
    return torch.softmax(x, dim=axis)
def _gelu(x):
    return torch.nn.functional.gelu(x, approximate="tanh")
def _silu(x):
    return torch.nn.functional.silu(x)
def _sigmoid(x):
    return torch.sigmoid(x)
def _layernorm(x, axis=-1, eps=1e-5):
    m = x.mean(dim=axis, keepdim=True)
    v = x.var(dim=axis, keepdim=True, unbiased=False)
    return (x - m) / torch.sqrt(v + eps)
def _scatter_add(tgt, idx, src, axis=0):
    return tgt.clone().index_add_(axis, idx, src)
def _segment_sum(src, seg, n):
    out = torch.zeros((n,) + src.shape[1:], dtype=src.dtype)
    return out.index_add_(0, seg, src)
def _pad(x, pw):
    flat = tuple(v for pair in reversed(pw) for v in pair)
    return torch.nn.functional.pad(x, flat)

kernel_name = 'sequential_preLN__ssm_conv_s4__glu_gated_bilinear__prompt'

def setup_inputs():

    _w = (lambda a: (lambda t: t.to(torch.bfloat16) if t.is_floating_point() else t)(torch.as_tensor(a)))
    def _A_setup():
        B, L, D, N = 1, 2048, 448, 256
        A_re = -(lambda _x: torch.exp(torch.as_tensor(_x)))((lambda *s: torch.randn(*s, dtype=torch.bfloat16) * 3.2)(D, N))
        A_im = torch.pi * (lambda *s: torch.randn(*s, dtype=torch.bfloat16) * 0.05)(D, N)
        B_re = (lambda *s: torch.randn(*s, dtype=torch.bfloat16) * 0.05)(D, N)
        B_im = (lambda *s: torch.randn(*s, dtype=torch.bfloat16) * 0.05)(D, N)
        C_re = (lambda *s: torch.randn(*s, dtype=torch.bfloat16) * 0.05)(D, N)
        C_im = (lambda *s: torch.randn(*s, dtype=torch.bfloat16) * 0.05)(D, N)
        log_dt = (lambda *s: torch.randn(*s, dtype=torch.bfloat16) * 0.05)(D) * 0.5 - 4.0
        Dskip = (lambda *s: torch.randn(*s, dtype=torch.bfloat16) * 0.05)(D)
        return {
            "u": _w((lambda *s: torch.randn(*s, dtype=torch.bfloat16) * 0.05)(B, L, D)),
            "A_re": _w(A_re),
            "A_im": _w(A_im),
            "B_re": _w(B_re),
            "B_im": _w(B_im),
            "C_re": _w(C_re),
            "C_im": _w(C_im),
            "log_dt": _w(log_dt),
            "Dskip": _w(Dskip),
        }
    _A_in = _A_setup()

    def _B_setup():
        B, S, D, F = 1, 2048, 448, 1792
        return {
            "x": _w((lambda *s: torch.randn(*s, dtype=torch.bfloat16) * 0.05)(B, S, D)),
            "w_gate": _w((lambda *s: torch.randn(*s, dtype=torch.bfloat16) * 0.4)(D, F) * (D ** -0.5)),
            "w_up": _w((lambda *s: torch.randn(*s, dtype=torch.bfloat16) * 0.4)(D, F) * (D ** -0.5)),
            "w_down": _w((lambda *s: torch.randn(*s, dtype=torch.bfloat16) * 0.4)(F, D) * (F ** -0.5)),
        }
    _B_in = _B_setup()

    return {
        "A_u": _A_in["u"],
        "A_A_re": _A_in["A_re"],
        "A_A_im": _A_in["A_im"],
        "A_B_re": _A_in["B_re"],
        "A_B_im": _A_in["B_im"],
        "A_C_re": _A_in["C_re"],
        "A_C_im": _A_in["C_im"],
        "A_log_dt": _A_in["log_dt"],
        "A_Dskip": _A_in["Dskip"],
        "B_x": _B_in["x"],
        "B_w_gate": _B_in["w_gate"],
        "B_w_up": _B_in["w_up"],
        "B_w_down": _B_in["w_down"],
    }

def reference(A_u, A_A_re, A_A_im, A_B_re, A_B_im, A_C_re, A_C_im, A_log_dt, A_Dskip, B_x, B_w_gate, B_w_up, B_w_down):
    def _A_ref(u, A_re, A_im, B_re, B_im, C_re, C_im, log_dt, Dskip):
        Bsz, L, D = u.shape
        dt = torch.exp(log_dt)[:, None]
        A = A_re + 1j * A_im
        Bc = B_re + 1j * B_im
        Cc = C_re + 1j * C_im
        logdA = dt * A
        dB = dt * Bc
        l = (lambda x, dt: x.to(dt))(torch.arange(L), A_re.dtype)
        P = torch.exp(logdA[:, :, None] * l[None, None, :])
        K = torch.einsum("dn,dnl,dn->dl", Cc, P, dB).real
        L2 = 2 * L
        Kp = _pad(K, ((0, 0), (0, L)))
        up = (lambda x, *d: x.permute(*d))(u, 0, 2, 1)
        up = _pad(up, ((0, 0), (0, 0), (0, L)))
        Kf = (lambda x, axes=(-2,-1): torch.fft.rfft2(x.float(), dim=axes))(Kp[:, None, :], axes=(-2, -1))
        Uf = (lambda x, axes=(-2,-1): torch.fft.rfft2(x.float(), dim=axes))(up[:, :, None, :], axes=(-2, -1))
        Yf = Uf * Kf[None, :, :, :]
        y = (lambda x, s, axes=(-2,-1): torch.fft.irfft2(x, s=s, dim=axes).to(torch.bfloat16))(Yf, (1, L2), axes=(-2, -1))[:, :, 0, :L]
        y = (lambda x, *d: x.permute(*d))(y, 0, 2, 1) + u * Dskip[None, None, :]
        return y

    def _B_ref(x, w_gate, w_up, w_down):
        g = torch.einsum("bsd,df->bsf", x, w_gate)
        u = torch.einsum("bsd,df->bsf", x, w_up)
        h = g * u
        return torch.einsum("bsf,fd->bsd", h, w_down)

    x = A_u
    h = x + _A_ref(_layernorm(x, axis=-1), A_A_re, A_A_im, A_B_re, A_B_im, A_C_re, A_C_im, A_log_dt, A_Dskip)
    h2 = h + _B_ref(_layernorm(h, axis=-1), B_w_gate, B_w_up, B_w_down)
    return h2
```

```asm
; @launch grid=(256,1,1) block=(512,1,1) lds=163840
.amdgcn_target "amdgcn-amd-amdhsa--gfx950"
.text
.globl sequential_preLN__ssm_conv_s4__glu_gated_bilinear__prompt_kernel
.p2align 8
.type sequential_preLN__ssm_conv_s4__glu_gated_bilinear__prompt_kernel,@function
sequential_preLN__ssm_conv_s4__glu_gated_bilinear__prompt_kernel:
s_load_dwordx2 s[4:5], s[0:1], 120
s_load_dwordx2 s[12:13], s[0:1], 0
s_load_dwordx4 s[40:43], s[0:1], 8
s_load_dwordx4 s[48:51], s[0:1], 24
s_load_dwordx4 s[56:59], s[0:1], 40
s_load_dwordx4 s[64:67], s[0:1], 56
s_cmp_ge_u32 s2, 256
s_cbranch_scc1 M_END
v_and_b32 v1, 63, v0
v_lshrrev_b32 v2, 6, v0
s_nop 0
v_readfirstlane_b32 s30, v2
s_lshl_b32 s72, s2, 1
s_cmp_lt_u32 s2, 224
s_cselect_b32 s72, s72, 448
s_and_b32 s32, s30, 3
v_and_b32 v5, 255, v0
s_cmp_ge_u32 s30, 4
s_cbranch_scc1 P1_XPRO
s_lshl_b32 s24, s72, 9
s_lshl_b32 s25, s72, 1
v_mov_b32 v54, s25
v_mov_b32 v138, s25
v_lshlrev_b32 v6, 1, v5
s_bfe_u32 s27, s30, 0x10001
s_add_u32 s27, s27, s72
s_lshl_b32 s27, s27, 1
v_mov_b32 v47, s27
s_mov_b32 s18, 229376
s_mov_b32 s19, 0x20000
s_waitcnt lgkmcnt(0)
s_barrier
s_load_dword s3, s[4:5], 49152
s_mov_b32 s16, s40
s_mov_b32 s17, s41
buffer_load_ushort v48, v6, s[16:19], s24 offen
s_mov_b32 s16, s42
s_mov_b32 s17, s43
buffer_load_ushort v49, v6, s[16:19], s24 offen
s_mov_b32 s16, s48
s_mov_b32 s17, s49
buffer_load_ushort v50, v6, s[16:19], s24 offen
s_mov_b32 s16, s50
s_mov_b32 s17, s51
buffer_load_ushort v51, v6, s[16:19], s24 offen
s_mov_b32 s16, s56
s_mov_b32 s17, s57
buffer_load_ushort v52, v6, s[16:19], s24 offen
s_mov_b32 s16, s58
s_mov_b32 s17, s59
buffer_load_ushort v53, v6, s[16:19], s24 offen
s_mov_b32 s18, 896
s_mov_b32 s16, s64
s_mov_b32 s17, s65
buffer_load_ushort v54, v54, s[16:19], 0 offen
s_mov_b32 s18, 229376
s_mov_b32 s16, s40
s_mov_b32 s17, s41
buffer_load_ushort v132, v6, s[16:19], s24 offen offset:512
s_mov_b32 s16, s42
s_mov_b32 s17, s43
buffer_load_ushort v133, v6, s[16:19], s24 offen offset:512
s_mov_b32 s16, s48
s_mov_b32 s17, s49
buffer_load_ushort v134, v6, s[16:19], s24 offen offset:512
s_mov_b32 s16, s50
s_mov_b32 s17, s51
buffer_load_ushort v135, v6, s[16:19], s24 offen offset:512
s_mov_b32 s16, s56
s_mov_b32 s17, s57
buffer_load_ushort v136, v6, s[16:19], s24 offen offset:512
s_mov_b32 s16, s58
s_mov_b32 s17, s59
buffer_load_ushort v137, v6, s[16:19], s24 offen offset:512
s_mov_b32 s18, 896
s_mov_b32 s16, s64
s_mov_b32 s17, s65
buffer_load_ushort v138, v138, s[16:19], 0 offen offset:2
s_mov_b32 s18, 229376
s_mov_b32 s18, 896
s_mov_b32 s16, s66
s_mov_b32 s17, s67
buffer_load_ushort v47, v47, s[16:19], 0 offen
s_getpc_b64 s[16:17]
PF_M:
s_add_u32 s16, s16, (sequential_preLN__ssm_conv_s4__glu_gated_bilinear__prompt_kernel-PF_M)
s_addc_u32 s17, s17, -1
s_lshr_b32 s18, s2, 3
s_mul_i32 s18, s18, 12
v_add_u32 v7, s18, v0
v_lshlrev_b32 v7, 7, v7
v_min_u32 v7, (M_CODE_END-sequential_preLN__ssm_conv_s4__glu_gated_bilinear__prompt_kernel-4), v7
v_cmp_gt_u32 vcc, 12, v0
s_nop 1
s_and_saveexec_b64 s[18:19], vcc
s_cbranch_execz PF_M_DONE
global_load_dword v255, v7, s[16:17]
PF_M_DONE:
s_mov_b64 exec, s[18:19]
s_branch P1_JOIN0
P1_XPRO:
v_mov_b32 v232, 0
v_mov_b32 v233, 0
v_mov_b32 v234, 0
v_mov_b32 v235, 0
v_mov_b32 v236, 163328
ds_write_b128 v236, v[232:235]
ds_write_b128 v236, v[232:235] offset:16
v_and_b32 v237, 31, v1
v_lshlrev_b32 v237, 4, v237
s_and_b32 s29, s30, 1
s_mul_i32 s29, s29, 8704
s_add_u32 s29, s29, 142336
v_add_u32 v237, s29, v237
ds_write_b128 v237, v[232:235]
s_waitcnt lgkmcnt(0)
s_barrier
s_and_b32 s21, s2, 7
s_lshl_b32 s21, s21, 2
s_bfe_u32 s22, s2, 0x20003
s_add_u32 s21, s21, s22
s_lshr_b32 s22, s2, 5
s_lshl_b32 s23, s21, 6
s_lshl_b32 s24, s32, 4
s_add_u32 s23, s23, s24
s_mul_i32 s23, s23, 896
s_mul_i32 s24, s32, 14592
s_add_u32 s24, s24, 54272
v_lshlrev_b32 v6, 4, v1
s_mov_b32 s14, 1835008
s_mov_b32 s15, 0x20000
s_mov_b32 s26, -1
s_mov_b32 s27, 0x00ffffff
s_waitcnt lgkmcnt(0)
s_load_dword s3, s[4:5], 49152
s_mov_b64 exec, s[26:27]
s_add_u32 m0, s24, 0
s_add_u32 s25, s23, 0
buffer_load_dwordx4 v6, s[12:15], s25 offen lds
s_add_u32 m0, s24, 912
s_add_u32 s25, s23, 896
buffer_load_dwordx4 v6, s[12:15], s25 offen lds
s_add_u32 m0, s24, 1824
s_add_u32 s25, s23, 1792
buffer_load_dwordx4 v6, s[12:15], s25 offen lds
s_add_u32 m0, s24, 2736
s_add_u32 s25, s23, 2688
buffer_load_dwordx4 v6, s[12:15], s25 offen lds
s_add_u32 m0, s24, 3648
s_add_u32 s25, s23, 3584
buffer_load_dwordx4 v6, s[12:15], s25 offen lds
s_add_u32 m0, s24, 4560
s_add_u32 s25, s23, 4480
buffer_load_dwordx4 v6, s[12:15], s25 offen lds
s_add_u32 m0, s24, 5472
s_add_u32 s25, s23, 5376
buffer_load_dwordx4 v6, s[12:15], s25 offen lds
s_add_u32 m0, s24, 6384
s_add_u32 s25, s23, 6272
buffer_load_dwordx4 v6, s[12:15], s25 offen lds
s_add_u32 m0, s24, 7296
s_add_u32 s25, s23, 7168
buffer_load_dwordx4 v6, s[12:15], s25 offen lds
s_add_u32 m0, s24, 8208
s_add_u32 s25, s23, 8064
buffer_load_dwordx4 v6, s[12:15], s25 offen lds
s_add_u32 m0, s24, 9120
s_add_u32 s25, s23, 8960
buffer_load_dwordx4 v6, s[12:15], s25 offen lds
s_add_u32 m0, s24, 10032
s_add_u32 s25, s23, 9856
buffer_load_dwordx4 v6, s[12:15], s25 offen lds
s_add_u32 m0, s24, 10944
s_add_u32 s25, s23, 10752
buffer_load_dwordx4 v6, s[12:15], s25 offen lds
s_add_u32 m0, s24, 11856
s_add_u32 s25, s23, 11648
buffer_load_dwordx4 v6, s[12:15], s25 offen lds
s_add_u32 m0, s24, 12768
s_add_u32 s25, s23, 12544
buffer_load_dwordx4 v6, s[12:15], s25 offen lds
s_add_u32 m0, s24, 13680
s_add_u32 s25, s23, 13440
buffer_load_dwordx4 v6, s[12:15], s25 offen lds
s_mov_b64 exec, -1
P1_JOIN0:
s_mov_b32 s8, s4
s_mov_b32 s9, s5
s_mov_b32 s10, 65536
s_mov_b32 s11, 0x20000
s_add_u32 s68, s4, 1048576
s_addc_u32 s69, s5, 0
s_mov_b32 s70, 3670016
s_mov_b32 s71, 0x20000
s_cmp_ge_u32 s30, 4
s_cbranch_scc1 P1_X
s_cmp_ge_u32 s2, 224
s_cbranch_scc1 P1_KCS
v_lshlrev_b32 v168, 3, v5
v_sub_u32 v168, 2047, v168
v_subrev_u32 v169, 0, v168
v_subrev_u32 v170, 1, v168
v_subrev_u32 v171, 2, v168
v_subrev_u32 v172, 3, v168
v_subrev_u32 v173, 4, v168
v_subrev_u32 v174, 5, v168
v_subrev_u32 v175, 6, v168
v_subrev_u32 v176, 7, v168
v_subrev_u32 v177, 8, v168
v_subrev_u32 v178, 9, v168
v_subrev_u32 v179, 10, v168
v_subrev_u32 v180, 11, v168
v_subrev_u32 v181, 12, v168
v_subrev_u32 v182, 13, v168
v_subrev_u32 v183, 14, v168
v_cvt_f32_u32 v200, v169
v_cvt_f32_u32 v201, v170
v_cvt_f32_u32 v202, v171
v_cvt_f32_u32 v203, v172
v_cvt_f32_u32 v204, v173
v_cvt_f32_u32 v205, v174
v_cvt_f32_u32 v206, v175
v_cvt_f32_u32 v207, v176
v_max_i32 v192, 0, v177
v_cvt_f32_u32 v208, v192
v_max_i32 v193, 0, v178
v_cvt_f32_u32 v209, v193
v_max_i32 v194, 0, v179
v_cvt_f32_u32 v210, v194
v_max_i32 v195, 0, v180
v_cvt_f32_u32 v211, v195
v_max_i32 v196, 0, v181
v_cvt_f32_u32 v212, v196
v_max_i32 v197, 0, v182
v_cvt_f32_u32 v213, v197
v_max_i32 v198, 0, v183
v_cvt_f32_u32 v214, v198
v_cvt_pk_bf16_f32 v216, v200, v201
v_cvt_pk_bf16_f32 v217, v202, v203
v_cvt_pk_bf16_f32 v218, v204, v205
v_cvt_pk_bf16_f32 v219, v206, v207
v_cvt_pk_bf16_f32 v220, v208, v209
v_cvt_pk_bf16_f32 v221, v210, v211
v_cvt_pk_bf16_f32 v222, v212, v213
v_cvt_pk_bf16_f32 v223, v214, v214
v_lshlrev_b32 v200, 16, v216
v_and_b32 v201, 0xffff0000, v216
v_lshlrev_b32 v202, 16, v217
v_and_b32 v203, 0xffff0000, v217
v_lshlrev_b32 v204, 16, v218
v_and_b32 v205, 0xffff0000, v218
v_lshlrev_b32 v206, 16, v219
v_and_b32 v207, 0xffff0000, v219
v_lshlrev_b32 v208, 16, v220
v_and_b32 v209, 0xffff0000, v220
v_lshlrev_b32 v210, 16, v221
v_and_b32 v211, 0xffff0000, v221
v_lshlrev_b32 v212, 16, v222
v_and_b32 v213, 0xffff0000, v222
v_lshlrev_b32 v214, 16, v223
v_cvt_u32_f32 v200, v200
v_cvt_u32_f32 v201, v201
v_cvt_u32_f32 v202, v202
v_cvt_u32_f32 v203, v203
v_cvt_u32_f32 v204, v204
v_cvt_u32_f32 v205, v205
v_cvt_u32_f32 v206, v206
v_cvt_u32_f32 v207, v207
v_cvt_u32_f32 v208, v208
v_cvt_u32_f32 v209, v209
v_cvt_u32_f32 v210, v210
v_cvt_u32_f32 v211, v211
v_cvt_u32_f32 v212, v212
v_cvt_u32_f32 v213, v213
v_cvt_u32_f32 v214, v214
v_and_b32 v216, 7, v200
v_mul_u32_u24 v216, 1152, v216
v_lshrrev_b32 v217, 3, v200
v_lshl_add_u32 v216, v217, 2, v216
v_add_u32 v152, 78848, v216
v_and_b32 v216, 7, v201
v_mul_u32_u24 v216, 1152, v216
v_lshrrev_b32 v217, 3, v201
v_lshl_add_u32 v216, v217, 2, v216
v_add_u32 v153, 78848, v216
v_and_b32 v216, 7, v202
v_mul_u32_u24 v216, 1152, v216
v_lshrrev_b32 v217, 3, v202
v_lshl_add_u32 v216, v217, 2, v216
v_add_u32 v154, 78848, v216
v_and_b32 v216, 7, v203
v_mul_u32_u24 v216, 1152, v216
v_lshrrev_b32 v217, 3, v203
v_lshl_add_u32 v216, v217, 2, v216
v_add_u32 v155, 78848, v216
v_and_b32 v216, 7, v204
v_mul_u32_u24 v216, 1152, v216
v_lshrrev_b32 v217, 3, v204
v_lshl_add_u32 v216, v217, 2, v216
v_add_u32 v156, 78848, v216
v_and_b32 v216, 7, v205
v_mul_u32_u24 v216, 1152, v216
v_lshrrev_b32 v217, 3, v205
v_lshl_add_u32 v216, v217, 2, v216
v_add_u32 v157, 78848, v216
v_and_b32 v216, 7, v206
v_mul_u32_u24 v216, 1152, v216
v_lshrrev_b32 v217, 3, v206
v_lshl_add_u32 v216, v217, 2, v216
v_add_u32 v158, 78848, v216
v_and_b32 v216, 7, v207
v_mul_u32_u24 v216, 1152, v216
v_lshrrev_b32 v217, 3, v207
v_lshl_add_u32 v216, v217, 2, v216
v_add_u32 v159, 78848, v216
v_and_b32 v216, 7, v208
v_mul_u32_u24 v216, 1152, v216
v_lshrrev_b32 v217, 3, v208
v_lshl_add_u32 v216, v217, 2, v216
v_cmp_gt_i32 vcc, 0, v177
v_mov_b32 v217, 9212
s_nop 0
v_cndmask_b32 v216, v216, v217, vcc
v_add_u32 v160, 78848, v216
v_and_b32 v216, 7, v209
v_mul_u32_u24 v216, 1152, v216
v_lshrrev_b32 v217, 3, v209
v_lshl_add_u32 v216, v217, 2, v216
v_cmp_gt_i32 vcc, 0, v178
v_mov_b32 v217, 9212
s_nop 0
v_cndmask_b32 v216, v216, v217, vcc
v_add_u32 v161, 78848, v216
v_and_b32 v216, 7, v210
v_mul_u32_u24 v216, 1152, v216
v_lshrrev_b32 v217, 3, v210
v_lshl_add_u32 v216, v217, 2, v216
v_cmp_gt_i32 vcc, 0, v179
v_mov_b32 v217, 9212
s_nop 0
v_cndmask_b32 v216, v216, v217, vcc
v_add_u32 v162, 78848, v216
v_and_b32 v216, 7, v211
v_mul_u32_u24 v216, 1152, v216
v_lshrrev_b32 v217, 3, v211
v_lshl_add_u32 v216, v217, 2, v216
v_cmp_gt_i32 vcc, 0, v180
v_mov_b32 v217, 9212
s_nop 0
v_cndmask_b32 v216, v216, v217, vcc
v_add_u32 v163, 78848, v216
v_and_b32 v216, 7, v212
v_mul_u32_u24 v216, 1152, v216
v_lshrrev_b32 v217, 3, v212
v_lshl_add_u32 v216, v217, 2, v216
v_cmp_gt_i32 vcc, 0, v181
v_mov_b32 v217, 9212
s_nop 0
v_cndmask_b32 v216, v216, v217, vcc
v_add_u32 v164, 78848, v216
v_and_b32 v216, 7, v213
v_mul_u32_u24 v216, 1152, v216
v_lshrrev_b32 v217, 3, v213
v_lshl_add_u32 v216, v217, 2, v216
v_cmp_gt_i32 vcc, 0, v182
v_mov_b32 v217, 9212
s_nop 0
v_cndmask_b32 v216, v216, v217, vcc
v_add_u32 v165, 78848, v216
v_and_b32 v216, 7, v214
v_mul_u32_u24 v216, 1152, v216
v_lshrrev_b32 v217, 3, v214
v_lshl_add_u32 v216, v217, 2, v216
v_cmp_gt_i32 vcc, 0, v183
v_mov_b32 v217, 9212
s_nop 0
v_cndmask_b32 v216, v216, v217, vcc
v_add_u32 v166, 78848, v216
v_lshrrev_b32 v3, 2, v5
v_mul_u32_u24 v3, 848, v3
v_and_b32 v4, 3, v5
v_lshl_add_u32 v3, v4, 2, v3
v_and_b32 v224, 31, v1
v_lshrrev_b32 v225, 5, v1
s_lshl_b32 s28, s32, 4
v_add_u32 v226, s28, v225
v_mul_u32_u24 v226, 848, v226
v_lshl_add_u32 v226, v224, 4, v226
v_lshlrev_b32 v229, 4, v1
s_mul_i32 s29, s32, 3072
s_add_u32 s29, s29, 66560
v_add_u32 v227, s29, v229
s_lshl_b32 s29, s32, 10
s_add_u32 s29, s29, 66560
v_add_u32 v228, s29, v229
s_waitcnt vmcnt(8) lgkmcnt(0)
s_add_u32 s3, s3, 1
v_lshlrev_b32 v48, 16, v48
v_lshlrev_b32 v49, 16, v49
v_lshlrev_b32 v50, 16, v50
v_lshlrev_b32 v51, 16, v51
v_lshlrev_b32 v52, 16, v52
v_lshlrev_b32 v53, 16, v53
v_lshlrev_b32 v54, 16, v54
v_mul_f32 v54, 0x3fb8aa3b, v54
v_exp_f32 v54, v54
s_nop 0
v_cvt_pk_bf16_f32 v54, v54, v54
v_and_b32 v54, 0xffff0000, v54
v_mul_f32 v48, v54, v48
v_mul_f32 v49, v54, v49
v_mul_f32 v56, v54, v50
v_mul_f32 v57, v54, v51
v_mul_f32 v48, 0x3fb8aa3b, v48
v_mul_f32 v49, 0x3e22f983, v49
v_mov_b32 v58, v52
v_mov_b32 v59, v53
v_pk_mul_f32 v[62:63], v[58:59], v[56:57] op_sel:[0,0] op_sel_hi:[1,0]
v_pk_fma_f32 v[60:61], v[58:59], v[56:57], v[62:63] op_sel:[1,1,0] op_sel_hi:[0,1,1] neg_lo:[1,0,0]
v_mul_f32 v72, 0x41000000, v48
v_mul_f32 v74, 0x43800000, v48
v_exp_f32 v70, v48
v_mul_f32 v73, 0x41000000, v49
v_mul_f32 v75, 0x43800000, v49
v_fract_f32 v71, v49
v_exp_f32 v72, v72
v_exp_f32 v74, v74
v_cos_f32 v64, v71
v_fract_f32 v73, v73
v_fract_f32 v75, v75
v_cos_f32 v66, v73
v_cos_f32 v68, v75
v_sin_f32 v65, v71
v_sin_f32 v67, v73
v_sin_f32 v69, v75
v_pk_mul_f32 v[64:65], v[64:65], v[70:71] op_sel_hi:[1,0]
v_pk_mul_f32 v[66:67], v[66:67], v[72:73] op_sel_hi:[1,0]
v_pk_mul_f32 v[68:69], v[68:69], v[74:75] op_sel_hi:[1,0]
v_mov_b32 v78, 1.0
v_mov_b32 v79, 0
v_pk_mul_f32 v[94:95], v[66:67], v[66:67] op_sel:[0,0] op_sel_hi:[1,0]
v_pk_mul_f32 v[96:97], v[64:65], v[64:65] op_sel:[0,0] op_sel_hi:[1,0]
v_pk_mul_f32 v[98:99], v[68:69], v[68:69] op_sel:[0,0] op_sel_hi:[1,0]
v_cvt_pk_bf16_f32 v100, v78, v79
v_cvt_pk_bf16_f32 v101, v66, v67
ds_write2_b32 v3, v100, v101 offset0:84 offset1:88
v_pk_fma_f32 v[76:77], v[66:67], v[66:67], v[94:95] op_sel:[1,1,0] op_sel_hi:[0,1,1] neg_lo:[1,0,0]
v_pk_fma_f32 v[84:85], v[64:65], v[64:65], v[96:97] op_sel:[1,1,0] op_sel_hi:[0,1,1] neg_lo:[1,0,0]
v_pk_fma_f32 v[92:93], v[68:69], v[68:69], v[98:99] op_sel:[1,1,0] op_sel_hi:[0,1,1] neg_lo:[1,0,0]
v_cvt_pk_bf16_f32 v102, v60, -v61
v_cvt_pk_bf16_f32 v103, v76, v77
ds_write2_b32 v3, v102, v103 offset0:0 offset1:92
v_pk_mul_f32 v[94:95], v[66:67], v[76:77] op_sel:[0,0] op_sel_hi:[1,0]
v_pk_mul_f32 v[96:97], v[76:77], v[76:77] op_sel:[0,0] op_sel_hi:[1,0]
v_pk_mul_f32 v[98:99], v[60:61], v[64:65] op_sel:[0,0] op_sel_hi:[1,0]
v_pk_fma_f32 v[80:81], v[66:67], v[76:77], v[94:95] op_sel:[1,1,0] op_sel_hi:[0,1,1] neg_lo:[1,0,0]
v_pk_fma_f32 v[78:79], v[76:77], v[76:77], v[96:97] op_sel:[1,1,0] op_sel_hi:[0,1,1] neg_lo:[1,0,0]
v_pk_fma_f32 v[82:83], v[60:61], v[64:65], v[98:99] op_sel:[1,1,0] op_sel_hi:[0,1,1] neg_lo:[1,0,0]
v_cvt_pk_bf16_f32 v100, v80, v81
v_cvt_pk_bf16_f32 v101, v78, v79
ds_write2_b32 v3, v100, v101 offset0:96 offset1:100
v_cvt_pk_bf16_f32 v102, v82, -v83
v_pk_mul_f32 v[94:95], v[80:81], v[76:77] op_sel:[0,0] op_sel_hi:[1,0]
v_pk_mul_f32 v[96:97], v[78:79], v[76:77] op_sel:[0,0] op_sel_hi:[1,0]
v_pk_mul_f32 v[98:99], v[84:85], v[84:85] op_sel:[0,0] op_sel_hi:[1,0]
v_pk_fma_f32 v[80:81], v[80:81], v[76:77], v[94:95] op_sel:[1,1,0] op_sel_hi:[0,1,1] neg_lo:[1,0,0]
v_pk_fma_f32 v[78:79], v[78:79], v[76:77], v[96:97] op_sel:[1,1,0] op_sel_hi:[0,1,1] neg_lo:[1,0,0]
v_pk_fma_f32 v[86:87], v[84:85], v[84:85], v[98:99] op_sel:[1,1,0] op_sel_hi:[0,1,1] neg_lo:[1,0,0]
v_cvt_pk_bf16_f32 v103, v80, v81
ds_write2_b32 v3, v102, v103 offset0:4 offset1:104
v_cvt_pk_bf16_f32 v100, v78, v79
v_pk_mul_f32 v[94:95], v[80:81], v[76:77] op_sel:[0,0] op_sel_hi:[1,0]
v_pk_mul_f32 v[96:97], v[78:79], v[76:77] op_sel:[0,0] op_sel_hi:[1,0]
v_pk_mul_f32 v[98:99], v[60:61], v[68:69] op_sel:[0,0] op_sel_hi:[1,0]
v_pk_fma_f32 v[80:81], v[80:81], v[76:77], v[94:95] op_sel:[1,1,0] op_sel_hi:[0,1,1] neg_lo:[1,0,0]
v_pk_fma_f32 v[78:79], v[78:79], v[76:77], v[96:97] op_sel:[1,1,0] op_sel_hi:[0,1,1] neg_lo:[1,0,0]
v_pk_fma_f32 v[88:89], v[60:61], v[68:69], v[98:99] op_sel:[1,1,0] op_sel_hi:[0,1,1] neg_lo:[1,0,0]
v_cvt_pk_bf16_f32 v101, v80, v81
ds_write2_b32 v3, v100, v101 offset0:108 offset1:112
v_cvt_pk_bf16_f32 v102, v78, v79
v_cvt_pk_bf16_f32 v103, v88, -v89
ds_write2_b32 v3, v102, v103 offset0:116 offset1:32
v_pk_mul_f32 v[94:95], v[80:81], v[76:77] op_sel:[0,0] op_sel_hi:[1,0]
v_pk_mul_f32 v[96:97], v[78:79], v[76:77] op_sel:[0,0] op_sel_hi:[1,0]
v_pk_mul_f32 v[98:99], v[60:61], v[92:93] op_sel:[0,0] op_sel_hi:[1,0]
v_pk_fma_f32 v[80:81], v[80:81], v[76:77], v[94:95] op_sel:[1,1,0] op_sel_hi:[0,1,1] neg_lo:[1,0,0]
v_pk_fma_f32 v[78:79], v[78:79], v[76:77], v[96:97] op_sel:[1,1,0] op_sel_hi:[0,1,1] neg_lo:[1,0,0]
v_pk_fma_f32 v[90:91], v[60:61], v[92:93], v[98:99] op_sel:[1,1,0] op_sel_hi:[0,1,1] neg_lo:[1,0,0]
v_cvt_pk_bf16_f32 v100, v80, v81
v_cvt_pk_bf16_f32 v101, v78, v79
ds_write2_b32 v3, v100, v101 offset0:120 offset1:124
v_cvt_pk_bf16_f32 v102, v90, -v91
v_pk_mul_f32 v[94:95], v[80:81], v[76:77] op_sel:[0,0] op_sel_hi:[1,0]
v_pk_mul_f32 v[96:97], v[78:79], v[76:77] op_sel:[0,0] op_sel_hi:[1,0]
v_pk_mul_f32 v[98:99], v[82:83], v[64:65] op_sel:[0,0] op_sel_hi:[1,0]
v_pk_fma_f32 v[80:81], v[80:81], v[76:77], v[94:95] op_sel:[1,1,0] op_sel_hi:[0,1,1] neg_lo:[1,0,0]
v_pk_fma_f32 v[78:79], v[78:79], v[76:77], v[96:97] op_sel:[1,1,0] op_sel_hi:[0,1,1] neg_lo:[1,0,0]
v_pk_fma_f32 v[82:83], v[82:83], v[64:65], v[98:99] op_sel:[1,1,0] op_sel_hi:[0,1,1] neg_lo:[1,0,0]
v_cvt_pk_bf16_f32 v103, v80, v81
ds_write2_b32 v3, v102, v103 offset0:48 offset1:128
v_cvt_pk_bf16_f32 v100, v78, v79
v_cvt_pk_bf16_f32 v101, v82, -v83
ds_write2_b32 v3, v100, v101 offset0:132 offset1:8
v_pk_mul_f32 v[94:95], v[80:81], v[76:77] op_sel:[0,0] op_sel_hi:[1,0]
v_pk_mul_f32 v[96:97], v[78:79], v[76:77] op_sel:[0,0] op_sel_hi:[1,0]
v_pk_mul_f32 v[98:99], v[82:83], v[64:65] op_sel:[0,0] op_sel_hi:[1,0]
v_pk_fma_f32 v[80:81], v[80:81], v[76:77], v[94:95] op_sel:[1,1,0] op_sel_hi:[0,1,1] neg_lo:[1,0,0]
v_pk_fma_f32 v[78:79], v[78:79], v[76:77], v[96:97] op_sel:[1,1,0] op_sel_hi:[0,1,1] neg_lo:[1,0,0]
v_pk_fma_f32 v[82:83], v[82:83], v[64:65], v[98:99] op_sel:[1,1,0] op_sel_hi:[0,1,1] neg_lo:[1,0,0]
v_cvt_pk_bf16_f32 v102, v80, v81
v_cvt_pk_bf16_f32 v103, v78, v79
ds_write2_b32 v3, v102, v103 offset0:136 offset1:140
v_cvt_pk_bf16_f32 v100, v82, -v83
v_pk_mul_f32 v[94:95], v[80:81], v[76:77] op_sel:[0,0] op_sel_hi:[1,0]
v_pk_mul_f32 v[96:97], v[78:79], v[76:77] op_sel:[0,0] op_sel_hi:[1,0]
v_pk_mul_f32 v[98:99], v[82:83], v[64:65] op_sel:[0,0] op_sel_hi:[1,0]
v_pk_fma_f32 v[80:81], v[80:81], v[76:77], v[94:95] op_sel:[1,1,0] op_sel_hi:[0,1,1] neg_lo:[1,0,0]
v_pk_fma_f32 v[78:79], v[78:79], v[76:77], v[96:97] op_sel:[1,1,0] op_sel_hi:[0,1,1] neg_lo:[1,0,0]
v_pk_fma_f32 v[82:83], v[82:83], v[64:65], v[98:99] op_sel:[1,1,0] op_sel_hi:[0,1,1] neg_lo:[1,0,0]
v_cvt_pk_bf16_f32 v101, v80, v81
ds_write2_b32 v3, v100, v101 offset0:12 offset1:144
v_cvt_pk_bf16_f32 v102, v78, v79
v_cvt_pk_bf16_f32 v103, v82, -v83
ds_write2_b32 v3, v102, v103 offset0:148 offset1:16
v_pk_mul_f32 v[94:95], v[80:81], v[76:77] op_sel:[0,0] op_sel_hi:[1,0]
v_pk_mul_f32 v[96:97], v[78:79], v[76:77] op_sel:[0,0] op_sel_hi:[1,0]
v_pk_mul_f32 v[98:99], v[82:83], v[64:65] op_sel:[0,0] op_sel_hi:[1,0]
v_pk_fma_f32 v[80:81], v[80:81], v[76:77], v[94:95] op_sel:[1,1,0] op_sel_hi:[0,1,1] neg_lo:[1,0,0]
v_pk_fma_f32 v[78:79], v[78:79], v[76:77], v[96:97] op_sel:[1,1,0] op_sel_hi:[0,1,1] neg_lo:[1,0,0]
v_pk_fma_f32 v[82:83], v[82:83], v[64:65], v[98:99] op_sel:[1,1,0] op_sel_hi:[0,1,1] neg_lo:[1,0,0]
v_cvt_pk_bf16_f32 v100, v80, v81
v_cvt_pk_bf16_f32 v101, v78, v79
ds_write2_b32 v3, v100, v101 offset0:152 offset1:156
v_cvt_pk_bf16_f32 v102, v82, -v83
v_pk_mul_f32 v[94:95], v[80:81], v[76:77] op_sel:[0,0] op_sel_hi:[1,0]
v_pk_mul_f32 v[96:97], v[78:79], v[76:77] op_sel:[0,0] op_sel_hi:[1,0]
v_pk_mul_f32 v[98:99], v[82:83], v[64:65] op_sel:[0,0] op_sel_hi:[1,0]
v_pk_fma_f32 v[80:81], v[80:81], v[76:77], v[94:95] op_sel:[1,1,0] op_sel_hi:[0,1,1] neg_lo:[1,0,0]
v_pk_fma_f32 v[78:79], v[78:79], v[76:77], v[96:97] op_sel:[1,1,0] op_sel_hi:[0,1,1] neg_lo:[1,0,0]
v_pk_fma_f32 v[82:83], v[82:83], v[64:65], v[98:99] op_sel:[1,1,0] op_sel_hi:[0,1,1] neg_lo:[1,0,0]
v_cvt_pk_bf16_f32 v103, v80, v81
ds_write2_b32 v3, v102, v103 offset0:20 offset1:160
v_cvt_pk_bf16_f32 v100, v78, v79
v_cvt_pk_bf16_f32 v101, v82, -v83
ds_write2_b32 v3, v100, v101 offset0:164 offset1:24
v_pk_mul_f32 v[94:95], v[80:81], v[76:77] op_sel:[0,0] op_sel_hi:[1,0]
v_pk_mul_f32 v[96:97], v[78:79], v[76:77] op_sel:[0,0] op_sel_hi:[1,0]
v_pk_mul_f32 v[98:99], v[82:83], v[64:65] op_sel:[0,0] op_sel_hi:[1,0]
v_pk_fma_f32 v[80:81], v[80:81], v[76:77], v[94:95] op_sel:[1,1,0] op_sel_hi:[0,1,1] neg_lo:[1,0,0]
v_pk_fma_f32 v[78:79], v[78:79], v[76:77], v[96:97] op_sel:[1,1,0] op_sel_hi:[0,1,1] neg_lo:[1,0,0]
v_pk_fma_f32 v[82:83], v[82:83], v[64:65], v[98:99] op_sel:[1,1,0] op_sel_hi:[0,1,1] neg_lo:[1,0,0]
v_cvt_pk_bf16_f32 v102, v80, v81
v_cvt_pk_bf16_f32 v103, v78, v79
ds_write2_b32 v3, v102, v103 offset0:168 offset1:172
v_cvt_pk_bf16_f32 v100, v82, -v83
v_pk_mul_f32 v[94:95], v[80:81], v[76:77] op_sel:[0,0] op_sel_hi:[1,0]
v_pk_mul_f32 v[96:97], v[78:79], v[76:77] op_sel:[0,0] op_sel_hi:[1,0]
v_pk_mul_f32 v[98:99], v[90:91], v[86:87] op_sel:[0,0] op_sel_hi:[1,0]
v_pk_fma_f32 v[80:81], v[80:81], v[76:77], v[94:95] op_sel:[1,1,0] op_sel_hi:[0,1,1] neg_lo:[1,0,0]
v_pk_fma_f32 v[78:79], v[78:79], v[76:77], v[96:97] op_sel:[1,1,0] op_sel_hi:[0,1,1] neg_lo:[1,0,0]
v_pk_fma_f32 v[82:83], v[90:91], v[86:87], v[98:99] op_sel:[1,1,0] op_sel_hi:[0,1,1] neg_lo:[1,0,0]
v_cvt_pk_bf16_f32 v101, v80, v81
ds_write2_b32 v3, v100, v101 offset0:28 offset1:176
v_cvt_pk_bf16_f32 v102, v78, v79
v_cvt_pk_bf16_f32 v103, v82, -v83
ds_write2_b32 v3, v102, v103 offset0:180 offset1:52
v_pk_mul_f32 v[94:95], v[80:81], v[76:77] op_sel:[0,0] op_sel_hi:[1,0]
v_pk_mul_f32 v[96:97], v[78:79], v[76:77] op_sel:[0,0] op_sel_hi:[1,0]
v_pk_mul_f32 v[98:99], v[88:89], v[84:85] op_sel:[0,0] op_sel_hi:[1,0]
v_pk_fma_f32 v[80:81], v[80:81], v[76:77], v[94:95] op_sel:[1,1,0] op_sel_hi:[0,1,1] neg_lo:[1,0,0]
v_pk_fma_f32 v[78:79], v[78:79], v[76:77], v[96:97] op_sel:[1,1,0] op_sel_hi:[0,1,1] neg_lo:[1,0,0]
v_pk_fma_f32 v[88:89], v[88:89], v[84:85], v[98:99] op_sel:[1,1,0] op_sel_hi:[0,1,1] neg_lo:[1,0,0]
v_cvt_pk_bf16_f32 v100, v80, v81
v_cvt_pk_bf16_f32 v101, v78, v79
ds_write2_b32 v3, v100, v101 offset0:184 offset1:188
v_cvt_pk_bf16_f32 v102, v88, -v89
v_pk_mul_f32 v[94:95], v[80:81], v[76:77] op_sel:[0,0] op_sel_hi:[1,0]
v_pk_mul_f32 v[96:97], v[78:79], v[76:77] op_sel:[0,0] op_sel_hi:[1,0]
v_pk_mul_f32 v[98:99], v[88:89], v[84:85] op_sel:[0,0] op_sel_hi:[1,0]
v_pk_fma_f32 v[80:81], v[80:81], v[76:77], v[94:95] op_sel:[1,1,0] op_sel_hi:[0,1,1] neg_lo:[1,0,0]
v_pk_fma_f32 v[78:79], v[78:79], v[76:77], v[96:97] op_sel:[1,1,0] op_sel_hi:[0,1,1] neg_lo:[1,0,0]
v_pk_fma_f32 v[88:89], v[88:89], v[84:85], v[98:99] op_sel:[1,1,0] op_sel_hi:[0,1,1] neg_lo:[1,0,0]
v_cvt_pk_bf16_f32 v103, v80, v81
ds_write2_b32 v3, v102, v103 offset0:36 offset1:192
v_cvt_pk_bf16_f32 v100, v78, v79
v_cvt_pk_bf16_f32 v101, v88, -v89
ds_write2_b32 v3, v100, v101 offset0:196 offset1:40
v_pk_mul_f32 v[94:95], v[80:81], v[76:77] op_sel:[0,0] op_sel_hi:[1,0]
v_pk_mul_f32 v[96:97], v[78:79], v[76:77] op_sel:[0,0] op_sel_hi:[1,0]
v_pk_mul_f32 v[98:99], v[88:89], v[84:85] op_sel:[0,0] op_sel_hi:[1,0]
v_pk_fma_f32 v[80:81], v[80:81], v[76:77], v[94:95] op_sel:[1,1,0] op_sel_hi:[0,1,1] neg_lo:[1,0,0]
v_pk_fma_f32 v[78:79], v[78:79], v[76:77], v[96:97] op_sel:[1,1,0] op_sel_hi:[0,1,1] neg_lo:[1,0,0]
v_pk_fma_f32 v[88:89], v[88:89], v[84:85], v[98:99] op_sel:[1,1,0] op_sel_hi:[0,1,1] neg_lo:[1,0,0]
v_cvt_pk_bf16_f32 v102, v80, v81
v_cvt_pk_bf16_f32 v103, v78, v79
ds_write2_b32 v3, v102, v103 offset0:200 offset1:204
v_cvt_pk_bf16_f32 v100, v88, -v89
v_pk_mul_f32 v[94:95], v[80:81], v[76:77] op_sel:[0,0] op_sel_hi:[1,0]
v_pk_mul_f32 v[98:99], v[90:91], v[92:93] op_sel:[0,0] op_sel_hi:[1,0]
v_pk_fma_f32 v[80:81], v[80:81], v[76:77], v[94:95] op_sel:[1,1,0] op_sel_hi:[0,1,1] neg_lo:[1,0,0]
v_pk_fma_f32 v[88:89], v[90:91], v[92:93], v[98:99] op_sel:[1,1,0] op_sel_hi:[0,1,1] neg_lo:[1,0,0]
v_cvt_pk_bf16_f32 v101, v80, v81
ds_write2_b32 v3, v100, v101 offset0:44 offset1:208
v_cvt_pk_bf16_f32 v102, v88, -v89
v_pk_mul_f32 v[98:99], v[90:91], v[68:69] op_sel:[0,0] op_sel_hi:[1,0]
v_pk_fma_f32 v[90:91], v[90:91], v[68:69], v[98:99] op_sel:[1,1,0] op_sel_hi:[0,1,1] neg_lo:[1,0,0]
v_cvt_pk_bf16_f32 v103, v90, -v91
ds_write2_b32 v3, v102, v103 offset0:64 offset1:56
v_pk_mul_f32 v[98:99], v[90:91], v[86:87] op_sel:[0,0] op_sel_hi:[1,0]
v_pk_fma_f32 v[82:83], v[90:91], v[86:87], v[98:99] op_sel:[1,1,0] op_sel_hi:[0,1,1] neg_lo:[1,0,0]
v_cvt_pk_bf16_f32 v100, v82, -v83
v_pk_mul_f32 v[98:99], v[88:89], v[68:69] op_sel:[0,0] op_sel_hi:[1,0]
v_pk_fma_f32 v[88:89], v[88:89], v[68:69], v[98:99] op_sel:[1,1,0] op_sel_hi:[0,1,1] neg_lo:[1,0,0]
v_cvt_pk_bf16_f32 v101, v88, -v89
ds_write2_b32 v3, v100, v101 offset0:60 offset1:68
v_pk_mul_f32 v[98:99], v[88:89], v[68:69] op_sel:[0,0] op_sel_hi:[1,0]
v_pk_fma_f32 v[88:89], v[88:89], v[68:69], v[98:99] op_sel:[1,1,0] op_sel_hi:[0,1,1] neg_lo:[1,0,0]
v_cvt_pk_bf16_f32 v102, v88, -v89
v_pk_mul_f32 v[98:99], v[88:89], v[68:69] op_sel:[0,0] op_sel_hi:[1,0]
v_pk_fma_f32 v[88:89], v[88:89], v[68:69], v[98:99] op_sel:[1,1,0] op_sel_hi:[0,1,1] neg_lo:[1,0,0]
v_cvt_pk_bf16_f32 v103, v88, -v89
ds_write2_b32 v3, v102, v103 offset0:72 offset1:76
v_pk_mul_f32 v[98:99], v[88:89], v[68:69] op_sel:[0,0] op_sel_hi:[1,0]
v_pk_fma_f32 v[88:89], v[88:89], v[68:69], v[98:99] op_sel:[1,1,0] op_sel_hi:[0,1,1] neg_lo:[1,0,0]
v_cvt_pk_bf16_f32 v100, v88, -v89
ds_write_b32 v3, v100 offset:320
s_waitcnt lgkmcnt(0)
ds_read_b128 v[8:11], v226 offset:0
ds_read_b128 v[12:15], v226 offset:336
ds_read_b128 v[16:19], v226 offset:1696
ds_read_b128 v[20:23], v226 offset:2032
ds_read_b128 v[24:27], v226 offset:3392
ds_read_b128 v[28:31], v226 offset:3728
ds_read_b128 v[32:35], v226 offset:5088
ds_read_b128 v[36:39], v226 offset:5424
s_waitcnt lgkmcnt(6)
v_mfma_f32_32x32x16_bf16 v[104:119], v[8:11], v[12:15], 0
ds_read_b128 v[8:11], v226 offset:6784
ds_read_b128 v[12:15], v226 offset:7120
s_waitcnt lgkmcnt(6)
v_mfma_f32_32x32x16_bf16 v[104:119], v[16:19], v[20:23], v[104:119]
ds_read_b128 v[16:19], v226 offset:8480
ds_read_b128 v[20:23], v226 offset:8816
s_waitcnt lgkmcnt(6)
v_mfma_f32_32x32x16_bf16 v[104:119], v[24:27], v[28:31], v[104:119]
ds_read_b128 v[24:27], v226 offset:10176
ds_read_b128 v[28:31], v226 offset:10512
s_waitcnt lgkmcnt(6)
v_mfma_f32_32x32x16_bf16 v[104:119], v[32:35], v[36:39], v[104:119]
ds_read_b128 v[32:35], v226 offset:11872
ds_read_b128 v[36:39], v226 offset:12208
s_waitcnt lgkmcnt(6)
v_mfma_f32_32x32x16_bf16 v[104:119], v[8:11], v[12:15], v[104:119]
s_waitcnt lgkmcnt(4)
v_mfma_f32_32x32x16_bf16 v[104:119], v[16:19], v[20:23], v[104:119]
s_waitcnt lgkmcnt(2)
v_mfma_f32_32x32x16_bf16 v[104:119], v[24:27], v[28:31], v[104:119]
s_waitcnt lgkmcnt(0)
v_mfma_f32_32x32x16_bf16 v[104:119], v[32:35], v[36:39], v[104:119]
s_waitcnt vmcnt(0)
v_lshlrev_b32 v48, 16, v132
v_lshlrev_b32 v49, 16, v133
v_lshlrev_b32 v50, 16, v134
v_lshlrev_b32 v51, 16, v135
v_lshlrev_b32 v52, 16, v136
v_lshlrev_b32 v53, 16, v137
v_lshlrev_b32 v54, 16, v138
v_mul_f32 v54, 0x3fb8aa3b, v54
v_exp_f32 v54, v54
s_nop 0
v_cvt_pk_bf16_f32 v54, v54, v54
v_and_b32 v54, 0xffff0000, v54
v_mul_f32 v48, v54, v48
v_mul_f32 v49, v54, v49
v_mul_f32 v56, v54, v50
v_mul_f32 v57, v54, v51
v_mul_f32 v48, 0x3fb8aa3b, v48
v_mul_f32 v49, 0x3e22f983, v49
v_mov_b32 v58, v52
v_mov_b32 v59, v53
v_pk_mul_f32 v[62:63], v[58:59], v[56:57] op_sel:[0,0] op_sel_hi:[1,0]
v_pk_fma_f32 v[60:61], v[58:59], v[56:57], v[62:63] op_sel:[1,1,0] op_sel_hi:[0,1,1] neg_lo:[1,0,0]
v_mul_f32 v72, 0x41000000, v48
v_mul_f32 v74, 0x43800000, v48
v_exp_f32 v70, v48
v_mul_f32 v73, 0x41000000, v49
v_mul_f32 v75, 0x43800000, v49
v_fract_f32 v71, v49
v_exp_f32 v72, v72
v_exp_f32 v74, v74
v_cos_f32 v64, v71
v_fract_f32 v73, v73
v_fract_f32 v75, v75
v_cos_f32 v66, v73
v_cos_f32 v68, v75
v_sin_f32 v65, v71
v_sin_f32 v67, v73
v_sin_f32 v69, v75
v_pk_mul_f32 v[64:65], v[64:65], v[70:71] op_sel_hi:[1,0]
v_pk_mul_f32 v[66:67], v[66:67], v[72:73] op_sel_hi:[1,0]
v_pk_mul_f32 v[68:69], v[68:69], v[74:75] op_sel_hi:[1,0]
v_mov_b32 v78, 1.0
v_mov_b32 v79, 0
v_pk_mul_f32 v[94:95], v[66:67], v[66:67] op_sel:[0,0] op_sel_hi:[1,0]
v_pk_mul_f32 v[96:97], v[64:65], v[64:65] op_sel:[0,0] op_sel_hi:[1,0]
v_pk_mul_f32 v[98:99], v[68:69], v[68:69] op_sel:[0,0] op_sel_hi:[1,0]
v_cvt_pk_bf16_f32 v100, v78, v79
v_cvt_pk_bf16_f32 v101, v66, v67
ds_write2_b32 v3, v100, v101 offset0:84 offset1:88
v_pk_fma_f32 v[76:77], v[66:67], v[66:67], v[94:95] op_sel:[1,1,0] op_sel_hi:[0,1,1] neg_lo:[1,0,0]
v_pk_fma_f32 v[84:85], v[64:65], v[64:65], v[96:97] op_sel:[1,1,0] op_sel_hi:[0,1,1] neg_lo:[1,0,0]
v_pk_fma_f32 v[92:93], v[68:69], v[68:69], v[98:99] op_sel:[1,1,0] op_sel_hi:[0,1,1] neg_lo:[1,0,0]
v_cvt_pk_bf16_f32 v102, v60, -v61
v_cvt_pk_bf16_f32 v103, v76, v77
ds_write2_b32 v3, v102, v103 offset0:0 offset1:92
v_pk_mul_f32 v[94:95], v[66:67], v[76:77] op_sel:[0,0] op_sel_hi:[1,0]
v_pk_mul_f32 v[96:97], v[76:77], v[76:77] op_sel:[0,0] op_sel_hi:[1,0]
v_pk_mul_f32 v[98:99], v[60:61], v[64:65] op_sel:[0,0] op_sel_hi:[1,0]
v_pk_fma_f32 v[80:81], v[66:67], v[76:77], v[94:95] op_sel:[1,1,0] op_sel_hi:[0,1,1] neg_lo:[1,0,0]
v_pk_fma_f32 v[78:79], v[76:77], v[76:77], v[96:97] op_sel:[1,1,0] op_sel_hi:[0,1,1] neg_lo:[1,0,0]
v_pk_fma_f32 v[82:83], v[60:61], v[64:65], v[98:99] op_sel:[1,1,0] op_sel_hi:[0,1,1] neg_lo:[1,0,0]
v_cvt_pk_bf16_f32 v100, v80, v81
v_cvt_pk_bf16_f32 v101, v78, v79
ds_write2_b32 v3, v100, v101 offset0:96 offset1:100
v_cvt_pk_bf16_f32 v102, v82, -v83
v_pk_mul_f32 v[94:95], v[80:81], v[76:77] op_sel:[0,0] op_sel_hi:[1,0]
v_pk_mul_f32 v[96:97], v[78:79], v[76:77] op_sel:[0,0] op_sel_hi:[1,0]
v_pk_mul_f32 v[98:99], v[84:85], v[84:85] op_sel:[0,0] op_sel_hi:[1,0]
v_pk_fma_f32 v[80:81], v[80:81], v[76:77], v[94:95] op_sel:[1,1,0] op_sel_hi:[0,1,1] neg_lo:[1,0,0]
v_pk_fma_f32 v[78:79], v[78:79], v[76:77], v[96:97] op_sel:[1,1,0] op_sel_hi:[0,1,1] neg_lo:[1,0,0]
v_pk_fma_f32 v[86:87], v[84:85], v[84:85], v[98:99] op_sel:[1,1,0] op_sel_hi:[0,1,1] neg_lo:[1,0,0]
v_cvt_pk_bf16_f32 v103, v80, v81
ds_write2_b32 v3, v102, v103 offset0:4 offset1:104
v_cvt_pk_bf16_f32 v100, v78, v79
v_pk_mul_f32 v[94:95], v[80:81], v[76:77] op_sel:[0,0] op_sel_hi:[1,0]
v_pk_mul_f32 v[96:97], v[78:79], v[76:77] op_sel:[0,0] op_sel_hi:[1,0]
v_pk_mul_f32 v[98:99], v[60:61], v[68:69] op_sel:[0,0] op_sel_hi:[1,0]
v_pk_fma_f32 v[80:81], v[80:81], v[76:77], v[94:95] op_sel:[1,1,0] op_sel_hi:[0,1,1] neg_lo:[1,0,0]
v_pk_fma_f32 v[78:79], v[78:79], v[76:77], v[96:97] op_sel:[1,1,0] op_sel_hi:[0,1,1] neg_lo:[1,0,0]
v_pk_fma_f32 v[88:89], v[60:61], v[68:69], v[98:99] op_sel:[1,1,0] op_sel_hi:[0,1,1] neg_lo:[1,0,0]
v_cvt_pk_bf16_f32 v101, v80, v81
ds_write2_b32 v3, v100, v101 offset0:108 offset1:112
v_cvt_pk_bf16_f32 v102, v78, v79
v_cvt_pk_bf16_f32 v103, v88, -v89
ds_write2_b32 v3, v102, v103 offset0:116 offset1:32
v_pk_mul_f32 v[94:95], v[80:81], v[76:77] op_sel:[0,0] op_sel_hi:[1,0]
v_pk_mul_f32 v[96:97], v[78:79], v[76:77] op_sel:[0,0] op_sel_hi:[1,0]
v_pk_mul_f32 v[98:99], v[60:61], v[92:93] op_sel:[0,0] op_sel_hi:[1,0]
v_pk_fma_f32 v[80:81], v[80:81], v[76:77], v[94:95] op_sel:[1,1,0] op_sel_hi:[0,1,1] neg_lo:[1,0,0]
v_pk_fma_f32 v[78:79], v[78:79], v[76:77], v[96:97] op_sel:[1,1,0] op_sel_hi:[0,1,1] neg_lo:[1,0,0]
v_pk_fma_f32 v[90:91], v[60:61], v[92:93], v[98:99] op_sel:[1,1,0] op_sel_hi:[0,1,1] neg_lo:[1,0,0]
v_cvt_pk_bf16_f32 v100, v80, v81
v_cvt_pk_bf16_f32 v101, v78, v79
ds_write2_b32 v3, v100, v101 offset0:120 offset1:124
v_cvt_pk_bf16_f32 v102, v90, -v91
v_pk_mul_f32 v[94:95], v[80:81], v[76:77] op_sel:[0,0] op_sel_hi:[1,0]
v_pk_mul_f32 v[96:97], v[78:79], v[76:77] op_sel:[0,0] op_sel_hi:[1,0]
v_pk_mul_f32 v[98:99], v[82:83], v[64:65] op_sel:[0,0] op_sel_hi:[1,0]
v_pk_fma_f32 v[80:81], v[80:81], v[76:77], v[94:95] op_sel:[1,1,0] op_sel_hi:[0,1,1] neg_lo:[1,0,0]
v_pk_fma_f32 v[78:79], v[78:79], v[76:77], v[96:97] op_sel:[1,1,0] op_sel_hi:[0,1,1] neg_lo:[1,0,0]
v_pk_fma_f32 v[82:83], v[82:83], v[64:65], v[98:99] op_sel:[1,1,0] op_sel_hi:[0,1,1] neg_lo:[1,0,0]
v_cvt_pk_bf16_f32 v103, v80, v81
ds_write2_b32 v3, v102, v103 offset0:48 offset1:128
v_cvt_pk_bf16_f32 v100, v78, v79
v_cvt_pk_bf16_f32 v101, v82, -v83
ds_write2_b32 v3, v100, v101 offset0:132 offset1:8
v_pk_mul_f32 v[94:95], v[80:81], v[76:77] op_sel:[0,0] op_sel_hi:[1,0]
v_pk_mul_f32 v[96:97], v[78:79], v[76:77] op_sel:[0,0] op_sel_hi:[1,0]
v_pk_mul_f32 v[98:99], v[82:83], v[64:65] op_sel:[0,0] op_sel_hi:[1,0]
v_pk_fma_f32 v[80:81], v[80:81], v[76:77], v[94:95] op_sel:[1,1,0] op_sel_hi:[0,1,1] neg_lo:[1,0,0]
v_pk_fma_f32 v[78:79], v[78:79], v[76:77], v[96:97] op_sel:[1,1,0] op_sel_hi:[0,1,1] neg_lo:[1,0,0]
v_pk_fma_f32 v[82:83], v[82:83], v[64:65], v[98:99] op_sel:[1,1,0] op_sel_hi:[0,1,1] neg_lo:[1,0,0]
v_cvt_pk_bf16_f32 v102, v80, v81
v_cvt_pk_bf16_f32 v103, v78, v79
ds_write2_b32 v3, v102, v103 offset0:136 offset1:140
v_cvt_pk_bf16_f32 v100, v82, -v83
v_pk_mul_f32 v[94:95], v[80:81], v[76:77] op_sel:[0,0] op_sel_hi:[1,0]
v_pk_mul_f32 v[96:97], v[78:79], v[76:77] op_sel:[0,0] op_sel_hi:[1,0]
v_pk_mul_f32 v[98:99], v[82:83], v[64:65] op_sel:[0,0] op_sel_hi:[1,0]
v_pk_fma_f32 v[80:81], v[80:81], v[76:77], v[94:95] op_sel:[1,1,0] op_sel_hi:[0,1,1] neg_lo:[1,0,0]
v_pk_fma_f32 v[78:79], v[78:79], v[76:77], v[96:97] op_sel:[1,1,0] op_sel_hi:[0,1,1] neg_lo:[1,0,0]
v_pk_fma_f32 v[82:83], v[82:83], v[64:65], v[98:99] op_sel:[1,1,0] op_sel_hi:[0,1,1] neg_lo:[1,0,0]
v_cvt_pk_bf16_f32 v101, v80, v81
ds_write2_b32 v3, v100, v101 offset0:12 offset1:144
v_cvt_pk_bf16_f32 v102, v78, v79
v_cvt_pk_bf16_f32 v103, v82, -v83
ds_write2_b32 v3, v102, v103 offset0:148 offset1:16
v_pk_mul_f32 v[94:95], v[80:81], v[76:77] op_sel:[0,0] op_sel_hi:[1,0]
v_pk_mul_f32 v[96:97], v[78:79], v[76:77] op_sel:[0,0] op_sel_hi:[1,0]
v_pk_mul_f32 v[98:99], v[82:83], v[64:65] op_sel:[0,0] op_sel_hi:[1,0]
v_pk_fma_f32 v[80:81], v[80:81], v[76:77], v[94:95] op_sel:[1,1,0] op_sel_hi:[0,1,1] neg_lo:[1,0,0]
v_pk_fma_f32 v[78:79], v[78:79], v[76:77], v[96:97] op_sel:[1,1,0] op_sel_hi:[0,1,1] neg_lo:[1,0,0]
v_pk_fma_f32 v[82:83], v[82:83], v[64:65], v[98:99] op_sel:[1,1,0] op_sel_hi:[0,1,1] neg_lo:[1,0,0]
v_cvt_pk_bf16_f32 v100, v80, v81
v_cvt_pk_bf16_f32 v101, v78, v79
ds_write2_b32 v3, v100, v101 offset0:152 offset1:156
v_cvt_pk_bf16_f32 v102, v82, -v83
v_pk_mul_f32 v[94:95], v[80:81], v[76:77] op_sel:[0,0] op_sel_hi:[1,0]
v_pk_mul_f32 v[96:97], v[78:79], v[76:77] op_sel:[0,0] op_sel_hi:[1,0]
v_pk_mul_f32 v[98:99], v[82:83], v[64:65] op_sel:[0,0] op_sel_hi:[1,0]
v_pk_fma_f32 v[80:81], v[80:81], v[76:77], v[94:95] op_sel:[1,1,0] op_sel_hi:[0,1,1] neg_lo:[1,0,0]
v_pk_fma_f32 v[78:79], v[78:79], v[76:77], v[96:97] op_sel:[1,1,0] op_sel_hi:[0,1,1] neg_lo:[1,0,0]
v_pk_fma_f32 v[82:83], v[82:83], v[64:65], v[98:99] op_sel:[1,1,0] op_sel_hi:[0,1,1] neg_lo:[1,0,0]
v_cvt_pk_bf16_f32 v103, v80, v81
ds_write2_b32 v3, v102, v103 offset0:20 offset1:160
v_cvt_pk_bf16_f32 v100, v78, v79
v_cvt_pk_bf16_f32 v101, v82, -v83
ds_write2_b32 v3, v100, v101 offset0:164 offset1:24
v_pk_mul_f32 v[94:95], v[80:81], v[76:77] op_sel:[0,0] op_sel_hi:[1,0]
v_pk_mul_f32 v[96:97], v[78:79], v[76:77] op_sel:[0,0] op_sel_hi:[1,0]
v_pk_mul_f32 v[98:99], v[82:83], v[64:65] op_sel:[0,0] op_sel_hi:[1,0]
v_pk_fma_f32 v[80:81], v[80:81], v[76:77], v[94:95] op_sel:[1,1,0] op_sel_hi:[0,1,1] neg_lo:[1,0,0]
v_pk_fma_f32 v[78:79], v[78:79], v[76:77], v[96:97] op_sel:[1,1,0] op_sel_hi:[0,1,1] neg_lo:[1,0,0]
v_pk_fma_f32 v[82:83], v[82:83], v[64:65], v[98:99] op_sel:[1,1,0] op_sel_hi:[0,1,1] neg_lo:[1,0,0]
v_cvt_pk_bf16_f32 v102, v80, v81
v_cvt_pk_bf16_f32 v103, v78, v79
ds_write2_b32 v3, v102, v103 offset0:168 offset1:172
v_cvt_pk_bf16_f32 v100, v82, -v83
v_pk_mul_f32 v[94:95], v[80:81], v[76:77] op_sel:[0,0] op_sel_hi:[1,0]
v_pk_mul_f32 v[96:97], v[78:79], v[76:77] op_sel:[0,0] op_sel_hi:[1,0]
v_pk_mul_f32 v[98:99], v[90:91], v[86:87] op_sel:[0,0] op_sel_hi:[1,0]
v_pk_fma_f32 v[80:81], v[80:81], v[76:77], v[94:95] op_sel:[1,1,0] op_sel_hi:[0,1,1] neg_lo:[1,0,0]
v_pk_fma_f32 v[78:79], v[78:79], v[76:77], v[96:97] op_sel:[1,1,0] op_sel_hi:[0,1,1] neg_lo:[1,0,0]
v_pk_fma_f32 v[82:83], v[90:91], v[86:87], v[98:99] op_sel:[1,1,0] op_sel_hi:[0,1,1] neg_lo:[1,0,0]
v_cvt_pk_bf16_f32 v101, v80, v81
ds_write2_b32 v3, v100, v101 offset0:28 offset1:176
v_cvt_pk_bf16_f32 v102, v78, v79
v_cvt_pk_bf16_f32 v103, v82, -v83
ds_write2_b32 v3, v102, v103 offset0:180 offset1:52
v_pk_mul_f32 v[94:95], v[80:81], v[76:77] op_sel:[0,0] op_sel_hi:[1,0]
v_pk_mul_f32 v[96:97], v[78:79], v[76:77] op_sel:[0,0] op_sel_hi:[1,0]
v_pk_mul_f32 v[98:99], v[88:89], v[84:85] op_sel:[0,0] op_sel_hi:[1,0]
v_pk_fma_f32 v[80:81], v[80:81], v[76:77], v[94:95] op_sel:[1,1,0] op_sel_hi:[0,1,1] neg_lo:[1,0,0]
v_pk_fma_f32 v[78:79], v[78:79], v[76:77], v[96:97] op_sel:[1,1,0] op_sel_hi:[0,1,1] neg_lo:[1,0,0]
v_pk_fma_f32 v[88:89], v[88:89], v[84:85], v[98:99] op_sel:[1,1,0] op_sel_hi:[0,1,1] neg_lo:[1,0,0]
v_cvt_pk_bf16_f32 v100, v80, v81
v_cvt_pk_bf16_f32 v101, v78, v79
ds_write2_b32 v3, v100, v101 offset0:184 offset1:188
v_cvt_pk_bf16_f32 v102, v88, -v89
v_pk_mul_f32 v[94:95], v[80:81], v[76:77] op_sel:[0,0] op_sel_hi:[1,0]
v_pk_mul_f32 v[96:97], v[78:79], v[76:77] op_sel:[0,0] op_sel_hi:[1,0]
v_pk_mul_f32 v[98:99], v[88:89], v[84:85] op_sel:[0,0] op_sel_hi:[1,0]
v_pk_fma_f32 v[80:81], v[80:81], v[76:77], v[94:95] op_sel:[1,1,0] op_sel_hi:[0,1,1] neg_lo:[1,0,0]
v_pk_fma_f32 v[78:79], v[78:79], v[76:77], v[96:97] op_sel:[1,1,0] op_sel_hi:[0,1,1] neg_lo:[1,0,0]
v_pk_fma_f32 v[88:89], v[88:89], v[84:85], v[98:99] op_sel:[1,1,0] op_sel_hi:[0,1,1] neg_lo:[1,0,0]
v_cvt_pk_bf16_f32 v103, v80, v81
ds_write2_b32 v3, v102, v103 offset0:36 offset1:192
v_cvt_pk_bf16_f32 v100, v78, v79
v_cvt_pk_bf16_f32 v101, v88, -v89
ds_write2_b32 v3, v100, v101 offset0:196 offset1:40
v_pk_mul_f32 v[94:95], v[80:81], v[76:77] op_sel:[0,0] op_sel_hi:[1,0]
v_pk_mul_f32 v[96:97], v[78:79], v[76:77] op_sel:[0,0] op_sel_hi:[1,0]
v_pk_mul_f32 v[98:99], v[88:89], v[84:85] op_sel:[0,0] op_sel_hi:[1,0]
v_pk_fma_f32 v[80:81], v[80:81], v[76:77], v[94:95] op_sel:[1,1,0] op_sel_hi:[0,1,1] neg_lo:[1,0,0]
v_pk_fma_f32 v[78:79], v[78:79], v[76:77], v[96:97] op_sel:[1,1,0] op_sel_hi:[0,1,1] neg_lo:[1,0,0]
v_pk_fma_f32 v[88:89], v[88:89], v[84:85], v[98:99] op_sel:[1,1,0] op_sel_hi:[0,1,1] neg_lo:[1,0,0]
v_cvt_pk_bf16_f32 v102, v80, v81
v_cvt_pk_bf16_f32 v103, v78, v79
ds_write2_b32 v3, v102, v103 offset0:200 offset1:204
v_cvt_pk_bf16_f32 v100, v88, -v89
v_pk_mul_f32 v[94:95], v[80:81], v[76:77] op_sel:[0,0] op_sel_hi:[1,0]
v_pk_mul_f32 v[98:99], v[90:91], v[92:93] op_sel:[0,0] op_sel_hi:[1,0]
v_pk_fma_f32 v[80:81], v[80:81], v[76:77], v[94:95] op_sel:[1,1,0] op_sel_hi:[0,1,1] neg_lo:[1,0,0]
v_pk_fma_f32 v[88:89], v[90:91], v[92:93], v[98:99] op_sel:[1,1,0] op_sel_hi:[0,1,1] neg_lo:[1,0,0]
v_cvt_pk_bf16_f32 v101, v80, v81
ds_write2_b32 v3, v100, v101 offset0:44 offset1:208
v_cvt_pk_bf16_f32 v102, v88, -v89
v_pk_mul_f32 v[98:99], v[90:91], v[68:69] op_sel:[0,0] op_sel_hi:[1,0]
v_pk_fma_f32 v[90:91], v[90:91], v[68:69], v[98:99] op_sel:[1,1,0] op_sel_hi:[0,1,1] neg_lo:[1,0,0]
v_cvt_pk_bf16_f32 v103, v90, -v91
ds_write2_b32 v3, v102, v103 offset0:64 offset1:56
v_pk_mul_f32 v[98:99], v[90:91], v[86:87] op_sel:[0,0] op_sel_hi:[1,0]
v_pk_fma_f32 v[82:83], v[90:91], v[86:87], v[98:99] op_sel:[1,1,0] op_sel_hi:[0,1,1] neg_lo:[1,0,0]
v_cvt_pk_bf16_f32 v100, v82, -v83
v_pk_mul_f32 v[98:99], v[88:89], v[68:69] op_sel:[0,0] op_sel_hi:[1,0]
v_pk_fma_f32 v[88:89], v[88:89], v[68:69], v[98:99] op_sel:[1,1,0] op_sel_hi:[0,1,1] neg_lo:[1,0,0]
v_cvt_pk_bf16_f32 v101, v88, -v89
ds_write2_b32 v3, v100, v101 offset0:60 offset1:68
v_pk_mul_f32 v[98:99], v[88:89], v[68:69] op_sel:[0,0] op_sel_hi:[1,0]
v_pk_fma_f32 v[88:89], v[88:89], v[68:69], v[98:99] op_sel:[1,1,0] op_sel_hi:[0,1,1] neg_lo:[1,0,0]
v_cvt_pk_bf16_f32 v102, v88, -v89
v_pk_mul_f32 v[98:99], v[88:89], v[68:69] op_sel:[0,0] op_sel_hi:[1,0]
v_pk_fma_f32 v[88:89], v[88:89], v[68:69], v[98:99] op_sel:[1,1,0] op_sel_hi:[0,1,1] neg_lo:[1,0,0]
v_cvt_pk_bf16_f32 v103, v88, -v89
ds_write2_b32 v3, v102, v103 offset0:72 offset1:76
v_pk_mul_f32 v[98:99], v[88:89], v[68:69] op_sel:[0,0] op_sel_hi:[1,0]
v_pk_fma_f32 v[88:89], v[88:89], v[68:69], v[98:99] op_sel:[1,1,0] op_sel_hi:[0,1,1] neg_lo:[1,0,0]
v_cvt_pk_bf16_f32 v100, v88, -v89
ds_write_b32 v3, v100 offset:320
s_waitcnt lgkmcnt(0)
ds_read_b128 v[120:123], v226 offset:0
ds_read_b128 v[124:127], v226 offset:336
ds_read_b128 v[128:131], v226 offset:1696
ds_read_b128 v[132:135], v226 offset:2032
ds_read_b128 v[136:139], v226 offset:3392
ds_read_b128 v[140:143], v226 offset:3728
ds_read_b128 v[144:147], v226 offset:5088
ds_read_b128 v[148:151], v226 offset:5424
s_waitcnt lgkmcnt(6)
v_mfma_f32_32x32x16_bf16 v[208:223], v[120:123], v[124:127], 0
ds_read_b128 v[120:123], v226 offset:6784
ds_read_b128 v[124:127], v226 offset:7120
s_waitcnt lgkmcnt(6)
v_mfma_f32_32x32x16_bf16 v[208:223], v[128:131], v[132:135], v[208:223]
ds_read_b128 v[128:131], v226 offset:8480
ds_read_b128 v[132:135], v226 offset:8816
s_waitcnt lgkmcnt(6)
v_mfma_f32_32x32x16_bf16 v[208:223], v[136:139], v[140:143], v[208:223]
ds_read_b128 v[136:139], v226 offset:10176
ds_read_b128 v[140:143], v226 offset:10512
s_waitcnt lgkmcnt(6)
v_mfma_f32_32x32x16_bf16 v[208:223], v[144:147], v[148:151], v[208:223]
ds_read_b128 v[144:147], v226 offset:11872
ds_read_b128 v[148:151], v226 offset:12208
s_waitcnt lgkmcnt(6)
v_mfma_f32_32x32x16_bf16 v[208:223], v[120:123], v[124:127], v[208:223]
s_waitcnt lgkmcnt(4)
v_mfma_f32_32x32x16_bf16 v[208:223], v[128:131], v[132:135], v[208:223]
s_waitcnt lgkmcnt(2)
v_mfma_f32_32x32x16_bf16 v[208:223], v[136:139], v[140:143], v[208:223]
s_waitcnt lgkmcnt(0)
v_mfma_f32_32x32x16_bf16 v[208:223], v[144:147], v[148:151], v[208:223]
s_waitcnt lgkmcnt(0)
s_mov_b64 exec, 1
v_mov_b32 v236, 163344
v_mov_b32 v237, 1
ds_add_u32 v236, v237
s_mov_b64 exec, -1
v_mov_b32 v236, 163336
s_mov_b32 s28, 0
LW_XF:
ds_read_b32 v237, v236
s_waitcnt lgkmcnt(0)
v_readfirstlane_b32 s29, v237
s_add_u32 s28, s28, 1
s_cmp_gt_u32 s28, 2000000
s_cbranch_scc1 LD_XF
s_cmp_lt_u32 s29, 4
s_cbranch_scc1 LW_XF
LD_XF:
v_mov_b32 v236, 163344
s_mov_b32 s28, 0
LW_K0:
ds_read_b32 v237, v236
s_waitcnt lgkmcnt(0)
v_readfirstlane_b32 s29, v237
s_add_u32 s28, s28, 1
s_cmp_gt_u32 s28, 2000000
s_cbranch_scc1 LD_K0
s_cmp_lt_u32 s29, 4
s_cbranch_scc1 LW_K0
LD_K0:
ds_write_b128 v227, v[104:107] offset:0
ds_write_b128 v227, v[208:211] offset:21504
ds_write_b128 v227, v[108:111] offset:1024
ds_write_b128 v227, v[212:215] offset:22528
ds_write_b128 v227, v[112:115] offset:2048
ds_write_b128 v227, v[216:219] offset:23552
s_waitcnt lgkmcnt(0)
s_mov_b64 exec, 1
v_mov_b32 v236, 163348
v_mov_b32 v237, 1
ds_add_u32 v236, v237
s_mov_b64 exec, -1
v_mov_b32 v236, 163348
s_mov_b32 s28, 0
LW_K1:
ds_read_b32 v237, v236
s_waitcnt lgkmcnt(0)
v_readfirstlane_b32 s29, v237
s_add_u32 s28, s28, 1
s_cmp_gt_u32 s28, 2000000
s_cbranch_scc1 LD_K1
s_cmp_lt_u32 s29, 4
s_cbranch_scc1 LW_K1
LD_K1:
s_cmp_eq_u32 s32, 3
s_cbranch_scc1 P1_SKIP
ds_read_b128 v[120:123], v228 offset:0
ds_read_b128 v[124:127], v228 offset:3072
ds_read_b128 v[128:131], v228 offset:6144
ds_read_b128 v[132:135], v228 offset:9216
ds_read_b128 v[136:139], v228 offset:21504
ds_read_b128 v[140:143], v228 offset:24576
ds_read_b128 v[144:147], v228 offset:27648
ds_read_b128 v[148:151], v228 offset:30720
v_lshlrev_b32 v8, 2, v224
v_add_u32 v8, 78848, v8
s_waitcnt lgkmcnt(0)
v_pk_add_f32 v[120:121], v[120:121], v[124:125]
v_pk_add_f32 v[122:123], v[122:123], v[126:127]
v_pk_add_f32 v[128:129], v[128:129], v[132:133]
v_pk_add_f32 v[130:131], v[130:131], v[134:135]
v_pk_add_f32 v[120:121], v[120:121], v[128:129]
v_pk_add_f32 v[122:123], v[122:123], v[130:131]
v_pk_add_f32 v[136:137], v[136:137], v[140:141]
v_pk_add_f32 v[138:139], v[138:139], v[142:143]
v_pk_add_f32 v[144:145], v[144:145], v[148:149]
v_pk_add_f32 v[146:147], v[146:147], v[150:151]
v_pk_add_f32 v[136:137], v[136:137], v[144:145]
v_pk_add_f32 v[138:139], v[138:139], v[146:147]
s_cmp_lg_u32 s32, 0
s_cbranch_scc1 P1_Q0
v_mul_i32_i24 v9, 4608, v225
v_add_u32 v9, v9, v8
ds_write_b32 v9, v120 offset:0
ds_write_b32 v9, v136 offset:21504
v_mul_i32_i24 v9, 4608, v225
v_add_u32 v9, v9, v8
ds_write_b32 v9, v121 offset:1152
ds_write_b32 v9, v137 offset:22656
v_mul_i32_i24 v9, 4608, v225
v_add_u32 v9, v9, v8
ds_write_b32 v9, v122 offset:2304
ds_write_b32 v9, v138 offset:23808
v_mul_i32_i24 v9, 4608, v225
v_add_u32 v9, v9, v8
ds_write_b32 v9, v123 offset:3456
ds_write_b32 v9, v139 offset:24960
P1_Q0:
s_cmp_lg_u32 s32, 1
s_cbranch_scc1 P1_Q1
v_mul_i32_i24 v9, 128, v225
v_add_u32 v9, v9, v8
ds_write_b32 v9, v120 offset:128
ds_write_b32 v9, v136 offset:21632
v_mul_i32_i24 v9, 2432, v225
v_add_u32 v9, v9, v8
ds_write_b32 v9, v121 offset:2432
ds_write_b32 v9, v137 offset:23936
v_mul_i32_i24 v9, -4352, v225
v_add_u32 v9, v9, v8
ds_write_b32 v9, v122 offset:4736
ds_write_b32 v9, v138 offset:26240
v_mul_i32_i24 v9, -2048, v225
v_add_u32 v9, v9, v8
ds_write_b32 v9, v123 offset:7040
ds_write_b32 v9, v139 offset:28544
P1_Q1:
s_cmp_lg_u32 s32, 2
s_cbranch_scc1 P1_Q2
v_mul_i32_i24 v9, 512, v225
v_add_u32 v9, v9, v8
ds_write_b32 v9, v120 offset:512
ds_write_b32 v9, v136 offset:22016
v_mul_i32_i24 v9, 1536, v225
v_add_u32 v9, v9, v8
ds_write_b32 v9, v121 offset:640
ds_write_b32 v9, v137 offset:22144
v_mul_i32_i24 v9, 2560, v225
v_add_u32 v9, v9, v8
ds_write_b32 v9, v122 offset:768
ds_write_b32 v9, v138 offset:22272
v_mul_i32_i24 v9, 3584, v225
v_add_u32 v9, v9, v8
ds_write_b32 v9, v123 offset:896
ds_write_b32 v9, v139 offset:22400
P1_Q2:
s_branch P1_SKIP2
P1_SKIP:
v_mov_b32 v120, 0
v_mov_b32 v121, 0
v_mov_b32 v122, 0
v_mov_b32 v123, 0
v_mov_b32 v8, 78848
ds_write_b32 v8, v120 offset:9212
ds_write_b32 v8, v120 offset:30716
v_and_b32 v9, 15, v1
v_mul_u32_u24 v9, 4160, v9
ds_write_b128 v9, v[120:123] offset:4096
P1_SKIP2:
s_waitcnt lgkmcnt(0)
s_mov_b64 exec, 1
v_mov_b32 v236, 163332
v_mov_b32 v237, 1
ds_add_u32 v236, v237
s_mov_b64 exec, -1
v_mov_b32 v236, 163332
s_mov_b32 s28, 0
LW_K2:
ds_read_b32 v237, v236
s_waitcnt lgkmcnt(0)
v_readfirstlane_b32 s29, v237
s_add_u32 s28, s28, 1
s_cmp_gt_u32 s28, 2000000
s_cbranch_scc1 LD_K2
s_cmp_lt_u32 s29, 4
s_cbranch_scc1 LW_K2
LD_K2:
v_lshlrev_b32 v8, 4, v5
ds_read_b32 v168, v152 offset:0
ds_read_b32 v169, v153 offset:0
ds_read_b32 v170, v154 offset:0
ds_read_b32 v171, v155 offset:0
ds_read_b32 v172, v156 offset:0
ds_read_b32 v173, v157 offset:0
ds_read_b32 v174, v158 offset:0
ds_read_b32 v175, v159 offset:0
ds_read_b32 v176, v160 offset:0
ds_read_b32 v177, v161 offset:0
ds_read_b32 v178, v162 offset:0
ds_read_b32 v179, v163 offset:0
ds_read_b32 v180, v164 offset:0
ds_read_b32 v181, v165 offset:0
ds_read_b32 v182, v166 offset:0
s_waitcnt lgkmcnt(0)
v_cvt_pk_bf16_f32 v184, v168, v169
v_cvt_pk_bf16_f32 v196, v169, v170
v_cvt_pk_bf16_f32 v190, v170, v171
v_cvt_pk_bf16_f32 v202, v171, v172
v_cvt_pk_bf16_f32 v185, v170, v171
v_cvt_pk_bf16_f32 v197, v171, v172
v_cvt_pk_bf16_f32 v191, v172, v173
v_cvt_pk_bf16_f32 v203, v173, v174
v_cvt_pk_bf16_f32 v186, v172, v173
v_cvt_pk_bf16_f32 v198, v173, v174
v_cvt_pk_bf16_f32 v192, v174, v175
v_cvt_pk_bf16_f32 v204, v175, v176
v_cvt_pk_bf16_f32 v187, v174, v175
v_cvt_pk_bf16_f32 v199, v175, v176
v_cvt_pk_bf16_f32 v193, v176, v177
v_cvt_pk_bf16_f32 v205, v177, v178
v_cvt_pk_bf16_f32 v188, v176, v177
v_cvt_pk_bf16_f32 v200, v177, v178
v_cvt_pk_bf16_f32 v194, v178, v179
v_cvt_pk_bf16_f32 v206, v179, v180
v_cvt_pk_bf16_f32 v189, v178, v179
v_cvt_pk_bf16_f32 v201, v179, v180
v_cvt_pk_bf16_f32 v195, v180, v181
v_cvt_pk_bf16_f32 v207, v181, v182
ds_write_b128 v8, v[184:187] offset:0
ds_write_b128 v8, v[196:199] offset:4160
ds_write_b128 v8, v[190:193] offset:8320
ds_write_b128 v8, v[202:205] offset:12480
ds_write_b128 v8, v[186:189] offset:16640
ds_write_b128 v8, v[198:201] offset:20800
ds_write_b128 v8, v[192:195] offset:24960
ds_write_b128 v8, v[204:207] offset:29120
s_nop 1
ds_read_b32 v168, v152 offset:21504
ds_read_b32 v169, v153 offset:21504
ds_read_b32 v170, v154 offset:21504
ds_read_b32 v171, v155 offset:21504
ds_read_b32 v172, v156 offset:21504
ds_read_b32 v173, v157 offset:21504
ds_read_b32 v174, v158 offset:21504
ds_read_b32 v175, v159 offset:21504
ds_read_b32 v176, v160 offset:21504
ds_read_b32 v177, v161 offset:21504
ds_read_b32 v178, v162 offset:21504
ds_read_b32 v179, v163 offset:21504
ds_read_b32 v180, v164 offset:21504
ds_read_b32 v181, v165 offset:21504
ds_read_b32 v182, v166 offset:21504
s_waitcnt lgkmcnt(0)
v_cvt_pk_bf16_f32 v184, v168, v169
v_cvt_pk_bf16_f32 v196, v169, v170
v_cvt_pk_bf16_f32 v190, v170, v171
v_cvt_pk_bf16_f32 v202, v171, v172
v_cvt_pk_bf16_f32 v185, v170, v171
v_cvt_pk_bf16_f32 v197, v171, v172
v_cvt_pk_bf16_f32 v191, v172, v173
v_cvt_pk_bf16_f32 v203, v173, v174
v_cvt_pk_bf16_f32 v186, v172, v173
v_cvt_pk_bf16_f32 v198, v173, v174
v_cvt_pk_bf16_f32 v192, v174, v175
v_cvt_pk_bf16_f32 v204, v175, v176
v_cvt_pk_bf16_f32 v187, v174, v175
v_cvt_pk_bf16_f32 v199, v175, v176
v_cvt_pk_bf16_f32 v193, v176, v177
v_cvt_pk_bf16_f32 v205, v177, v178
v_cvt_pk_bf16_f32 v188, v176, v177
v_cvt_pk_bf16_f32 v200, v177, v178
v_cvt_pk_bf16_f32 v194, v178, v179
v_cvt_pk_bf16_f32 v206, v179, v180
v_cvt_pk_bf16_f32 v189, v178, v179
v_cvt_pk_bf16_f32 v201, v179, v180
v_cvt_pk_bf16_f32 v195, v180, v181
v_cvt_pk_bf16_f32 v207, v181, v182
ds_write_b128 v8, v[184:187] offset:33280
ds_write_b128 v8, v[196:199] offset:37440
ds_write_b128 v8, v[190:193] offset:41600
ds_write_b128 v8, v[202:205] offset:45760
ds_write_b128 v8, v[186:189] offset:49920
ds_write_b128 v8, v[198:201] offset:54080
ds_write_b128 v8, v[192:195] offset:58240
ds_write_b128 v8, v[204:207] offset:62400
s_branch P1_TAIL
P1_KCS:
s_waitcnt lgkmcnt(0)
s_add_u32 s3, s3, 1
v_mov_b32 v236, 163340
s_mov_b32 s28, 0
LW_KC:
ds_read_b32 v237, v236
s_waitcnt lgkmcnt(0)
v_readfirstlane_b32 s29, v237
s_add_u32 s28, s28, 1
s_cmp_gt_u32 s28, 2000000
s_cbranch_scc1 LD_KC
s_cmp_lt_u32 s29, 4
s_cbranch_scc1 LW_KC
LD_KC:
s_branch M_CS
P1_X:
v_and_b32 v2, 15, v1
v_lshrrev_b32 v3, 4, v1
v_mul_u32_u24 v4, 912, v2
v_lshl_add_u32 v4, v3, 4, v4
v_add_u32 v4, s24, v4
v_mov_b32 v120, 0x3f803f80
v_mov_b32 v121, 0x3f803f80
v_mov_b32 v122, 0x3f803f80
v_mov_b32 v123, 0x3f803f80
v_and_b32 v21, 3, v2
v_cmp_eq_u32 s[44:45], 1, v21
v_cmp_eq_u32 s[46:47], 2, v21
v_cmp_eq_u32 s[48:49], 3, v21
v_lshrrev_b32 v21, 2, v2
v_cmp_eq_u32 s[50:51], v21, v3
s_mul_i32 s25, s22, 112
s_add_u32 s25, s25, s24
v_mul_u32_u24 v8, 912, v2
v_lshl_add_u32 v8, v3, 4, v8
v_add_u32 v8, s25, v8
s_mul_i32 s25, s32, 2176
s_add_u32 s25, s25, 112640
v_mul_u32_u24 v9, 136, v2
v_lshl_add_u32 v9, v3, 4, v9
v_add_u32 v9, s25, v9
s_waitcnt vmcnt(0) lgkmcnt(0)
s_add_u32 s3, s3, 1
s_setprio 3
ds_read_b128 v[24:27], v4 offset:0
ds_read_b128 v[28:31], v4 offset:64
ds_read_b128 v[32:35], v4 offset:128
ds_read_b128 v[36:39], v4 offset:192
ds_read_b128 v[40:43], v4 offset:256
ds_read_b128 v[44:47], v4 offset:320
ds_read_b128 v[48:51], v4 offset:384
ds_read_b128 v[52:55], v4 offset:448
ds_read_b128 v[56:59], v4 offset:512
ds_read_b128 v[60:63], v4 offset:576
ds_read_b128 v[64:67], v4 offset:640
ds_read_b128 v[68:71], v4 offset:704
ds_read_b128 v[72:75], v4 offset:768
ds_read_b128 v[76:79], v4 offset:832
ds_read_b128 v[80:83], v8
s_waitcnt lgkmcnt(8)
v_mfma_f32_16x16x32_bf16 v[88:91], v[24:27], v[24:27], 0
v_mfma_f32_16x16x32_bf16 v[92:95], v[120:123], v[24:27], 0
v_mfma_f32_16x16x32_bf16 v[88:91], v[28:31], v[28:31], v[88:91]
v_mfma_f32_16x16x32_bf16 v[92:95], v[120:123], v[28:31], v[92:95]
v_mfma_f32_16x16x32_bf16 v[88:91], v[32:35], v[32:35], v[88:91]
v_mfma_f32_16x16x32_bf16 v[92:95], v[120:123], v[32:35], v[92:95]
v_mfma_f32_16x16x32_bf16 v[88:91], v[36:39], v[36:39], v[88:91]
v_mfma_f32_16x16x32_bf16 v[92:95], v[120:123], v[36:39], v[92:95]
v_mfma_f32_16x16x32_bf16 v[88:91], v[40:43], v[40:43], v[88:91]
v_mfma_f32_16x16x32_bf16 v[92:95], v[120:123], v[40:43], v[92:95]
v_mfma_f32_16x16x32_bf16 v[88:91], v[44:47], v[44:47], v[88:91]
v_mfma_f32_16x16x32_bf16 v[92:95], v[120:123], v[44:47], v[92:95]
v_mfma_f32_16x16x32_bf16 v[88:91], v[48:51], v[48:51], v[88:91]
v_mfma_f32_16x16x32_bf16 v[92:95], v[120:123], v[48:51], v[92:95]
ds_read_b128 v[84:87], v8 offset:64
s_waitcnt lgkmcnt(2)
v_mfma_f32_16x16x32_bf16 v[88:91], v[52:55], v[52:55], v[88:91]
v_mfma_f32_16x16x32_bf16 v[92:95], v[120:123], v[52:55], v[92:95]
v_mfma_f32_16x16x32_bf16 v[88:91], v[56:59], v[56:59], v[88:91]
v_mfma_f32_16x16x32_bf16 v[92:95], v[120:123], v[56:59], v[92:95]
v_mfma_f32_16x16x32_bf16 v[88:91], v[60:63], v[60:63], v[88:91]
v_mfma_f32_16x16x32_bf16 v[92:95], v[120:123], v[60:63], v[92:95]
v_mfma_f32_16x16x32_bf16 v[88:91], v[64:67], v[64:67], v[88:91]
v_mfma_f32_16x16x32_bf16 v[92:95], v[120:123], v[64:67], v[92:95]
v_mfma_f32_16x16x32_bf16 v[88:91], v[68:71], v[68:71], v[88:91]
v_mfma_f32_16x16x32_bf16 v[92:95], v[120:123], v[68:71], v[92:95]
v_mfma_f32_16x16x32_bf16 v[88:91], v[72:75], v[72:75], v[88:91]
v_mfma_f32_16x16x32_bf16 v[92:95], v[120:123], v[72:75], v[92:95]
v_mfma_f32_16x16x32_bf16 v[88:91], v[76:79], v[76:79], v[88:91]
v_mfma_f32_16x16x32_bf16 v[92:95], v[120:123], v[76:79], v[92:95]
s_waitcnt lgkmcnt(0)
s_nop 5
v_cndmask_b32 v16, v88, v89, s[44:45]
v_cndmask_b32 v16, v16, v90, s[46:47]
v_cndmask_b32 v16, v16, v91, s[48:49]
v_mov_b32 v17, 0
v_cndmask_b32 v16, v17, v16, s[50:51]
v_mov_b32 v17, v16
s_nop 1
v_permlane32_swap_b32 v16, v17
v_add_f32 v16, v16, v17
v_mov_b32 v17, v16
s_nop 1
v_permlane16_swap_b32 v16, v17
v_add_f32 v16, v16, v17
v_mul_f32 v18, 0x3b124925, v92
v_mul_f32 v16, 0x3b124925, v16
v_fma_f32 v16, -v18, v18, v16
v_max_f32 v16, 0, v16
v_cvt_pk_bf16_f32 v17, v18, v16
v_lshlrev_b32 v18, 16, v17
v_and_b32 v16, 0xffff0000, v17
v_add_f32 v16, 0x3727c5ac, v16
v_cvt_pk_bf16_f32 v16, v16, v16
v_and_b32 v16, 0xffff0000, v16
v_sqrt_f32 v16, v16
s_nop 0
v_cvt_pk_bf16_f32 v16, v16, v16
v_and_b32 v16, 0xffff0000, v16
v_rcp_f32 v19, v16
v_lshlrev_b32 v24, 16, v80
v_and_b32 v25, 0xffff0000, v80
v_lshlrev_b32 v26, 16, v81
v_and_b32 v27, 0xffff0000, v81
v_lshlrev_b32 v28, 16, v82
v_and_b32 v29, 0xffff0000, v82
v_lshlrev_b32 v30, 16, v83
v_and_b32 v31, 0xffff0000, v83
v_pk_add_f32 v[24:25], v[24:25], v[18:19] op_sel_hi:[1,0] neg_lo:[0,1] neg_hi:[0,1]
v_pk_add_f32 v[26:27], v[26:27], v[18:19] op_sel_hi:[1,0] neg_lo:[0,1] neg_hi:[0,1]
v_pk_add_f32 v[28:29], v[28:29], v[18:19] op_sel_hi:[1,0] neg_lo:[0,1] neg_hi:[0,1]
v_pk_add_f32 v[30:31], v[30:31], v[18:19] op_sel_hi:[1,0] neg_lo:[0,1] neg_hi:[0,1]
v_cvt_pk_bf16_f32 v32, v24, v25
v_cvt_pk_bf16_f32 v33, v26, v27
v_cvt_pk_bf16_f32 v34, v28, v29
v_cvt_pk_bf16_f32 v35, v30, v31
v_lshlrev_b32 v24, 16, v32
v_and_b32 v25, 0xffff0000, v32
v_lshlrev_b32 v26, 16, v33
v_and_b32 v27, 0xffff0000, v33
v_lshlrev_b32 v28, 16, v34
v_and_b32 v29, 0xffff0000, v34
v_lshlrev_b32 v30, 16, v35
v_and_b32 v31, 0xffff0000, v35
v_pk_mul_f32 v[24:25], v[24:25], v[18:19] op_sel:[0,1] op_sel_hi:[1,1]
v_pk_mul_f32 v[26:27], v[26:27], v[18:19] op_sel:[0,1] op_sel_hi:[1,1]
v_pk_mul_f32 v[28:29], v[28:29], v[18:19] op_sel:[0,1] op_sel_hi:[1,1]
v_pk_mul_f32 v[30:31], v[30:31], v[18:19] op_sel:[0,1] op_sel_hi:[1,1]
v_cvt_pk_bf16_f32 v36, v24, v25
v_cvt_pk_bf16_f32 v37, v26, v27
v_cvt_pk_bf16_f32 v38, v28, v29
v_cvt_pk_bf16_f32 v39, v30, v31
v_lshlrev_b32 v24, 16, v84
v_and_b32 v25, 0xffff0000, v84
v_lshlrev_b32 v26, 16, v85
v_and_b32 v27, 0xffff0000, v85
v_lshlrev_b32 v28, 16, v86
v_and_b32 v29, 0xffff0000, v86
v_lshlrev_b32 v30, 16, v87
v_and_b32 v31, 0xffff0000, v87
v_pk_add_f32 v[24:25], v[24:25], v[18:19] op_sel_hi:[1,0] neg_lo:[0,1] neg_hi:[0,1]
v_pk_add_f32 v[26:27], v[26:27], v[18:19] op_sel_hi:[1,0] neg_lo:[0,1] neg_hi:[0,1]
v_pk_add_f32 v[28:29], v[28:29], v[18:19] op_sel_hi:[1,0] neg_lo:[0,1] neg_hi:[0,1]
v_pk_add_f32 v[30:31], v[30:31], v[18:19] op_sel_hi:[1,0] neg_lo:[0,1] neg_hi:[0,1]
v_cvt_pk_bf16_f32 v32, v24, v25
v_cvt_pk_bf16_f32 v33, v26, v27
v_cvt_pk_bf16_f32 v34, v28, v29
v_cvt_pk_bf16_f32 v35, v30, v31
v_lshlrev_b32 v24, 16, v32
v_and_b32 v25, 0xffff0000, v32
v_lshlrev_b32 v26, 16, v33
v_and_b32 v27, 0xffff0000, v33
v_lshlrev_b32 v28, 16, v34
v_and_b32 v29, 0xffff0000, v34
v_lshlrev_b32 v30, 16, v35
v_and_b32 v31, 0xffff0000, v35
v_pk_mul_f32 v[24:25], v[24:25], v[18:19] op_sel:[0,1] op_sel_hi:[1,1]
v_pk_mul_f32 v[26:27], v[26:27], v[18:19] op_sel:[0,1] op_sel_hi:[1,1]
v_pk_mul_f32 v[28:29], v[28:29], v[18:19] op_sel:[0,1] op_sel_hi:[1,1]
v_pk_mul_f32 v[30:31], v[30:31], v[18:19] op_sel:[0,1] op_sel_hi:[1,1]
v_cvt_pk_bf16_f32 v40, v24, v25
v_cvt_pk_bf16_f32 v41, v26, v27
v_cvt_pk_bf16_f32 v42, v28, v29
v_cvt_pk_bf16_f32 v43, v30, v31
ds_write_b64 v9, v[36:37]
ds_write_b64 v9, v[38:39] offset:8
ds_write_b64 v9, v[40:41] offset:64
ds_write_b64 v9, v[42:43] offset:72
s_waitcnt lgkmcnt(0)
s_mov_b64 exec, 1
v_mov_b32 v236, 163328
v_mov_b32 v237, 1
ds_add_u32 v236, v237
s_mov_b64 exec, -1
v_bfe_u32 v10, v1, 4, 1
v_lshlrev_b32 v10, 2, v10
v_and_b32 v11, 3, v1
v_add_u32 v10, v10, v11
v_lshlrev_b32 v10, 3, v10
v_bfe_u32 v11, v1, 2, 2
v_add_u32 v10, v10, v11
v_lshrrev_b32 v11, 5, v1
v_lshlrev_b32 v11, 3, v11
v_mul_u32_u24 v12, 136, v10
v_add_u32 v12, v12, v11
s_lshl_b32 s25, s32, 4
s_add_u32 s26, s25, 112640
v_add_u32 v12, s26, v12
v_mul_u32_u24 v13, 912, v10
v_add_u32 v13, v13, v11
s_mul_i32 s26, s22, 112
s_add_u32 s26, s26, s25
s_add_u32 s26, s26, 54272
v_add_u32 v13, s26, v13
v_lshrrev_b32 v14, 5, v1
v_lshlrev_b32 v14, 2, v14
v_and_b32 v15, 3, v1
v_add_u32 v14, v14, v15
v_lshlrev_b32 v14, 13, v14
v_bfe_u32 v15, v1, 4, 1
v_lshlrev_b32 v15, 2, v15
v_bfe_u32 v11, v1, 2, 2
v_add_u32 v15, v15, v11
v_lshl_add_u32 v14, v15, 4, v14
s_mul_i32 s26, s22, 56
s_lshl_b32 s27, s32, 3
s_add_u32 s26, s26, s27
s_lshl_b32 s26, s26, 13
s_lshl_b32 s27, s21, 7
s_add_u32 s26, s26, s27
v_mov_b32 v236, 163328
s_mov_b32 s28, 0
LW_X0:
ds_read_b32 v237, v236
s_waitcnt lgkmcnt(0)
v_readfirstlane_b32 s29, v237
s_add_u32 s28, s28, 1
s_cmp_gt_u32 s28, 2000000
s_cbranch_scc1 LD_X0
s_cmp_lt_u32 s29, 4
s_cbranch_scc1 LW_X0
LD_X0:
ds_read_b64_tr_b16 v[24:25], v12 offset:0
ds_read_b64_tr_b16 v[26:27], v12 offset:544
ds_read_b64_tr_b16 v[28:29], v13 offset:0
ds_read_b64_tr_b16 v[30:31], v13 offset:3648
s_waitcnt lgkmcnt(0)
buffer_store_dwordx4 v[24:27], v14, s[68:71], s26 offen sc1
s_add_u32 s27, s26, 4096
buffer_store_dwordx4 v[28:31], v14, s[68:71], s27 offen sc1
s_cmp_eq_u32 s32, 3
s_cbranch_scc1 P1_X2
ds_read_b64_tr_b16 v[32:33], v12 offset:64
ds_read_b64_tr_b16 v[34:35], v12 offset:608
ds_read_b64_tr_b16 v[36:37], v13 offset:64
ds_read_b64_tr_b16 v[38:39], v13 offset:3712
s_waitcnt lgkmcnt(0)
s_add_u32 s26, s26, 262144
buffer_store_dwordx4 v[32:35], v14, s[68:71], s26 offen sc1
s_add_u32 s27, s26, 4096
buffer_store_dwordx4 v[36:39], v14, s[68:71], s27 offen sc1
P1_X2:
s_setprio 0
s_add_u32 s60, s4, 4718592
s_addc_u32 s61, s5, 0
s_mov_b32 s62, 1835008
s_mov_b32 s63, 0x20000
v_mov_b32 v244, -1
v_mov_b32 v245, -1
v_mov_b32 v246, -1
v_mov_b32 v247, -1
s_lshl_b32 s27, s72, 12
s_lshl_b32 s28, s32, 11
s_add_u32 s27, s27, s28
buffer_store_dwordx4 v[244:247], v6, s[60:63], s27 offen sc1
buffer_store_dwordx4 v[244:247], v6, s[60:63], s27 offen offset:1024 sc1
s_waitcnt lgkmcnt(0)
s_mov_b64 exec, 1
v_mov_b32 v236, 163336
v_mov_b32 v237, 1
ds_add_u32 v236, v237
s_mov_b64 exec, -1
s_waitcnt vmcnt(0)
s_mov_b64 exec, 1
v_mov_b32 v236, 163340
v_mov_b32 v237, 1
ds_add_rtn_u32 v237, v236, v237
s_waitcnt lgkmcnt(0)
v_readfirstlane_b32 s28, v237
s_nop 1
s_cmp_lg_u32 s28, 3
s_cbranch_scc1 SIG_S1
s_lshl_b32 s29, s22, 5
s_add_u32 s29, s29, s21
s_lshl_b32 s29, s29, 6
v_mov_b32 v236, 0
v_mov_b32 v237, s3
buffer_store_dword v237, v236, s[8:11], s29 offen sc1
SIG_S1:
s_mov_b64 exec, -1
s_sub_u32 s28, s30, 4
s_lshr_b32 s29, s28, 1
s_lshl_b32 s29, s29, 3
s_add_u32 s16, s0, s29
s_addc_u32 s17, s1, 0
s_load_dwordx2 s[16:17], s[16:17], 80
s_and_b32 s28, s28, 1
s_lshr_b32 s18, s2, 3
s_mul_i32 s18, s18, 14
s_lshl_b32 s29, s28, 3
s_add_u32 s18, s18, s29
s_mul_i32 s29, s18, 3584
s_and_b32 s18, s2, 3
s_mul_i32 s18, s18, 896
s_and_b32 s18, s18, 0xffffff80
s_add_u32 s29, s29, s18
v_and_b32 v7, 7, v1
v_lshlrev_b32 v7, 7, v7
v_lshrrev_b32 v4, 3, v1
v_mul_u32_u24 v4, 3584, v4
v_add_u32 v7, v7, v4
s_mov_b32 s18, 1605632
s_mov_b32 s19, 0x20000
s_cmp_eq_u32 s28, 0
s_cselect_b32 s35, -1, 0xffff
s_mov_b32 s34, -1
s_waitcnt lgkmcnt(0)
s_mov_b64 exec, s[34:35]
buffer_load_dword v254, v7, s[16:19], s29 offen
s_mov_b64 exec, -1
s_cmp_ge_u32 s2, 224
s_cbranch_scc1 M_CS
s_cmp_lg_u32 s32, 0
s_cbranch_scc1 P1_NOPOLL
s_mul_i32 s34, s2, 2341
s_lshr_b32 s34, s34, 16
s_lshl_b32 s34, s34, 11
v_and_b32 v16, 31, v1
v_lshlrev_b32 v16, 6, v16
s_mov_b32 s28, 0
buffer_load_dword v17, v16, s[8:11], s34 offen sc1
s_sleep 2
buffer_load_dword v18, v16, s[8:11], s34 offen sc1
s_sleep 2
buffer_load_dword v19, v16, s[8:11], s34 offen sc1
POLL_S1:
s_waitcnt vmcnt(2)
v_xor_b32 v17, s3, v17
v_cmp_ne_u32 vcc, 0, v17
s_nop 1
s_cbranch_vccz POLLD_S1
buffer_load_dword v17, v16, s[8:11], s34 offen sc1
s_waitcnt vmcnt(2)
v_xor_b32 v18, s3, v18
v_cmp_ne_u32 vcc, 0, v18
s_nop 1
s_cbranch_vccz POLLD_S1
buffer_load_dword v18, v16, s[8:11], s34 offen sc1
s_waitcnt vmcnt(2)
v_xor_b32 v19, s3, v19
v_cmp_ne_u32 vcc, 0, v19
s_nop 1
s_cbranch_vccz POLLD_S1
buffer_load_dword v19, v16, s[8:11], s34 offen sc1
s_add_u32 s28, s28, 1
s_cmp_gt_u32 s28, 60000
s_cbranch_scc0 POLL_S1
POLLD_S1:
P1_NOPOLL:
s_waitcnt lgkmcnt(0)
s_mov_b64 exec, 1
v_mov_b32 v236, 163352
v_mov_b32 v237, 1
ds_add_u32 v236, v237
s_mov_b64 exec, -1
v_mov_b32 v236, 163352
s_mov_b32 s28, 0
LW_X1:
ds_read_b32 v237, v236
s_waitcnt lgkmcnt(0)
v_readfirstlane_b32 s29, v237
s_add_u32 s28, s28, 1
s_cmp_gt_u32 s28, 2000000
s_cbranch_scc1 LD_X1
s_cmp_lt_u32 s29, 4
s_cbranch_scc1 LW_X1
LD_X1:
v_lshlrev_b32 v16, 4, v1
s_lshr_b32 s34, s32, 1
s_add_u32 s35, s34, s72
s_lshl_b32 s35, s35, 13
s_and_b32 s36, s32, 1
s_lshl_b32 s36, s36, 12
s_add_u32 s35, s35, s36
s_mul_i32 s34, s34, 8704
s_add_u32 s34, s34, s36
s_add_u32 m0, s34, 142848
s_nop 0
buffer_load_dwordx4 v16, s[68:71], s35 offen offset:0 sc1 lds
buffer_load_dwordx4 v16, s[68:71], s35 offen offset:1024 sc1 lds
buffer_load_dwordx4 v16, s[68:71], s35 offen offset:2048 sc1 lds
buffer_load_dwordx4 v16, s[68:71], s35 offen offset:3072 sc1 lds
s_waitcnt vmcnt(0)
P1_TAIL:
s_waitcnt lgkmcnt(0)
s_barrier
s_cmp_ge_u32 s30, 4
s_cbranch_scc1 M_HELP
s_lshr_b32 s31, s30, 1
s_and_b32 s32, s30, 1
s_add_u32 s33, s72, s31
v_and_b32 v4, 15, v1
v_lshrrev_b32 v5, 4, v1
v_lshlrev_b32 v6, 5, v4
v_lshl_add_u32 v6, v5, 3, v6
s_mul_i32 s34, s31, 33280
v_and_b32 v14, 7, v4
v_sub_u32 v14, 7, v14
v_mul_u32_u24 v14, 4160, v14
v_lshrrev_b32 v15, 3, v4
v_sub_u32 v15, v5, v15
v_lshl_add_u32 v8, v15, 4, v14
v_add_u32 v8, 16, v8
v_add_u32 v8, s34, v8
s_mul_i32 s35, s31, 8704
s_add_u32 s35, s35, 142336
v_lshlrev_b32 v9, 5, v4
v_lshl_add_u32 v9, v5, 4, v9
v_add_u32 v9, 32, v9
v_add_u32 v9, s35, v9
v_add_u32 v10, s35, v6
s_lshl_b32 s38, s33, 12
s_cmp_eq_u32 s32, 0
s_mov_b32 s48, 2560
s_cselect_b32 s44, 3584, s48
s_mov_b32 s48, 2048
s_cselect_b32 s45, 3072, s48
s_mov_b32 s48, 1536
s_cselect_b32 s46, 512, s48
s_mov_b32 s48, 1024
s_cselect_b32 s47, 0, s48
v_add_u32 v11, s44, v10
ds_read_b64 v[32:33], v11 offset:512
ds_read_b64 v[36:37], v11 offset:4608
v_add_u32 v11, s45, v10
ds_read_b64 v[40:41], v11 offset:512
ds_read_b64 v[44:45], v11 offset:4608
v_add_u32 v11, s46, v10
ds_read_b64 v[48:49], v11 offset:512
ds_read_b64 v[52:53], v11 offset:4608
v_add_u32 v11, s47, v10
ds_read_b64 v[56:57], v11 offset:512
ds_read_b64 v[60:61], v11 offset:4608
s_add_u32 s44, s44, s38
s_add_u32 s45, s45, s38
s_add_u32 s46, s46, s38
s_add_u32 s47, s47, s38
s_add_u32 s20, s4, 4718592
s_addc_u32 s21, s5, 0
s_mov_b32 s22, 1835008
s_mov_b32 s23, 0x20000
v_lshlrev_b32 v7, 16, v47
s_waitcnt lgkmcnt(0)
s_cmp_eq_u32 s32, 0
s_cbranch_scc0 P2_Q
ds_read_b128 v[64:67], v9 offset:4032
ds_read_b128 v[96:99], v8 offset:4032
ds_read_b128 v[160:163], v9 offset:960
ds_read_b128 v[92:95], v9 offset:3968
ds_read_b128 v[100:103], v8 offset:3968
ds_read_b128 v[188:191], v9 offset:896
ds_read_b128 v[88:91], v9 offset:3904
ds_read_b128 v[104:107], v8 offset:3904
ds_read_b128 v[184:187], v9 offset:832
ds_read_b128 v[84:87], v9 offset:3840
ds_read_b128 v[108:111], v8 offset:3840
ds_read_b128 v[180:183], v9 offset:768
ds_read_b128 v[80:83], v9 offset:3776
ds_read_b128 v[112:115], v8 offset:3776
ds_read_b128 v[176:179], v9 offset:704
s_waitcnt lgkmcnt(12)
v_mfma_f32_16x16x32_bf16 v[16:19], v[96:99], v[64:67], 0
ds_read_b128 v[76:79], v9 offset:3712
v_mfma_f32_16x16x32_bf16 v[24:27], v[96:99], v[160:163], 0
ds_read_b128 v[116:119], v8 offset:3712
ds_read_b128 v[172:175], v9 offset:640
s_waitcnt lgkmcnt(12)
v_mfma_f32_16x16x32_bf16 v[16:19], v[100:103], v[92:95], v[16:19]
ds_read_b128 v[72:75], v9 offset:3648
v_mfma_f32_16x16x32_bf16 v[24:27], v[100:103], v[188:191], v[24:27]
ds_read_b128 v[120:123], v8 offset:3648
ds_read_b128 v[168:171], v9 offset:576
s_waitcnt lgkmcnt(12)
v_mfma_f32_16x16x32_bf16 v[16:19], v[104:107], v[88:91], v[16:19]
ds_read_b128 v[68:71], v9 offset:3584
v_lshlrev_b32 v236, 16, v32
v_mfma_f32_16x16x32_bf16 v[24:27], v[104:107], v[184:187], v[24:27]
ds_read_b128 v[124:127], v8 offset:3584
v_and_b32 v237, 0xffff0000, v32
ds_read_b128 v[164:167], v9 offset:512
s_waitcnt lgkmcnt(12)
v_mfma_f32_16x16x32_bf16 v[16:19], v[108:111], v[84:87], v[16:19]
ds_read_b128 v[64:67], v9 offset:3520
v_lshlrev_b32 v238, 16, v33
v_mfma_f32_16x16x32_bf16 v[24:27], v[108:111], v[180:183], v[24:27]
ds_read_b128 v[128:131], v8 offset:3520
v_and_b32 v239, 0xffff0000, v33
ds_read_b128 v[160:163], v9 offset:448
s_waitcnt lgkmcnt(12)
v_mfma_f32_16x16x32_bf16 v[16:19], v[112:115], v[80:83], v[16:19]
ds_read_b128 v[92:95], v9 offset:3456
v_mul_f32 v236, v236, v7
v_mfma_f32_16x16x32_bf16 v[24:27], v[112:115], v[176:179], v[24:27]
ds_read_b128 v[132:135], v8 offset:3456
v_mul_f32 v237, v237, v7
ds_read_b128 v[188:191], v9 offset:384
s_waitcnt lgkmcnt(12)
v_mfma_f32_16x16x32_bf16 v[16:19], v[116:119], v[76:79], v[16:19]
ds_read_b128 v[88:91], v9 offset:3392
v_mul_f32 v238, v238, v7
v_mfma_f32_16x16x32_bf16 v[24:27], v[116:119], v[172:175], v[24:27]
ds_read_b128 v[136:139], v8 offset:3392
v_mul_f32 v239, v239, v7
ds_read_b128 v[184:187], v9 offset:320
s_waitcnt lgkmcnt(12)
v_mfma_f32_16x16x32_bf16 v[16:19], v[120:123], v[72:75], v[16:19]
ds_read_b128 v[84:87], v9 offset:3328
v_cvt_pk_bf16_f32 v236, v236, v237
v_mfma_f32_16x16x32_bf16 v[24:27], v[120:123], v[168:171], v[24:27]
ds_read_b128 v[140:143], v8 offset:3328
v_cvt_pk_bf16_f32 v238, v238, v239
ds_read_b128 v[180:183], v9 offset:256
s_waitcnt lgkmcnt(12)
v_mfma_f32_16x16x32_bf16 v[16:19], v[124:127], v[68:71], v[16:19]
ds_read_b128 v[80:83], v9 offset:3264
v_lshlrev_b32 v32, 16, v236
v_mfma_f32_16x16x32_bf16 v[24:27], v[124:127], v[164:167], v[24:27]
ds_read_b128 v[144:147], v8 offset:3264
v_and_b32 v33, 0xffff0000, v236
ds_read_b128 v[176:179], v9 offset:192
s_waitcnt lgkmcnt(12)
v_mfma_f32_16x16x32_bf16 v[16:19], v[128:131], v[64:67], v[16:19]
ds_read_b128 v[76:79], v9 offset:3200
v_lshlrev_b32 v34, 16, v238
v_mfma_f32_16x16x32_bf16 v[20:23], v[96:99], v[64:67], 0
ds_read_b128 v[148:151], v8 offset:3200
v_and_b32 v35, 0xffff0000, v238
v_mfma_f32_16x16x32_bf16 v[24:27], v[128:131], v[160:163], v[24:27]
ds_read_b128 v[172:175], v9 offset:128
v_and_b32 v39, 0xffff0000, v37
v_mfma_f32_16x16x32_bf16 v[28:31], v[96:99], v[160:163], 0
v_lshlrev_b32 v38, 16, v37
s_waitcnt lgkmcnt(12)
v_mfma_f32_16x16x32_bf16 v[16:19], v[132:135], v[92:95], v[16:19]
ds_read_b128 v[72:75], v9 offset:3136
v_and_b32 v37, 0xffff0000, v36
v_mfma_f32_16x16x32_bf16 v[20:23], v[100:103], v[92:95], v[20:23]
ds_read_b128 v[152:155], v8 offset:3136
v_lshlrev_b32 v36, 16, v36
v_mfma_f32_16x16x32_bf16 v[24:27], v[132:135], v[188:191], v[24:27]
ds_read_b128 v[168:171], v9 offset:64
v_lshlrev_b32 v240, 16, v40
v_mfma_f32_16x16x32_bf16 v[28:31], v[100:103], v[188:191], v[28:31]
v_and_b32 v241, 0xffff0000, v40
s_waitcnt lgkmcnt(12)
v_mfma_f32_16x16x32_bf16 v[16:19], v[136:139], v[88:91], v[16:19]
ds_read_b128 v[68:71], v9 offset:3072
v_lshlrev_b32 v242, 16, v41
v_mfma_f32_16x16x32_bf16 v[20:23], v[104:107], v[88:91], v[20:23]
ds_read_b128 v[156:159], v8 offset:3072
v_and_b32 v243, 0xffff0000, v41
v_mfma_f32_16x16x32_bf16 v[24:27], v[136:139], v[184:187], v[24:27]
ds_read_b128 v[164:167], v9 offset:0
v_mul_f32 v240, v240, v7
v_mfma_f32_16x16x32_bf16 v[28:31], v[104:107], v[184:187], v[28:31]
v_mul_f32 v241, v241, v7
s_waitcnt lgkmcnt(12)
v_mfma_f32_16x16x32_bf16 v[16:19], v[140:143], v[84:87], v[16:19]
ds_read_b128 v[64:67], v9 offset:3008
v_mul_f32 v242, v242, v7
v_mfma_f32_16x16x32_bf16 v[20:23], v[108:111], v[84:87], v[20:23]
ds_read_b128 v[96:99], v8 offset:3008
v_mul_f32 v243, v243, v7
v_mfma_f32_16x16x32_bf16 v[24:27], v[140:143], v[180:183], v[24:27]
v_cvt_pk_bf16_f32 v240, v240, v241
v_mfma_f32_16x16x32_bf16 v[28:31], v[108:111], v[180:183], v[28:31]
v_cvt_pk_bf16_f32 v242, v242, v243
s_waitcnt lgkmcnt(11)
v_mfma_f32_16x16x32_bf16 v[16:19], v[144:147], v[80:83], v[16:19]
ds_read_b128 v[92:95], v9 offset:2944
v_lshlrev_b32 v40, 16, v240
v_mfma_f32_16x16x32_bf16 v[20:23], v[112:115], v[80:83], v[20:23]
ds_read_b128 v[100:103], v8 offset:2944
v_and_b32 v41, 0xffff0000, v240
v_mfma_f32_16x16x32_bf16 v[24:27], v[144:147], v[176:179], v[24:27]
v_lshlrev_b32 v42, 16, v242
v_mfma_f32_16x16x32_bf16 v[28:31], v[112:115], v[176:179], v[28:31]
v_and_b32 v43, 0xffff0000, v242
s_waitcnt lgkmcnt(10)
v_mfma_f32_16x16x32_bf16 v[16:19], v[148:151], v[76:79], v[16:19]
ds_read_b128 v[88:91], v9 offset:2880
v_and_b32 v47, 0xffff0000, v45
v_mfma_f32_16x16x32_bf16 v[20:23], v[116:119], v[76:79], v[20:23]
ds_read_b128 v[104:107], v8 offset:2880
v_lshlrev_b32 v46, 16, v45
v_mfma_f32_16x16x32_bf16 v[24:27], v[148:151], v[172:175], v[24:27]
v_and_b32 v45, 0xffff0000, v44
v_mfma_f32_16x16x32_bf16 v[28:31], v[116:119], v[172:175], v[28:31]
v_lshlrev_b32 v44, 16, v44
s_waitcnt lgkmcnt(9)
v_mfma_f32_16x16x32_bf16 v[16:19], v[152:155], v[72:75], v[16:19]
ds_read_b128 v[84:87], v9 offset:2816
v_lshlrev_b32 v236, 16, v48
v_mfma_f32_16x16x32_bf16 v[20:23], v[120:123], v[72:75], v[20:23]
ds_read_b128 v[108:111], v8 offset:2816
v_and_b32 v237, 0xffff0000, v48
v_mfma_f32_16x16x32_bf16 v[24:27], v[152:155], v[168:171], v[24:27]
v_lshlrev_b32 v238, 16, v49
v_mfma_f32_16x16x32_bf16 v[28:31], v[120:123], v[168:171], v[28:31]
v_and_b32 v239, 0xffff0000, v49
s_waitcnt lgkmcnt(8)
v_mfma_f32_16x16x32_bf16 v[16:19], v[156:159], v[68:71], v[16:19]
ds_read_b128 v[80:83], v9 offset:2752
v_mul_f32 v236, v236, v7
v_mfma_f32_16x16x32_bf16 v[20:23], v[124:127], v[68:71], v[20:23]
ds_read_b128 v[112:115], v8 offset:2752
v_mul_f32 v237, v237, v7
v_mfma_f32_16x16x32_bf16 v[24:27], v[156:159], v[164:167], v[24:27]
v_mul_f32 v238, v238, v7
v_mfma_f32_16x16x32_bf16 v[28:31], v[124:127], v[164:167], v[28:31]
v_mul_f32 v239, v239, v7
s_waitcnt lgkmcnt(8)
v_mfma_f32_16x16x32_bf16 v[16:19], v[96:99], v[64:67], v[16:19]
ds_read_b128 v[76:79], v9 offset:2688
v_cvt_pk_bf16_f32 v236, v236, v237
v_mfma_f32_16x16x32_bf16 v[20:23], v[128:131], v[64:67], v[20:23]
ds_read_b128 v[116:119], v8 offset:2688
v_cvt_pk_bf16_f32 v238, v238, v239
s_waitcnt lgkmcnt(8)
v_mfma_f32_16x16x32_bf16 v[16:19], v[100:103], v[92:95], v[16:19]
ds_read_b128 v[72:75], v9 offset:2624
v_lshlrev_b32 v48, 16, v236
v_mfma_f32_16x16x32_bf16 v[20:23], v[132:135], v[92:95], v[20:23]
ds_read_b128 v[120:123], v8 offset:2624
v_and_b32 v49, 0xffff0000, v236
s_waitcnt lgkmcnt(8)
v_mfma_f32_16x16x32_bf16 v[16:19], v[104:107], v[88:91], v[16:19]
ds_read_b128 v[68:71], v9 offset:2560
v_lshlrev_b32 v50, 16, v238
v_mfma_f32_16x16x32_bf16 v[20:23], v[136:139], v[88:91], v[20:23]
ds_read_b128 v[124:127], v8 offset:2560
v_and_b32 v51, 0xffff0000, v238
s_waitcnt lgkmcnt(8)
v_mfma_f32_16x16x32_bf16 v[16:19], v[108:111], v[84:87], v[16:19]
ds_read_b128 v[64:67], v9 offset:2496
v_and_b32 v55, 0xffff0000, v53
v_mfma_f32_16x16x32_bf16 v[20:23], v[140:143], v[84:87], v[20:23]
ds_read_b128 v[128:131], v8 offset:2496
v_lshlrev_b32 v54, 16, v53
s_waitcnt lgkmcnt(8)
v_mfma_f32_16x16x32_bf16 v[16:19], v[112:115], v[80:83], v[16:19]
ds_read_b128 v[92:95], v9 offset:2432
v_and_b32 v53, 0xffff0000, v52
v_mfma_f32_16x16x32_bf16 v[20:23], v[144:147], v[80:83], v[20:23]
ds_read_b128 v[132:135], v8 offset:2432
v_lshlrev_b32 v52, 16, v52
s_waitcnt lgkmcnt(8)
v_mfma_f32_16x16x32_bf16 v[16:19], v[116:119], v[76:79], v[16:19]
ds_read_b128 v[88:91], v9 offset:2368
v_lshlrev_b32 v240, 16, v56
v_mfma_f32_16x16x32_bf16 v[20:23], v[148:151], v[76:79], v[20:23]
ds_read_b128 v[136:139], v8 offset:2368
v_and_b32 v241, 0xffff0000, v56
s_waitcnt lgkmcnt(8)
v_mfma_f32_16x16x32_bf16 v[16:19], v[120:123], v[72:75], v[16:19]
ds_read_b128 v[84:87], v9 offset:2304
v_lshlrev_b32 v242, 16, v57
v_mfma_f32_16x16x32_bf16 v[20:23], v[152:155], v[72:75], v[20:23]
ds_read_b128 v[140:143], v8 offset:2304
v_and_b32 v243, 0xffff0000, v57
s_waitcnt lgkmcnt(8)
v_mfma_f32_16x16x32_bf16 v[16:19], v[124:127], v[68:71], v[16:19]
ds_read_b128 v[80:83], v9 offset:2240
v_mul_f32 v240, v240, v7
v_mfma_f32_16x16x32_bf16 v[20:23], v[156:159], v[68:71], v[20:23]
ds_read_b128 v[144:147], v8 offset:2240
v_mul_f32 v241, v241, v7
s_waitcnt lgkmcnt(8)
v_mfma_f32_16x16x32_bf16 v[16:19], v[128:131], v[64:67], v[16:19]
ds_read_b128 v[76:79], v9 offset:2176
v_mul_f32 v242, v242, v7
v_mfma_f32_16x16x32_bf16 v[20:23], v[96:99], v[64:67], v[20:23]
ds_read_b128 v[148:151], v8 offset:2176
v_mul_f32 v243, v243, v7
s_waitcnt lgkmcnt(8)
v_mfma_f32_16x16x32_bf16 v[16:19], v[132:135], v[92:95], v[16:19]
ds_read_b128 v[72:75], v9 offset:2112
v_cvt_pk_bf16_f32 v240, v240, v241
v_mfma_f32_16x16x32_bf16 v[20:23], v[100:103], v[92:95], v[20:23]
ds_read_b128 v[152:155], v8 offset:2112
v_cvt_pk_bf16_f32 v242, v242, v243
s_waitcnt lgkmcnt(8)
v_mfma_f32_16x16x32_bf16 v[16:19], v[136:139], v[88:91], v[16:19]
ds_read_b128 v[68:71], v9 offset:2048
v_lshlrev_b32 v56, 16, v240
v_mfma_f32_16x16x32_bf16 v[20:23], v[104:107], v[88:91], v[20:23]
ds_read_b128 v[156:159], v8 offset:2048
v_and_b32 v57, 0xffff0000, v240
s_waitcnt lgkmcnt(8)
v_mfma_f32_16x16x32_bf16 v[16:19], v[140:143], v[84:87], v[16:19]
ds_read_b128 v[64:67], v9 offset:1984
v_lshlrev_b32 v58, 16, v242
v_mfma_f32_16x16x32_bf16 v[20:23], v[108:111], v[84:87], v[20:23]
ds_read_b128 v[96:99], v8 offset:1984
v_and_b32 v59, 0xffff0000, v242
s_waitcnt lgkmcnt(8)
v_mfma_f32_16x16x32_bf16 v[16:19], v[144:147], v[80:83], v[16:19]
ds_read_b128 v[92:95], v9 offset:1920
v_and_b32 v63, 0xffff0000, v61
v_mfma_f32_16x16x32_bf16 v[20:23], v[112:115], v[80:83], v[20:23]
ds_read_b128 v[100:103], v8 offset:1920
v_lshlrev_b32 v62, 16, v61
s_waitcnt lgkmcnt(8)
v_mfma_f32_16x16x32_bf16 v[16:19], v[148:151], v[76:79], v[16:19]
ds_read_b128 v[88:91], v9 offset:1856
v_and_b32 v61, 0xffff0000, v60
v_mfma_f32_16x16x32_bf16 v[20:23], v[116:119], v[76:79], v[20:23]
ds_read_b128 v[104:107], v8 offset:1856
v_lshlrev_b32 v60, 16, v60
s_waitcnt lgkmcnt(8)
v_mfma_f32_16x16x32_bf16 v[16:19], v[152:155], v[72:75], v[16:19]
ds_read_b128 v[84:87], v9 offset:1792
v_mfma_f32_16x16x32_bf16 v[20:23], v[120:123], v[72:75], v[20:23]
ds_read_b128 v[108:111], v8 offset:1792
s_waitcnt lgkmcnt(8)
v_mfma_f32_16x16x32_bf16 v[16:19], v[156:159], v[68:71], v[16:19]
ds_read_b128 v[80:83], v9 offset:1728
v_mfma_f32_16x16x32_bf16 v[20:23], v[124:127], v[68:71], v[20:23]
ds_read_b128 v[112:115], v8 offset:1728
s_waitcnt lgkmcnt(8)
v_mfma_f32_16x16x32_bf16 v[16:19], v[96:99], v[64:67], v[16:19]
ds_read_b128 v[76:79], v9 offset:1664
v_mfma_f32_16x16x32_bf16 v[20:23], v[128:131], v[64:67], v[20:23]
ds_read_b128 v[116:119], v8 offset:1664
s_waitcnt lgkmcnt(8)
v_mfma_f32_16x16x32_bf16 v[16:19], v[100:103], v[92:95], v[16:19]
ds_read_b128 v[72:75], v9 offset:1600
v_mfma_f32_16x16x32_bf16 v[20:23], v[132:135], v[92:95], v[20:23]
ds_read_b128 v[120:123], v8 offset:1600
s_waitcnt lgkmcnt(8)
v_mfma_f32_16x16x32_bf16 v[16:19], v[104:107], v[88:91], v[16:19]
ds_read_b128 v[68:71], v9 offset:1536
v_mfma_f32_16x16x32_bf16 v[20:23], v[136:139], v[88:91], v[20:23]
ds_read_b128 v[124:127], v8 offset:1536
s_waitcnt lgkmcnt(8)
v_mfma_f32_16x16x32_bf16 v[16:19], v[108:111], v[84:87], v[16:19]
ds_read_b128 v[64:67], v9 offset:1472
v_mfma_f32_16x16x32_bf16 v[20:23], v[140:143], v[84:87], v[20:23]
ds_read_b128 v[128:131], v8 offset:1472
s_waitcnt lgkmcnt(8)
v_mfma_f32_16x16x32_bf16 v[16:19], v[112:115], v[80:83], v[16:19]
ds_read_b128 v[92:95], v9 offset:1408
v_mfma_f32_16x16x32_bf16 v[20:23], v[144:147], v[80:83], v[20:23]
ds_read_b128 v[132:135], v8 offset:1408
s_waitcnt lgkmcnt(8)
v_mfma_f32_16x16x32_bf16 v[16:19], v[116:119], v[76:79], v[16:19]
ds_read_b128 v[88:91], v9 offset:1344
v_mfma_f32_16x16x32_bf16 v[20:23], v[148:151], v[76:79], v[20:23]
ds_read_b128 v[136:139], v8 offset:1344
s_waitcnt lgkmcnt(8)
v_mfma_f32_16x16x32_bf16 v[16:19], v[120:123], v[72:75], v[16:19]
ds_read_b128 v[84:87], v9 offset:1280
v_mfma_f32_16x16x32_bf16 v[20:23], v[152:155], v[72:75], v[20:23]
ds_read_b128 v[140:143], v8 offset:1280
s_waitcnt lgkmcnt(8)
v_mfma_f32_16x16x32_bf16 v[16:19], v[124:127], v[68:71], v[16:19]
ds_read_b128 v[80:83], v9 offset:1216
v_mfma_f32_16x16x32_bf16 v[20:23], v[156:159], v[68:71], v[20:23]
ds_read_b128 v[144:147], v8 offset:1216
s_waitcnt lgkmcnt(8)
v_mfma_f32_16x16x32_bf16 v[16:19], v[128:131], v[64:67], v[16:19]
ds_read_b128 v[76:79], v9 offset:1152
v_mfma_f32_16x16x32_bf16 v[20:23], v[96:99], v[64:67], v[20:23]
ds_read_b128 v[148:151], v8 offset:1152
s_waitcnt lgkmcnt(8)
v_mfma_f32_16x16x32_bf16 v[16:19], v[132:135], v[92:95], v[16:19]
ds_read_b128 v[72:75], v9 offset:1088
v_mfma_f32_16x16x32_bf16 v[20:23], v[100:103], v[92:95], v[20:23]
ds_read_b128 v[152:155], v8 offset:1088
s_waitcnt lgkmcnt(8)
v_mfma_f32_16x16x32_bf16 v[16:19], v[136:139], v[88:91], v[16:19]
ds_read_b128 v[68:71], v9 offset:1024
v_mfma_f32_16x16x32_bf16 v[20:23], v[104:107], v[88:91], v[20:23]
ds_read_b128 v[156:159], v8 offset:1024
s_waitcnt lgkmcnt(8)
v_mfma_f32_16x16x32_bf16 v[16:19], v[140:143], v[84:87], v[16:19]
ds_read_b128 v[64:67], v9 offset:960
v_mfma_f32_16x16x32_bf16 v[20:23], v[108:111], v[84:87], v[20:23]
ds_read_b128 v[96:99], v8 offset:960
s_waitcnt lgkmcnt(8)
v_mfma_f32_16x16x32_bf16 v[16:19], v[144:147], v[80:83], v[16:19]
ds_read_b128 v[92:95], v9 offset:896
v_mfma_f32_16x16x32_bf16 v[20:23], v[112:115], v[80:83], v[20:23]
ds_read_b128 v[100:103], v8 offset:896
s_waitcnt lgkmcnt(8)
v_mfma_f32_16x16x32_bf16 v[16:19], v[148:151], v[76:79], v[16:19]
ds_read_b128 v[88:91], v9 offset:832
v_mfma_f32_16x16x32_bf16 v[20:23], v[116:119], v[76:79], v[20:23]
ds_read_b128 v[104:107], v8 offset:832
s_waitcnt lgkmcnt(8)
v_mfma_f32_16x16x32_bf16 v[16:19], v[152:155], v[72:75], v[16:19]
ds_read_b128 v[84:87], v9 offset:768
v_mfma_f32_16x16x32_bf16 v[20:23], v[120:123], v[72:75], v[20:23]
ds_read_b128 v[108:111], v8 offset:768
s_waitcnt lgkmcnt(8)
v_mfma_f32_16x16x32_bf16 v[16:19], v[156:159], v[68:71], v[16:19]
ds_read_b128 v[80:83], v9 offset:704
v_mfma_f32_16x16x32_bf16 v[20:23], v[124:127], v[68:71], v[20:23]
ds_read_b128 v[112:115], v8 offset:704
s_waitcnt lgkmcnt(8)
v_mfma_f32_16x16x32_bf16 v[16:19], v[96:99], v[64:67], v[16:19]
ds_read_b128 v[76:79], v9 offset:640
v_mfma_f32_16x16x32_bf16 v[20:23], v[128:131], v[64:67], v[20:23]
ds_read_b128 v[116:119], v8 offset:640
s_waitcnt lgkmcnt(8)
v_mfma_f32_16x16x32_bf16 v[16:19], v[100:103], v[92:95], v[16:19]
ds_read_b128 v[72:75], v9 offset:576
v_mfma_f32_16x16x32_bf16 v[20:23], v[132:135], v[92:95], v[20:23]
ds_read_b128 v[120:123], v8 offset:576
s_waitcnt lgkmcnt(8)
v_mfma_f32_16x16x32_bf16 v[16:19], v[104:107], v[88:91], v[16:19]
ds_read_b128 v[68:71], v9 offset:512
v_mfma_f32_16x16x32_bf16 v[20:23], v[136:139], v[88:91], v[20:23]
ds_read_b128 v[124:127], v8 offset:512
s_waitcnt lgkmcnt(8)
v_mfma_f32_16x16x32_bf16 v[16:19], v[108:111], v[84:87], v[16:19]
ds_read_b128 v[64:67], v9 offset:448
v_mfma_f32_16x16x32_bf16 v[20:23], v[140:143], v[84:87], v[20:23]
ds_read_b128 v[128:131], v8 offset:448
s_waitcnt lgkmcnt(8)
v_mfma_f32_16x16x32_bf16 v[16:19], v[112:115], v[80:83], v[16:19]
ds_read_b128 v[92:95], v9 offset:384
v_mfma_f32_16x16x32_bf16 v[20:23], v[144:147], v[80:83], v[20:23]
ds_read_b128 v[132:135], v8 offset:384
s_waitcnt lgkmcnt(8)
v_mfma_f32_16x16x32_bf16 v[16:19], v[116:119], v[76:79], v[16:19]
ds_read_b128 v[88:91], v9 offset:320
v_mfma_f32_16x16x32_bf16 v[20:23], v[148:151], v[76:79], v[20:23]
ds_read_b128 v[136:139], v8 offset:320
s_waitcnt lgkmcnt(8)
v_mfma_f32_16x16x32_bf16 v[16:19], v[120:123], v[72:75], v[16:19]
ds_read_b128 v[84:87], v9 offset:256
v_mfma_f32_16x16x32_bf16 v[20:23], v[152:155], v[72:75], v[20:23]
ds_read_b128 v[140:143], v8 offset:256
s_waitcnt lgkmcnt(8)
v_mfma_f32_16x16x32_bf16 v[16:19], v[124:127], v[68:71], v[16:19]
ds_read_b128 v[80:83], v9 offset:192
v_mfma_f32_16x16x32_bf16 v[20:23], v[156:159], v[68:71], v[20:23]
ds_read_b128 v[144:147], v8 offset:192
s_waitcnt lgkmcnt(8)
v_mfma_f32_16x16x32_bf16 v[16:19], v[128:131], v[64:67], v[16:19]
ds_read_b128 v[76:79], v9 offset:128
v_mfma_f32_16x16x32_bf16 v[20:23], v[96:99], v[64:67], v[20:23]
ds_read_b128 v[148:151], v8 offset:128
s_waitcnt lgkmcnt(8)
v_mfma_f32_16x16x32_bf16 v[16:19], v[132:135], v[92:95], v[16:19]
ds_read_b128 v[72:75], v9 offset:64
v_mfma_f32_16x16x32_bf16 v[20:23], v[100:103], v[92:95], v[20:23]
ds_read_b128 v[152:155], v8 offset:64
s_waitcnt lgkmcnt(8)
v_mfma_f32_16x16x32_bf16 v[16:19], v[136:139], v[88:91], v[16:19]
ds_read_b128 v[68:71], v9 offset:0
v_mfma_f32_16x16x32_bf16 v[20:23], v[104:107], v[88:91], v[20:23]
ds_read_b128 v[156:159], v8 offset:0
s_waitcnt lgkmcnt(8)
v_mfma_f32_16x16x32_bf16 v[16:19], v[140:143], v[84:87], v[16:19]
v_mfma_f32_16x16x32_bf16 v[20:23], v[108:111], v[84:87], v[20:23]
s_waitcnt lgkmcnt(6)
v_mfma_f32_16x16x32_bf16 v[16:19], v[144:147], v[80:83], v[16:19]
v_mfma_f32_16x16x32_bf16 v[20:23], v[112:115], v[80:83], v[20:23]
s_waitcnt lgkmcnt(4)
v_mfma_f32_16x16x32_bf16 v[16:19], v[148:151], v[76:79], v[16:19]
v_mfma_f32_16x16x32_bf16 v[20:23], v[116:119], v[76:79], v[20:23]
s_waitcnt lgkmcnt(2)
v_mfma_f32_16x16x32_bf16 v[16:19], v[152:155], v[72:75], v[16:19]
v_mfma_f32_16x16x32_bf16 v[20:23], v[120:123], v[72:75], v[20:23]
s_waitcnt lgkmcnt(0)
v_mfma_f32_16x16x32_bf16 v[16:19], v[156:159], v[68:71], v[16:19]
v_mfma_f32_16x16x32_bf16 v[20:23], v[124:127], v[68:71], v[20:23]
s_branch P2_EPI
P2_Q:
ds_read_b128 v[64:67], v9 offset:3008
ds_read_b128 v[96:99], v8 offset:4032
ds_read_b128 v[92:95], v9 offset:2944
ds_read_b128 v[100:103], v8 offset:3968
ds_read_b128 v[88:91], v9 offset:2880
ds_read_b128 v[104:107], v8 offset:3904
ds_read_b128 v[84:87], v9 offset:2816
ds_read_b128 v[108:111], v8 offset:3840
ds_read_b128 v[80:83], v9 offset:2752
ds_read_b128 v[112:115], v8 offset:3776
s_waitcnt lgkmcnt(8)
v_mfma_f32_16x16x32_bf16 v[16:19], v[96:99], v[64:67], 0
ds_read_b128 v[76:79], v9 offset:2688
ds_read_b128 v[116:119], v8 offset:3712
s_waitcnt lgkmcnt(8)
v_mfma_f32_16x16x32_bf16 v[16:19], v[100:103], v[92:95], v[16:19]
ds_read_b128 v[72:75], v9 offset:2624
ds_read_b128 v[120:123], v8 offset:3648
s_waitcnt lgkmcnt(8)
v_mfma_f32_16x16x32_bf16 v[16:19], v[104:107], v[88:91], v[16:19]
ds_read_b128 v[68:71], v9 offset:2560
v_lshlrev_b32 v236, 16, v32
ds_read_b128 v[124:127], v8 offset:3584
s_waitcnt lgkmcnt(8)
v_mfma_f32_16x16x32_bf16 v[16:19], v[108:111], v[84:87], v[16:19]
ds_read_b128 v[64:67], v9 offset:2496
v_and_b32 v237, 0xffff0000, v32
ds_read_b128 v[128:131], v8 offset:3520
s_waitcnt lgkmcnt(8)
v_mfma_f32_16x16x32_bf16 v[16:19], v[112:115], v[80:83], v[16:19]
ds_read_b128 v[92:95], v9 offset:2432
v_lshlrev_b32 v238, 16, v33
ds_read_b128 v[132:135], v8 offset:3456
s_waitcnt lgkmcnt(8)
v_mfma_f32_16x16x32_bf16 v[16:19], v[116:119], v[76:79], v[16:19]
ds_read_b128 v[88:91], v9 offset:2368
v_and_b32 v239, 0xffff0000, v33
ds_read_b128 v[136:139], v8 offset:3392
s_waitcnt lgkmcnt(8)
v_mfma_f32_16x16x32_bf16 v[16:19], v[120:123], v[72:75], v[16:19]
ds_read_b128 v[84:87], v9 offset:2304
v_mul_f32 v236, v236, v7
ds_read_b128 v[140:143], v8 offset:3328
s_waitcnt lgkmcnt(8)
v_mfma_f32_16x16x32_bf16 v[16:19], v[124:127], v[68:71], v[16:19]
ds_read_b128 v[80:83], v9 offset:2240
v_mul_f32 v237, v237, v7
ds_read_b128 v[144:147], v8 offset:3264
s_waitcnt lgkmcnt(8)
v_mfma_f32_16x16x32_bf16 v[16:19], v[128:131], v[64:67], v[16:19]
ds_read_b128 v[76:79], v9 offset:2176
v_mul_f32 v238, v238, v7
v_mfma_f32_16x16x32_bf16 v[20:23], v[96:99], v[64:67], 0
ds_read_b128 v[148:151], v8 offset:3200
v_mul_f32 v239, v239, v7
s_waitcnt lgkmcnt(8)
v_mfma_f32_16x16x32_bf16 v[16:19], v[132:135], v[92:95], v[16:19]
ds_read_b128 v[72:75], v9 offset:2112
v_cvt_pk_bf16_f32 v236, v236, v237
v_mfma_f32_16x16x32_bf16 v[20:23], v[100:103], v[92:95], v[20:23]
ds_read_b128 v[152:155], v8 offset:3136
v_cvt_pk_bf16_f32 v238, v238, v239
s_waitcnt lgkmcnt(8)
v_mfma_f32_16x16x32_bf16 v[16:19], v[136:139], v[88:91], v[16:19]
ds_read_b128 v[68:71], v9 offset:2048
v_lshlrev_b32 v32, 16, v236
v_mfma_f32_16x16x32_bf16 v[20:23], v[104:107], v[88:91], v[20:23]
ds_read_b128 v[156:159], v8 offset:3072
v_and_b32 v33, 0xffff0000, v236
s_waitcnt lgkmcnt(8)
v_mfma_f32_16x16x32_bf16 v[16:19], v[140:143], v[84:87], v[16:19]
ds_read_b128 v[64:67], v9 offset:1984
v_lshlrev_b32 v34, 16, v238
v_mfma_f32_16x16x32_bf16 v[20:23], v[108:111], v[84:87], v[20:23]
ds_read_b128 v[160:163], v8 offset:3008
v_and_b32 v35, 0xffff0000, v238
s_waitcnt lgkmcnt(8)
v_mfma_f32_16x16x32_bf16 v[16:19], v[144:147], v[80:83], v[16:19]
ds_read_b128 v[92:95], v9 offset:1920
v_and_b32 v39, 0xffff0000, v37
v_mfma_f32_16x16x32_bf16 v[20:23], v[112:115], v[80:83], v[20:23]
ds_read_b128 v[164:167], v8 offset:2944
v_lshlrev_b32 v38, 16, v37
s_waitcnt lgkmcnt(8)
v_mfma_f32_16x16x32_bf16 v[16:19], v[148:151], v[76:79], v[16:19]
ds_read_b128 v[88:91], v9 offset:1856
v_and_b32 v37, 0xffff0000, v36
v_mfma_f32_16x16x32_bf16 v[20:23], v[116:119], v[76:79], v[20:23]
ds_read_b128 v[168:171], v8 offset:2880
v_lshlrev_b32 v36, 16, v36
s_waitcnt lgkmcnt(8)
v_mfma_f32_16x16x32_bf16 v[16:19], v[152:155], v[72:75], v[16:19]
ds_read_b128 v[84:87], v9 offset:1792
v_lshlrev_b32 v240, 16, v40
v_mfma_f32_16x16x32_bf16 v[20:23], v[120:123], v[72:75], v[20:23]
ds_read_b128 v[172:175], v8 offset:2816
v_and_b32 v241, 0xffff0000, v40
s_waitcnt lgkmcnt(8)
v_mfma_f32_16x16x32_bf16 v[16:19], v[156:159], v[68:71], v[16:19]
ds_read_b128 v[80:83], v9 offset:1728
v_lshlrev_b32 v242, 16, v41
v_mfma_f32_16x16x32_bf16 v[20:23], v[124:127], v[68:71], v[20:23]
ds_read_b128 v[176:179], v8 offset:2752
v_and_b32 v243, 0xffff0000, v41
s_waitcnt lgkmcnt(8)
v_mfma_f32_16x16x32_bf16 v[16:19], v[160:163], v[64:67], v[16:19]
ds_read_b128 v[76:79], v9 offset:1664
v_mul_f32 v240, v240, v7
v_mfma_f32_16x16x32_bf16 v[20:23], v[128:131], v[64:67], v[20:23]
ds_read_b128 v[180:183], v8 offset:2688
v_mul_f32 v241, v241, v7
v_mfma_f32_16x16x32_bf16 v[24:27], v[96:99], v[64:67], 0
v_mul_f32 v242, v242, v7
s_waitcnt lgkmcnt(8)
v_mfma_f32_16x16x32_bf16 v[16:19], v[164:167], v[92:95], v[16:19]
ds_read_b128 v[72:75], v9 offset:1600
v_mul_f32 v243, v243, v7
v_mfma_f32_16x16x32_bf16 v[20:23], v[132:135], v[92:95], v[20:23]
ds_read_b128 v[184:187], v8 offset:2624
v_cvt_pk_bf16_f32 v240, v240, v241
v_mfma_f32_16x16x32_bf16 v[24:27], v[100:103], v[92:95], v[24:27]
v_cvt_pk_bf16_f32 v242, v242, v243
s_waitcnt lgkmcnt(8)
v_mfma_f32_16x16x32_bf16 v[16:19], v[168:171], v[88:91], v[16:19]
ds_read_b128 v[68:71], v9 offset:1536
v_lshlrev_b32 v40, 16, v240
v_mfma_f32_16x16x32_bf16 v[20:23], v[136:139], v[88:91], v[20:23]
ds_read_b128 v[188:191], v8 offset:2560
v_and_b32 v41, 0xffff0000, v240
v_mfma_f32_16x16x32_bf16 v[24:27], v[104:107], v[88:91], v[24:27]
v_lshlrev_b32 v42, 16, v242
s_waitcnt lgkmcnt(8)
v_mfma_f32_16x16x32_bf16 v[16:19], v[172:175], v[84:87], v[16:19]
ds_read_b128 v[64:67], v9 offset:1472
v_and_b32 v43, 0xffff0000, v242
v_mfma_f32_16x16x32_bf16 v[20:23], v[140:143], v[84:87], v[20:23]
ds_read_b128 v[192:195], v8 offset:2496
v_and_b32 v47, 0xffff0000, v45
v_mfma_f32_16x16x32_bf16 v[24:27], v[108:111], v[84:87], v[24:27]
v_lshlrev_b32 v46, 16, v45
s_waitcnt lgkmcnt(8)
v_mfma_f32_16x16x32_bf16 v[16:19], v[176:179], v[80:83], v[16:19]
ds_read_b128 v[92:95], v9 offset:1408
v_and_b32 v45, 0xffff0000, v44
v_mfma_f32_16x16x32_bf16 v[20:23], v[144:147], v[80:83], v[20:23]
ds_read_b128 v[196:199], v8 offset:2432
v_lshlrev_b32 v44, 16, v44
v_mfma_f32_16x16x32_bf16 v[24:27], v[112:115], v[80:83], v[24:27]
v_lshlrev_b32 v236, 16, v48
s_waitcnt lgkmcnt(8)
v_mfma_f32_16x16x32_bf16 v[16:19], v[180:183], v[76:79], v[16:19]
ds_read_b128 v[88:91], v9 offset:1344
v_and_b32 v237, 0xffff0000, v48
v_mfma_f32_16x16x32_bf16 v[20:23], v[148:151], v[76:79], v[20:23]
ds_read_b128 v[200:203], v8 offset:2368
v_lshlrev_b32 v238, 16, v49
v_mfma_f32_16x16x32_bf16 v[24:27], v[116:119], v[76:79], v[24:27]
v_and_b32 v239, 0xffff0000, v49
s_waitcnt lgkmcnt(8)
v_mfma_f32_16x16x32_bf16 v[16:19], v[184:187], v[72:75], v[16:19]
ds_read_b128 v[84:87], v9 offset:1280
v_mul_f32 v236, v236, v7
v_mfma_f32_16x16x32_bf16 v[20:23], v[152:155], v[72:75], v[20:23]
ds_read_b128 v[204:207], v8 offset:2304
v_mul_f32 v237, v237, v7
v_mfma_f32_16x16x32_bf16 v[24:27], v[120:123], v[72:75], v[24:27]
v_mul_f32 v238, v238, v7
s_waitcnt lgkmcnt(8)
v_mfma_f32_16x16x32_bf16 v[16:19], v[188:191], v[68:71], v[16:19]
ds_read_b128 v[80:83], v9 offset:1216
v_mul_f32 v239, v239, v7
v_mfma_f32_16x16x32_bf16 v[20:23], v[156:159], v[68:71], v[20:23]
ds_read_b128 v[208:211], v8 offset:2240
v_cvt_pk_bf16_f32 v236, v236, v237
v_mfma_f32_16x16x32_bf16 v[24:27], v[124:127], v[68:71], v[24:27]
v_cvt_pk_bf16_f32 v238, v238, v239
s_waitcnt lgkmcnt(8)
v_mfma_f32_16x16x32_bf16 v[16:19], v[192:195], v[64:67], v[16:19]
ds_read_b128 v[76:79], v9 offset:1152
v_lshlrev_b32 v48, 16, v236
v_mfma_f32_16x16x32_bf16 v[20:23], v[160:163], v[64:67], v[20:23]
ds_read_b128 v[212:215], v8 offset:2176
v_and_b32 v49, 0xffff0000, v236
v_mfma_f32_16x16x32_bf16 v[24:27], v[128:131], v[64:67], v[24:27]
v_lshlrev_b32 v50, 16, v238
v_mfma_f32_16x16x32_bf16 v[28:31], v[96:99], v[64:67], 0
v_and_b32 v51, 0xffff0000, v238
s_waitcnt lgkmcnt(8)
v_mfma_f32_16x16x32_bf16 v[16:19], v[196:199], v[92:95], v[16:19]
ds_read_b128 v[72:75], v9 offset:1088
v_and_b32 v55, 0xffff0000, v53
v_mfma_f32_16x16x32_bf16 v[20:23], v[164:167], v[92:95], v[20:23]
ds_read_b128 v[216:219], v8 offset:2112
v_lshlrev_b32 v54, 16, v53
v_mfma_f32_16x16x32_bf16 v[24:27], v[132:135], v[92:95], v[24:27]
v_and_b32 v53, 0xffff0000, v52
v_mfma_f32_16x16x32_bf16 v[28:31], v[100:103], v[92:95], v[28:31]
v_lshlrev_b32 v52, 16, v52
s_waitcnt lgkmcnt(8)
v_mfma_f32_16x16x32_bf16 v[16:19], v[200:203], v[88:91], v[16:19]
ds_read_b128 v[68:71], v9 offset:1024
v_lshlrev_b32 v240, 16, v56
v_mfma_f32_16x16x32_bf16 v[20:23], v[168:171], v[88:91], v[20:23]
ds_read_b128 v[220:223], v8 offset:2048
v_and_b32 v241, 0xffff0000, v56
v_mfma_f32_16x16x32_bf16 v[24:27], v[136:139], v[88:91], v[24:27]
v_lshlrev_b32 v242, 16, v57
v_mfma_f32_16x16x32_bf16 v[28:31], v[104:107], v[88:91], v[28:31]
v_and_b32 v243, 0xffff0000, v57
s_waitcnt lgkmcnt(8)
v_mfma_f32_16x16x32_bf16 v[16:19], v[204:207], v[84:87], v[16:19]
ds_read_b128 v[64:67], v9 offset:960
v_mul_f32 v240, v240, v7
v_mfma_f32_16x16x32_bf16 v[20:23], v[172:175], v[84:87], v[20:23]
ds_read_b128 v[96:99], v8 offset:1984
v_mul_f32 v241, v241, v7
v_mfma_f32_16x16x32_bf16 v[24:27], v[140:143], v[84:87], v[24:27]
v_mul_f32 v242, v242, v7
v_mfma_f32_16x16x32_bf16 v[28:31], v[108:111], v[84:87], v[28:31]
v_mul_f32 v243, v243, v7
s_waitcnt lgkmcnt(8)
v_mfma_f32_16x16x32_bf16 v[16:19], v[208:211], v[80:83], v[16:19]
ds_read_b128 v[92:95], v9 offset:896
v_cvt_pk_bf16_f32 v240, v240, v241
v_mfma_f32_16x16x32_bf16 v[20:23], v[176:179], v[80:83], v[20:23]
ds_read_b128 v[100:103], v8 offset:1920
v_cvt_pk_bf16_f32 v242, v242, v243
v_mfma_f32_16x16x32_bf16 v[24:27], v[144:147], v[80:83], v[24:27]
v_lshlrev_b32 v56, 16, v240
v_mfma_f32_16x16x32_bf16 v[28:31], v[112:115], v[80:83], v[28:31]
v_and_b32 v57, 0xffff0000, v240
s_waitcnt lgkmcnt(8)
v_mfma_f32_16x16x32_bf16 v[16:19], v[212:215], v[76:79], v[16:19]
ds_read_b128 v[88:91], v9 offset:832
v_lshlrev_b32 v58, 16, v242
v_mfma_f32_16x16x32_bf16 v[20:23], v[180:183], v[76:79], v[20:23]
ds_read_b128 v[104:107], v8 offset:1856
v_and_b32 v59, 0xffff0000, v242
v_mfma_f32_16x16x32_bf16 v[24:27], v[148:151], v[76:79], v[24:27]
v_and_b32 v63, 0xffff0000, v61
v_mfma_f32_16x16x32_bf16 v[28:31], v[116:119], v[76:79], v[28:31]
v_lshlrev_b32 v62, 16, v61
s_waitcnt lgkmcnt(8)
v_mfma_f32_16x16x32_bf16 v[16:19], v[216:219], v[72:75], v[16:19]
ds_read_b128 v[84:87], v9 offset:768
v_and_b32 v61, 0xffff0000, v60
v_mfma_f32_16x16x32_bf16 v[20:23], v[184:187], v[72:75], v[20:23]
ds_read_b128 v[108:111], v8 offset:1792
v_lshlrev_b32 v60, 16, v60
v_mfma_f32_16x16x32_bf16 v[24:27], v[152:155], v[72:75], v[24:27]
v_mfma_f32_16x16x32_bf16 v[28:31], v[120:123], v[72:75], v[28:31]
s_waitcnt lgkmcnt(8)
v_mfma_f32_16x16x32_bf16 v[16:19], v[220:223], v[68:71], v[16:19]
ds_read_b128 v[80:83], v9 offset:704
v_mfma_f32_16x16x32_bf16 v[20:23], v[188:191], v[68:71], v[20:23]
ds_read_b128 v[112:115], v8 offset:1728
v_mfma_f32_16x16x32_bf16 v[24:27], v[156:159], v[68:71], v[24:27]
v_mfma_f32_16x16x32_bf16 v[28:31], v[124:127], v[68:71], v[28:31]
s_waitcnt lgkmcnt(8)
v_mfma_f32_16x16x32_bf16 v[16:19], v[96:99], v[64:67], v[16:19]
ds_read_b128 v[76:79], v9 offset:640
v_mfma_f32_16x16x32_bf16 v[20:23], v[192:195], v[64:67], v[20:23]
ds_read_b128 v[116:119], v8 offset:1664
v_mfma_f32_16x16x32_bf16 v[24:27], v[160:163], v[64:67], v[24:27]
v_mfma_f32_16x16x32_bf16 v[28:31], v[128:131], v[64:67], v[28:31]
s_waitcnt lgkmcnt(8)
v_mfma_f32_16x16x32_bf16 v[16:19], v[100:103], v[92:95], v[16:19]
ds_read_b128 v[72:75], v9 offset:576
v_mfma_f32_16x16x32_bf16 v[20:23], v[196:199], v[92:95], v[20:23]
ds_read_b128 v[120:123], v8 offset:1600
v_mfma_f32_16x16x32_bf16 v[24:27], v[164:167], v[92:95], v[24:27]
v_mfma_f32_16x16x32_bf16 v[28:31], v[132:135], v[92:95], v[28:31]
s_waitcnt lgkmcnt(8)
v_mfma_f32_16x16x32_bf16 v[16:19], v[104:107], v[88:91], v[16:19]
ds_read_b128 v[68:71], v9 offset:512
v_mfma_f32_16x16x32_bf16 v[20:23], v[200:203], v[88:91], v[20:23]
ds_read_b128 v[124:127], v8 offset:1536
v_mfma_f32_16x16x32_bf16 v[24:27], v[168:171], v[88:91], v[24:27]
v_mfma_f32_16x16x32_bf16 v[28:31], v[136:139], v[88:91], v[28:31]
s_waitcnt lgkmcnt(8)
v_mfma_f32_16x16x32_bf16 v[16:19], v[108:111], v[84:87], v[16:19]
ds_read_b128 v[64:67], v9 offset:448
v_mfma_f32_16x16x32_bf16 v[20:23], v[204:207], v[84:87], v[20:23]
ds_read_b128 v[128:131], v8 offset:1472
v_mfma_f32_16x16x32_bf16 v[24:27], v[172:175], v[84:87], v[24:27]
v_mfma_f32_16x16x32_bf16 v[28:31], v[140:143], v[84:87], v[28:31]
s_waitcnt lgkmcnt(8)
v_mfma_f32_16x16x32_bf16 v[16:19], v[112:115], v[80:83], v[16:19]
ds_read_b128 v[92:95], v9 offset:384
v_mfma_f32_16x16x32_bf16 v[20:23], v[208:211], v[80:83], v[20:23]
ds_read_b128 v[132:135], v8 offset:1408
v_mfma_f32_16x16x32_bf16 v[24:27], v[176:179], v[80:83], v[24:27]
v_mfma_f32_16x16x32_bf16 v[28:31], v[144:147], v[80:83], v[28:31]
s_waitcnt lgkmcnt(8)
v_mfma_f32_16x16x32_bf16 v[16:19], v[116:119], v[76:79], v[16:19]
ds_read_b128 v[88:91], v9 offset:320
v_mfma_f32_16x16x32_bf16 v[20:23], v[212:215], v[76:79], v[20:23]
ds_read_b128 v[136:139], v8 offset:1344
v_mfma_f32_16x16x32_bf16 v[24:27], v[180:183], v[76:79], v[24:27]
v_mfma_f32_16x16x32_bf16 v[28:31], v[148:151], v[76:79], v[28:31]
s_waitcnt lgkmcnt(8)
v_mfma_f32_16x16x32_bf16 v[16:19], v[120:123], v[72:75], v[16:19]
ds_read_b128 v[84:87], v9 offset:256
v_mfma_f32_16x16x32_bf16 v[20:23], v[216:219], v[72:75], v[20:23]
ds_read_b128 v[140:143], v8 offset:1280
v_mfma_f32_16x16x32_bf16 v[24:27], v[184:187], v[72:75], v[24:27]
v_mfma_f32_16x16x32_bf16 v[28:31], v[152:155], v[72:75], v[28:31]
s_waitcnt lgkmcnt(8)
v_mfma_f32_16x16x32_bf16 v[16:19], v[124:127], v[68:71], v[16:19]
ds_read_b128 v[80:83], v9 offset:192
v_mfma_f32_16x16x32_bf16 v[20:23], v[220:223], v[68:71], v[20:23]
ds_read_b128 v[144:147], v8 offset:1216
v_mfma_f32_16x16x32_bf16 v[24:27], v[188:191], v[68:71], v[24:27]
v_mfma_f32_16x16x32_bf16 v[28:31], v[156:159], v[68:71], v[28:31]
s_waitcnt lgkmcnt(8)
v_mfma_f32_16x16x32_bf16 v[16:19], v[128:131], v[64:67], v[16:19]
ds_read_b128 v[76:79], v9 offset:128
v_mfma_f32_16x16x32_bf16 v[20:23], v[96:99], v[64:67], v[20:23]
ds_read_b128 v[148:151], v8 offset:1152
v_mfma_f32_16x16x32_bf16 v[24:27], v[192:195], v[64:67], v[24:27]
v_mfma_f32_16x16x32_bf16 v[28:31], v[160:163], v[64:67], v[28:31]
s_waitcnt lgkmcnt(8)
v_mfma_f32_16x16x32_bf16 v[16:19], v[132:135], v[92:95], v[16:19]
ds_read_b128 v[72:75], v9 offset:64
v_mfma_f32_16x16x32_bf16 v[20:23], v[100:103], v[92:95], v[20:23]
ds_read_b128 v[152:155], v8 offset:1088
v_mfma_f32_16x16x32_bf16 v[24:27], v[196:199], v[92:95], v[24:27]
v_mfma_f32_16x16x32_bf16 v[28:31], v[164:167], v[92:95], v[28:31]
s_waitcnt lgkmcnt(8)
v_mfma_f32_16x16x32_bf16 v[16:19], v[136:139], v[88:91], v[16:19]
ds_read_b128 v[68:71], v9 offset:0
v_mfma_f32_16x16x32_bf16 v[20:23], v[104:107], v[88:91], v[20:23]
ds_read_b128 v[156:159], v8 offset:1024
v_mfma_f32_16x16x32_bf16 v[24:27], v[200:203], v[88:91], v[24:27]
v_mfma_f32_16x16x32_bf16 v[28:31], v[168:171], v[88:91], v[28:31]
s_waitcnt lgkmcnt(8)
v_mfma_f32_16x16x32_bf16 v[16:19], v[140:143], v[84:87], v[16:19]
v_mfma_f32_16x16x32_bf16 v[20:23], v[108:111], v[84:87], v[20:23]
v_mfma_f32_16x16x32_bf16 v[24:27], v[204:207], v[84:87], v[24:27]
v_mfma_f32_16x16x32_bf16 v[28:31], v[172:175], v[84:87], v[28:31]
s_waitcnt lgkmcnt(6)
v_mfma_f32_16x16x32_bf16 v[16:19], v[144:147], v[80:83], v[16:19]
v_mfma_f32_16x16x32_bf16 v[20:23], v[112:115], v[80:83], v[20:23]
v_mfma_f32_16x16x32_bf16 v[24:27], v[208:211], v[80:83], v[24:27]
v_mfma_f32_16x16x32_bf16 v[28:31], v[176:179], v[80:83], v[28:31]
s_waitcnt lgkmcnt(4)
v_mfma_f32_16x16x32_bf16 v[16:19], v[148:151], v[76:79], v[16:19]
v_mfma_f32_16x16x32_bf16 v[20:23], v[116:119], v[76:79], v[20:23]
v_mfma_f32_16x16x32_bf16 v[24:27], v[212:215], v[76:79], v[24:27]
v_mfma_f32_16x16x32_bf16 v[28:31], v[180:183], v[76:79], v[28:31]
s_waitcnt lgkmcnt(2)
v_mfma_f32_16x16x32_bf16 v[16:19], v[152:155], v[72:75], v[16:19]
v_mfma_f32_16x16x32_bf16 v[20:23], v[120:123], v[72:75], v[20:23]
v_mfma_f32_16x16x32_bf16 v[24:27], v[216:219], v[72:75], v[24:27]
v_mfma_f32_16x16x32_bf16 v[28:31], v[184:187], v[72:75], v[28:31]
s_waitcnt lgkmcnt(0)
v_mfma_f32_16x16x32_bf16 v[16:19], v[156:159], v[68:71], v[16:19]
v_mfma_f32_16x16x32_bf16 v[20:23], v[124:127], v[68:71], v[20:23]
v_mfma_f32_16x16x32_bf16 v[24:27], v[220:223], v[68:71], v[24:27]
v_mfma_f32_16x16x32_bf16 v[28:31], v[188:191], v[68:71], v[28:31]
P2_EPI:
s_barrier
s_nop 4
v_cvt_pk_bf16_f32 v10, v16, v17
v_cvt_pk_bf16_f32 v11, v18, v19
v_lshlrev_b32 v16, 16, v10
v_and_b32 v17, 0xffff0000, v10
v_lshlrev_b32 v18, 16, v11
v_and_b32 v19, 0xffff0000, v11
v_pk_add_f32 v[16:17], v[16:17], v[32:33]
v_pk_add_f32 v[18:19], v[18:19], v[34:35]
v_cvt_pk_bf16_f32 v10, v16, v17
v_cvt_pk_bf16_f32 v11, v18, v19
v_lshlrev_b32 v16, 16, v10
v_and_b32 v17, 0xffff0000, v10
v_lshlrev_b32 v18, 16, v11
v_and_b32 v19, 0xffff0000, v11
v_pk_add_f32 v[16:17], v[16:17], v[36:37]
v_pk_add_f32 v[18:19], v[18:19], v[38:39]
v_cvt_pk_bf16_f32 v16, v16, v17
v_cvt_pk_bf16_f32 v17, v18, v19
buffer_store_dwordx2 v[16:17], v6, s[20:23], s44 offen sc1
v_cvt_pk_bf16_f32 v12, v20, v21
v_cvt_pk_bf16_f32 v13, v22, v23
v_lshlrev_b32 v20, 16, v12
v_and_b32 v21, 0xffff0000, v12
v_lshlrev_b32 v22, 16, v13
v_and_b32 v23, 0xffff0000, v13
v_pk_add_f32 v[20:21], v[20:21], v[40:41]
v_pk_add_f32 v[22:23], v[22:23], v[42:43]
v_cvt_pk_bf16_f32 v12, v20, v21
v_cvt_pk_bf16_f32 v13, v22, v23
v_lshlrev_b32 v20, 16, v12
v_and_b32 v21, 0xffff0000, v12
v_lshlrev_b32 v22, 16, v13
v_and_b32 v23, 0xffff0000, v13
v_pk_add_f32 v[20:21], v[20:21], v[44:45]
v_pk_add_f32 v[22:23], v[22:23], v[46:47]
v_cvt_pk_bf16_f32 v20, v20, v21
v_cvt_pk_bf16_f32 v21, v22, v23
buffer_store_dwordx2 v[20:21], v6, s[20:23], s45 offen sc1
v_cvt_pk_bf16_f32 v10, v24, v25
v_cvt_pk_bf16_f32 v11, v26, v27
v_lshlrev_b32 v24, 16, v10
v_and_b32 v25, 0xffff0000, v10
v_lshlrev_b32 v26, 16, v11
v_and_b32 v27, 0xffff0000, v11
v_pk_add_f32 v[24:25], v[24:25], v[48:49]
v_pk_add_f32 v[26:27], v[26:27], v[50:51]
v_cvt_pk_bf16_f32 v10, v24, v25
v_cvt_pk_bf16_f32 v11, v26, v27
v_lshlrev_b32 v24, 16, v10
v_and_b32 v25, 0xffff0000, v10
v_lshlrev_b32 v26, 16, v11
v_and_b32 v27, 0xffff0000, v11
v_pk_add_f32 v[24:25], v[24:25], v[52:53]
v_pk_add_f32 v[26:27], v[26:27], v[54:55]
v_cvt_pk_bf16_f32 v24, v24, v25
v_cvt_pk_bf16_f32 v25, v26, v27
buffer_store_dwordx2 v[24:25], v6, s[20:23], s46 offen sc1
v_cvt_pk_bf16_f32 v12, v28, v29
v_cvt_pk_bf16_f32 v13, v30, v31
v_lshlrev_b32 v28, 16, v12
v_and_b32 v29, 0xffff0000, v12
v_lshlrev_b32 v30, 16, v13
v_and_b32 v31, 0xffff0000, v13
v_pk_add_f32 v[28:29], v[28:29], v[56:57]
v_pk_add_f32 v[30:31], v[30:31], v[58:59]
v_cvt_pk_bf16_f32 v12, v28, v29
v_cvt_pk_bf16_f32 v13, v30, v31
v_lshlrev_b32 v28, 16, v12
v_and_b32 v29, 0xffff0000, v12
v_lshlrev_b32 v30, 16, v13
v_and_b32 v31, 0xffff0000, v13
v_pk_add_f32 v[28:29], v[28:29], v[60:61]
v_pk_add_f32 v[30:31], v[30:31], v[62:63]
v_cvt_pk_bf16_f32 v28, v28, v29
v_cvt_pk_bf16_f32 v29, v30, v31
buffer_store_dwordx2 v[28:29], v6, s[20:23], s47 offen sc1
s_barrier
s_branch M_G1C
M_HELP:
s_and_b32 s32, s30, 3
s_add_u32 s16, s4, 6815744
s_addc_u32 s17, s5, 0
s_mov_b32 s18, 7340032
s_mov_b32 s19, 0x20000
v_mov_b32 v244, -1
v_mov_b32 v245, -1
v_mov_b32 v246, -1
v_mov_b32 v247, -1
v_lshlrev_b32 v248, 4, v1
s_and_b32 s28, s2, 7
s_lshr_b32 s29, s2, 3
s_lshr_b32 s34, s28, 2
s_lshl_b32 s34, s34, 3
s_lshr_b32 s35, s29, 2
s_add_u32 s34, s34, s35
s_and_b32 s28, s28, 3
s_lshl_b32 s28, s28, 2
s_and_b32 s29, s29, 3
s_add_u32 s28, s28, s29
s_lshl_b32 s34, s34, 3
s_mul_i32 s28, s28, 3584
s_mov_b32 s35, s32
s_add_u32 s36, s34, s35
s_mul_i32 s36, s36, 57344
s_add_u32 s36, s36, s28
buffer_store_dwordx4 v[244:247], v248, s[16:19], s36 offen sc1
buffer_store_dwordx4 v[244:247], v248, s[16:19], s36 offen offset:1024 sc1
buffer_store_dwordx4 v[244:247], v248, s[16:19], s36 offen offset:2048 sc1
s_mov_b32 s38, -1
s_mov_b32 s39, 0
s_mov_b64 exec, s[38:39]
buffer_store_dwordx4 v[244:247], v248, s[16:19], s36 offen offset:3072 sc1
s_mov_b64 exec, -1
s_add_u32 s35, s32, 4
s_add_u32 s36, s34, s35
s_mul_i32 s36, s36, 57344
s_add_u32 s36, s36, s28
buffer_store_dwordx4 v[244:247], v248, s[16:19], s36 offen sc1
buffer_store_dwordx4 v[244:247], v248, s[16:19], s36 offen offset:1024 sc1
buffer_store_dwordx4 v[244:247], v248, s[16:19], s36 offen offset:2048 sc1
s_mov_b32 s38, -1
s_mov_b32 s39, 0
s_mov_b64 exec, s[38:39]
buffer_store_dwordx4 v[244:247], v248, s[16:19], s36 offen offset:3072 sc1
s_mov_b64 exec, -1
s_cmp_lg_u32 s30, 4
s_cbranch_scc1 FC_A
v_lshlrev_b32 v16, 6, v1
s_mov_b32 s28, 0
s_mov_b32 s29, 0
buffer_load_dword v17, v16, s[8:11], s29 offen sc1
s_mov_b32 s29, 4096
buffer_load_dword v18, v16, s[8:11], s29 offen sc1
s_mov_b32 s29, 8192
buffer_load_dword v19, v16, s[8:11], s29 offen sc1
s_mov_b32 s29, 12288
buffer_load_dword v20, v16, s[8:11], s29 offen sc1
s_sleep 2
s_mov_b32 s29, 0
buffer_load_dword v21, v16, s[8:11], s29 offen sc1
s_mov_b32 s29, 4096
buffer_load_dword v22, v16, s[8:11], s29 offen sc1
s_mov_b32 s29, 8192
buffer_load_dword v23, v16, s[8:11], s29 offen sc1
s_mov_b32 s29, 12288
buffer_load_dword v24, v16, s[8:11], s29 offen sc1
s_sleep 2
s_mov_b32 s29, 0
buffer_load_dword v25, v16, s[8:11], s29 offen sc1
s_mov_b32 s29, 4096
buffer_load_dword v26, v16, s[8:11], s29 offen sc1
s_mov_b32 s29, 8192
buffer_load_dword v27, v16, s[8:11], s29 offen sc1
s_mov_b32 s29, 12288
buffer_load_dword v28, v16, s[8:11], s29 offen sc1
POLL_S2A:
s_waitcnt vmcnt(8)
v_xor_b32 v17, s3, v17
v_xor_b32 v18, s3, v18
v_xor_b32 v19, s3, v19
v_xor_b32 v20, s3, v20
v_or_b32 v17, v17, v18
v_or_b32 v17, v17, v19
v_or_b32 v17, v17, v20
v_cmp_ne_u32 vcc, 0, v17
s_nop 1
s_cbranch_vccz POLLD_S2A
s_mov_b32 s29, 0
buffer_load_dword v17, v16, s[8:11], s29 offen sc1
s_mov_b32 s29, 4096
buffer_load_dword v18, v16, s[8:11], s29 offen sc1
s_mov_b32 s29, 8192
buffer_load_dword v19, v16, s[8:11], s29 offen sc1
s_mov_b32 s29, 12288
buffer_load_dword v20, v16, s[8:11], s29 offen sc1
s_waitcnt vmcnt(8)
v_xor_b32 v21, s3, v21
v_xor_b32 v22, s3, v22
v_xor_b32 v23, s3, v23
v_xor_b32 v24, s3, v24
v_or_b32 v21, v21, v22
v_or_b32 v21, v21, v23
v_or_b32 v21, v21, v24
v_cmp_ne_u32 vcc, 0, v21
s_nop 1
s_cbranch_vccz POLLD_S2A
s_mov_b32 s29, 0
buffer_load_dword v21, v16, s[8:11], s29 offen sc1
s_mov_b32 s29, 4096
buffer_load_dword v22, v16, s[8:11], s29 offen sc1
s_mov_b32 s29, 8192
buffer_load_dword v23, v16, s[8:11], s29 offen sc1
s_mov_b32 s29, 12288
buffer_load_dword v24, v16, s[8:11], s29 offen sc1
s_waitcnt vmcnt(8)
v_xor_b32 v25, s3, v25
v_xor_b32 v26, s3, v26
v_xor_b32 v27, s3, v27
v_xor_b32 v28, s3, v28
v_or_b32 v25, v25, v26
v_or_b32 v25, v25, v27
v_or_b32 v25, v25, v28
v_cmp_ne_u32 vcc, 0, v25
s_nop 1
s_cbranch_vccz POLLD_S2A
s_mov_b32 s29, 0
buffer_load_dword v25, v16, s[8:11], s29 offen sc1
s_mov_b32 s29, 4096
buffer_load_dword v26, v16, s[8:11], s29 offen sc1
s_mov_b32 s29, 8192
buffer_load_dword v27, v16, s[8:11], s29 offen sc1
s_mov_b32 s29, 12288
buffer_load_dword v28, v16, s[8:11], s29 offen sc1
s_add_u32 s28, s28, 1
s_cmp_gt_u32 s28, 60000
s_cbranch_scc0 POLL_S2A
POLLD_S2A:
s_cmp_lg_u32 s2, 0
s_cbranch_scc1 FC_A
s_mov_b64 exec, 1
v_mov_b32 v20, 0
v_mov_b32 v21, s3
s_mov_b32 s29, 49152
buffer_store_dword v21, v20, s[8:11], s29 offen sc1
s_mov_b64 exec, -1
FC_A:
s_and_b32 s22, s2, 7
s_lshr_b32 s23, s2, 3
s_lshr_b32 s20, s22, 2
s_lshl_b32 s20, s20, 3
s_lshr_b32 s24, s23, 2
s_add_u32 s20, s20, s24
s_and_b32 s21, s22, 3
s_lshl_b32 s21, s21, 2
s_and_b32 s25, s23, 3
s_add_u32 s21, s21, s25
s_load_dwordx4 s[52:55], s[0:1], 80
s_mul_i32 s44, s24, 7
s_lshr_b32 s44, s44, 2
s_mul_i32 s25, s25, 3
s_add_u32 s44, s44, s25
s_cmp_ge_u32 s44, 14
s_cselect_b32 s25, 14, 0
s_sub_u32 s44, s44, s25
s_sub_u32 s31, s30, 4
v_lshrrev_b32 v5, 4, v1
v_and_b32 v6, 15, v1
v_mul_u32_u24 v4, 3584, v5
v_lshl_add_u32 v4, v6, 4, v4
v_lshlrev_b32 v8, 12, v5
v_lshl_add_u32 v8, v6, 4, v8
s_mul_i32 s32, s21, 224
s_and_b32 s33, s21, 1
s_lshl_b32 s33, s33, 5
s_sub_u32 s32, s32, s33
s_lshl_b32 s33, s31, 1
s_mul_i32 s34, s33, 14336
s_add_u32 s32, s32, s34
s_lshl_b32 s35, s33, 14
s_lshl_b32 s36, s20, 8
s_add_u32 s35, s35, s36
s_mul_i32 s37, s33, 1056
s_mov_b32 s14, 1605632
s_mov_b32 s15, 0x20000
s_mov_b32 s18, 1605632
s_mov_b32 s19, 0x20000
v_lshlrev_b32 v9, 4, v1
s_waitcnt lgkmcnt(0)
s_mov_b32 s12, s52
s_mov_b32 s13, s53
s_mov_b32 s16, s54
s_mov_b32 s17, s55
s_add_u32 s40, s4, 4718592
s_addc_u32 s41, s5, 0
s_mov_b32 s42, 1835008
s_mov_b32 s43, 0x20000
s_add_u32 s48, s4, 6750208
s_addc_u32 s49, s5, 0
s_mov_b32 s50, 14336
s_mov_b32 s51, 0x20000
v_lshlrev_b32 v10, 4, v1
v_add_u32 v10, s37, v10
s_add_u32 s45, s44, 0
s_cmp_ge_u32 s45, 14
s_cselect_b32 s46, 14, 0
s_sub_u32 s45, s45, s46
s_mul_i32 s46, s45, 114688
s_add_u32 s46, s46, s32
s_add_u32 s39, s46, 14336
s_add_u32 m0, s37, 76080
s_nop 0
buffer_load_dwordx4 v4, s[12:15], s46 offen lds
s_add_u32 m0, s37, 77136
s_nop 0
buffer_load_dwordx4 v4, s[12:15], s39 offen lds
s_add_u32 m0, s37, 84544
s_nop 0
buffer_load_dwordx4 v4, s[16:19], s46 offen lds
s_add_u32 m0, s37, 85600
s_nop 0
buffer_load_dwordx4 v4, s[16:19], s39 offen lds
s_add_u32 s45, s44, 1
s_cmp_ge_u32 s45, 14
s_cselect_b32 s46, 14, 0
s_sub_u32 s45, s45, s46
s_mul_i32 s46, s45, 114688
s_add_u32 s46, s46, s32
s_add_u32 s39, s46, 14336
s_add_u32 m0, s37, 101440
s_nop 0
buffer_load_dwordx4 v4, s[12:15], s46 offen lds
s_add_u32 m0, s37, 102496
s_nop 0
buffer_load_dwordx4 v4, s[12:15], s39 offen lds
s_add_u32 m0, s37, 109904
s_nop 0
buffer_load_dwordx4 v4, s[16:19], s46 offen lds
s_add_u32 m0, s37, 110960
s_nop 0
buffer_load_dwordx4 v4, s[16:19], s39 offen lds
s_waitcnt vmcnt(0)
s_barrier
s_barrier
s_branch M_G1L
M_CS:
s_cmp_lt_u32 s30, 4
s_cbranch_scc1 M_CS2
s_and_b32 s32, s30, 3
s_add_u32 s16, s4, 6815744
s_addc_u32 s17, s5, 0
s_mov_b32 s18, 7340032
s_mov_b32 s19, 0x20000
v_mov_b32 v244, -1
v_mov_b32 v245, -1
v_mov_b32 v246, -1
v_mov_b32 v247, -1
v_lshlrev_b32 v248, 4, v1
s_and_b32 s28, s2, 7
s_lshr_b32 s29, s2, 3
s_lshr_b32 s34, s28, 2
s_lshl_b32 s34, s34, 3
s_lshr_b32 s35, s29, 2
s_add_u32 s34, s34, s35
s_and_b32 s28, s28, 3
s_lshl_b32 s28, s28, 2
s_and_b32 s29, s29, 3
s_add_u32 s28, s28, s29
s_lshl_b32 s34, s34, 3
s_mul_i32 s28, s28, 3584
s_mov_b32 s35, s32
s_add_u32 s36, s34, s35
s_mul_i32 s36, s36, 57344
s_add_u32 s36, s36, s28
buffer_store_dwordx4 v[244:247], v248, s[16:19], s36 offen sc1
buffer_store_dwordx4 v[244:247], v248, s[16:19], s36 offen offset:1024 sc1
buffer_store_dwordx4 v[244:247], v248, s[16:19], s36 offen offset:2048 sc1
s_mov_b32 s38, -1
s_mov_b32 s39, 0
s_mov_b64 exec, s[38:39]
buffer_store_dwordx4 v[244:247], v248, s[16:19], s36 offen offset:3072 sc1
s_mov_b64 exec, -1
s_add_u32 s35, s32, 4
s_add_u32 s36, s34, s35
s_mul_i32 s36, s36, 57344
s_add_u32 s36, s36, s28
buffer_store_dwordx4 v[244:247], v248, s[16:19], s36 offen sc1
buffer_store_dwordx4 v[244:247], v248, s[16:19], s36 offen offset:1024 sc1
buffer_store_dwordx4 v[244:247], v248, s[16:19], s36 offen offset:2048 sc1
s_mov_b32 s38, -1
s_mov_b32 s39, 0
s_mov_b64 exec, s[38:39]
buffer_store_dwordx4 v[244:247], v248, s[16:19], s36 offen offset:3072 sc1
s_mov_b64 exec, -1
M_CS2:
s_sub_u32 s20, s2, 224
s_cmp_ge_u32 s20, 28
s_cbranch_scc1 CS_DONE
s_cmp_lt_u32 s20, 14
s_mov_b32 s21, 88
s_cselect_b32 s21, 80, s21
s_cselect_b32 s22, 0, 14
s_cselect_b32 s23, 0, 7168
s_sub_u32 s20, s20, s22
s_add_u32 s24, s0, s21
s_addc_u32 s25, s1, 0
s_load_dwordx2 s[12:13], s[24:25], 0
v_and_b32 v2, 15, v0
v_lshrrev_b32 v3, 4, v0
v_mul_u32_u24 v4, 50176, v3
v_lshl_add_u32 v4, v2, 4, v4
s_lshl_b32 s26, s20, 8
s_mov_b32 s14, 1605632
s_mov_b32 s15, 0x20000
s_waitcnt lgkmcnt(0)
s_add_u32 s16, s4, 6750208
s_addc_u32 s17, s5, 0
s_mov_b32 s18, 14336
s_mov_b32 s19, 0x20000
s_add_u32 s27, s26, 0
buffer_load_dwordx4 v[8:11], v4, s[12:15], s27 offen
s_add_u32 s27, s26, 3584
buffer_load_dwordx4 v[12:15], v4, s[12:15], s27 offen
s_add_u32 s27, s26, 7168
buffer_load_dwordx4 v[16:19], v4, s[12:15], s27 offen
s_add_u32 s27, s26, 10752
buffer_load_dwordx4 v[20:23], v4, s[12:15], s27 offen
s_add_u32 s27, s26, 14336
buffer_load_dwordx4 v[24:27], v4, s[12:15], s27 offen
s_add_u32 s27, s26, 17920
buffer_load_dwordx4 v[28:31], v4, s[12:15], s27 offen
s_add_u32 s27, s26, 21504
buffer_load_dwordx4 v[32:35], v4, s[12:15], s27 offen
s_add_u32 s27, s26, 25088
buffer_load_dwordx4 v[36:39], v4, s[12:15], s27 offen
s_add_u32 s27, s26, 28672
buffer_load_dwordx4 v[40:43], v4, s[12:15], s27 offen
s_add_u32 s27, s26, 32256
buffer_load_dwordx4 v[44:47], v4, s[12:15], s27 offen
s_add_u32 s27, s26, 35840
buffer_load_dwordx4 v[48:51], v4, s[12:15], s27 offen
s_add_u32 s27, s26, 39424
buffer_load_dwordx4 v[52:55], v4, s[12:15], s27 offen
s_add_u32 s27, s26, 43008
buffer_load_dwordx4 v[56:59], v4, s[12:15], s27 offen
s_add_u32 s27, s26, 46592
buffer_load_dwordx4 v[60:63], v4, s[12:15], s27 offen
s_waitcnt vmcnt(13)
v_lshlrev_b32 v64, 16, v8
v_and_b32 v65, 0xffff0000, v8
v_lshlrev_b32 v66, 16, v9
v_and_b32 v67, 0xffff0000, v9
v_lshlrev_b32 v68, 16, v10
v_and_b32 v69, 0xffff0000, v10
v_lshlrev_b32 v70, 16, v11
v_and_b32 v71, 0xffff0000, v11
s_waitcnt vmcnt(12)
v_lshlrev_b32 v72, 16, v12
v_and_b32 v73, 0xffff0000, v12
v_lshlrev_b32 v74, 16, v13
v_and_b32 v75, 0xffff0000, v13
v_lshlrev_b32 v76, 16, v14
v_and_b32 v77, 0xffff0000, v14
v_lshlrev_b32 v78, 16, v15
v_and_b32 v79, 0xffff0000, v15
v_pk_add_f32 v[64:65], v[64:65], v[72:73]
v_pk_add_f32 v[66:67], v[66:67], v[74:75]
v_pk_add_f32 v[68:69], v[68:69], v[76:77]
v_pk_add_f32 v[70:71], v[70:71], v[78:79]
s_waitcnt vmcnt(11)
v_lshlrev_b32 v72, 16, v16
v_and_b32 v73, 0xffff0000, v16
v_lshlrev_b32 v74, 16, v17
v_and_b32 v75, 0xffff0000, v17
v_lshlrev_b32 v76, 16, v18
v_and_b32 v77, 0xffff0000, v18
v_lshlrev_b32 v78, 16, v19
v_and_b32 v79, 0xffff0000, v19
v_pk_add_f32 v[64:65], v[64:65], v[72:73]
v_pk_add_f32 v[66:67], v[66:67], v[74:75]
v_pk_add_f32 v[68:69], v[68:69], v[76:77]
v_pk_add_f32 v[70:71], v[70:71], v[78:79]
s_waitcnt vmcnt(10)
v_lshlrev_b32 v72, 16, v20
v_and_b32 v73, 0xffff0000, v20
v_lshlrev_b32 v74, 16, v21
v_and_b32 v75, 0xffff0000, v21
v_lshlrev_b32 v76, 16, v22
v_and_b32 v77, 0xffff0000, v22
v_lshlrev_b32 v78, 16, v23
v_and_b32 v79, 0xffff0000, v23
v_pk_add_f32 v[64:65], v[64:65], v[72:73]
v_pk_add_f32 v[66:67], v[66:67], v[74:75]
v_pk_add_f32 v[68:69], v[68:69], v[76:77]
v_pk_add_f32 v[70:71], v[70:71], v[78:79]
s_waitcnt vmcnt(9)
v_lshlrev_b32 v72, 16, v24
v_and_b32 v73, 0xffff0000, v24
v_lshlrev_b32 v74, 16, v25
v_and_b32 v75, 0xffff0000, v25
v_lshlrev_b32 v76, 16, v26
v_and_b32 v77, 0xffff0000, v26
v_lshlrev_b32 v78, 16, v27
v_and_b32 v79, 0xffff0000, v27
v_pk_add_f32 v[64:65], v[64:65], v[72:73]
v_pk_add_f32 v[66:67], v[66:67], v[74:75]
v_pk_add_f32 v[68:69], v[68:69], v[76:77]
v_pk_add_f32 v[70:71], v[70:71], v[78:79]
s_waitcnt vmcnt(8)
v_lshlrev_b32 v72, 16, v28
v_and_b32 v73, 0xffff0000, v28
v_lshlrev_b32 v74, 16, v29
v_and_b32 v75, 0xffff0000, v29
v_lshlrev_b32 v76, 16, v30
v_and_b32 v77, 0xffff0000, v30
v_lshlrev_b32 v78, 16, v31
v_and_b32 v79, 0xffff0000, v31
v_pk_add_f32 v[64:65], v[64:65], v[72:73]
v_pk_add_f32 v[66:67], v[66:67], v[74:75]
v_pk_add_f32 v[68:69], v[68:69], v[76:77]
v_pk_add_f32 v[70:71], v[70:71], v[78:79]
s_waitcnt vmcnt(7)
v_lshlrev_b32 v72, 16, v32
v_and_b32 v73, 0xffff0000, v32
v_lshlrev_b32 v74, 16, v33
v_and_b32 v75, 0xffff0000, v33
v_lshlrev_b32 v76, 16, v34
v_and_b32 v77, 0xffff0000, v34
v_lshlrev_b32 v78, 16, v35
v_and_b32 v79, 0xffff0000, v35
v_pk_add_f32 v[64:65], v[64:65], v[72:73]
v_pk_add_f32 v[66:67], v[66:67], v[74:75]
v_pk_add_f32 v[68:69], v[68:69], v[76:77]
v_pk_add_f32 v[70:71], v[70:71], v[78:79]
s_waitcnt vmcnt(6)
v_lshlrev_b32 v72, 16, v36
v_and_b32 v73, 0xffff0000, v36
v_lshlrev_b32 v74, 16, v37
v_and_b32 v75, 0xffff0000, v37
v_lshlrev_b32 v76, 16, v38
v_and_b32 v77, 0xffff0000, v38
v_lshlrev_b32 v78, 16, v39
v_and_b32 v79, 0xffff0000, v39
v_pk_add_f32 v[64:65], v[64:65], v[72:73]
v_pk_add_f32 v[66:67], v[66:67], v[74:75]
v_pk_add_f32 v[68:69], v[68:69], v[76:77]
v_pk_add_f32 v[70:71], v[70:71], v[78:79]
s_waitcnt vmcnt(5)
v_lshlrev_b32 v72, 16, v40
v_and_b32 v73, 0xffff0000, v40
v_lshlrev_b32 v74, 16, v41
v_and_b32 v75, 0xffff0000, v41
v_lshlrev_b32 v76, 16, v42
v_and_b32 v77, 0xffff0000, v42
v_lshlrev_b32 v78, 16, v43
v_and_b32 v79, 0xffff0000, v43
v_pk_add_f32 v[64:65], v[64:65], v[72:73]
v_pk_add_f32 v[66:67], v[66:67], v[74:75]
v_pk_add_f32 v[68:69], v[68:69], v[76:77]
v_pk_add_f32 v[70:71], v[70:71], v[78:79]
s_waitcnt vmcnt(4)
v_lshlrev_b32 v72, 16, v44
v_and_b32 v73, 0xffff0000, v44
v_lshlrev_b32 v74, 16, v45
v_and_b32 v75, 0xffff0000, v45
v_lshlrev_b32 v76, 16, v46
v_and_b32 v77, 0xffff0000, v46
v_lshlrev_b32 v78, 16, v47
v_and_b32 v79, 0xffff0000, v47
v_pk_add_f32 v[64:65], v[64:65], v[72:73]
v_pk_add_f32 v[66:67], v[66:67], v[74:75]
v_pk_add_f32 v[68:69], v[68:69], v[76:77]
v_pk_add_f32 v[70:71], v[70:71], v[78:79]
s_waitcnt vmcnt(3)
v_lshlrev_b32 v72, 16, v48
v_and_b32 v73, 0xffff0000, v48
v_lshlrev_b32 v74, 16, v49
v_and_b32 v75, 0xffff0000, v49
v_lshlrev_b32 v76, 16, v50
v_and_b32 v77, 0xffff0000, v50
v_lshlrev_b32 v78, 16, v51
v_and_b32 v79, 0xffff0000, v51
v_pk_add_f32 v[64:65], v[64:65], v[72:73]
v_pk_add_f32 v[66:67], v[66:67], v[74:75]
v_pk_add_f32 v[68:69], v[68:69], v[76:77]
v_pk_add_f32 v[70:71], v[70:71], v[78:79]
s_waitcnt vmcnt(2)
v_lshlrev_b32 v72, 16, v52
v_and_b32 v73, 0xffff0000, v52
v_lshlrev_b32 v74, 16, v53
v_and_b32 v75, 0xffff0000, v53
v_lshlrev_b32 v76, 16, v54
v_and_b32 v77, 0xffff0000, v54
v_lshlrev_b32 v78, 16, v55
v_and_b32 v79, 0xffff0000, v55
v_pk_add_f32 v[64:65], v[64:65], v[72:73]
v_pk_add_f32 v[66:67], v[66:67], v[74:75]
v_pk_add_f32 v[68:69], v[68:69], v[76:77]
v_pk_add_f32 v[70:71], v[70:71], v[78:79]
s_waitcnt vmcnt(1)
v_lshlrev_b32 v72, 16, v56
v_and_b32 v73, 0xffff0000, v56
v_lshlrev_b32 v74, 16, v57
v_and_b32 v75, 0xffff0000, v57
v_lshlrev_b32 v76, 16, v58
v_and_b32 v77, 0xffff0000, v58
v_lshlrev_b32 v78, 16, v59
v_and_b32 v79, 0xffff0000, v59
v_pk_add_f32 v[64:65], v[64:65], v[72:73]
v_pk_add_f32 v[66:67], v[66:67], v[74:75]
v_pk_add_f32 v[68:69], v[68:69], v[76:77]
v_pk_add_f32 v[70:71], v[70:71], v[78:79]
s_waitcnt vmcnt(0)
v_lshlrev_b32 v72, 16, v60
v_and_b32 v73, 0xffff0000, v60
v_lshlrev_b32 v74, 16, v61
v_and_b32 v75, 0xffff0000, v61
v_lshlrev_b32 v76, 16, v62
v_and_b32 v77, 0xffff0000, v62
v_lshlrev_b32 v78, 16, v63
v_and_b32 v79, 0xffff0000, v63
v_pk_add_f32 v[64:65], v[64:65], v[72:73]
v_pk_add_f32 v[66:67], v[66:67], v[74:75]
v_pk_add_f32 v[68:69], v[68:69], v[76:77]
v_pk_add_f32 v[70:71], v[70:71], v[78:79]
v_lshlrev_b32 v5, 5, v0
ds_write_b128 v5, v[64:67]
ds_write_b128 v5, v[68:71] offset:16
v_and_b32 v6, 127, v0
v_lshrrev_b32 v7, 7, v0
v_lshlrev_b32 v80, 2, v6
v_lshl_add_u32 v80, v7, 12, v80
s_waitcnt lgkmcnt(0)
s_barrier
ds_read_b32 v84, v80 offset:0
ds_read_b32 v85, v80 offset:512
ds_read_b32 v86, v80 offset:1024
ds_read_b32 v87, v80 offset:1536
ds_read_b32 v88, v80 offset:2048
ds_read_b32 v89, v80 offset:2560
ds_read_b32 v90, v80 offset:3072
ds_read_b32 v91, v80 offset:3584
s_waitcnt lgkmcnt(0)
v_add_f32 v84, v84, v85
v_add_f32 v84, v84, v86
v_add_f32 v84, v84, v87
v_add_f32 v84, v84, v88
v_add_f32 v84, v84, v89
v_add_f32 v84, v84, v90
v_add_f32 v84, v84, v91
v_lshlrev_b32 v5, 2, v0
ds_write_b32 v5, v84 offset:16384
s_waitcnt lgkmcnt(0)
s_barrier
v_cmp_gt_u32 vcc, 128, v0
s_nop 1
s_and_saveexec_b64 s[28:29], vcc
s_cbranch_execz CS_ST
ds_read_b32 v84, v5 offset:16384
ds_read_b32 v85, v5 offset:16896
ds_read_b32 v86, v5 offset:17408
ds_read_b32 v87, v5 offset:17920
s_lshl_b32 s28, s20, 9
s_add_u32 s28, s28, s23
s_waitcnt lgkmcnt(0)
v_add_f32 v84, v84, v85
v_add_f32 v86, v86, v87
v_add_f32 v84, v84, v86
buffer_store_dword v84, v5, s[16:19], s28 offen sc1
CS_ST:
s_mov_b64 exec, -1
CS_DONE:
s_waitcnt vmcnt(0)
s_mov_b64 exec, 1
v_mov_b32 v236, 163332
v_mov_b32 v237, 1
ds_add_rtn_u32 v237, v236, v237
s_waitcnt lgkmcnt(0)
v_readfirstlane_b32 s28, v237
s_nop 1
s_cmp_lg_u32 s28, 7
s_cbranch_scc1 SIG_S2B
s_sub_u32 s29, s2, 224
s_lshl_b32 s29, s29, 6
s_add_u32 s29, s29, 16384
v_mov_b32 v236, 0
v_mov_b32 v237, s3
buffer_store_dword v237, v236, s[8:11], s29 offen sc1
SIG_S2B:
s_mov_b64 exec, -1
s_cmp_lg_u32 s30, 4
s_cbranch_scc1 FC_B
v_lshlrev_b32 v16, 6, v1
s_mov_b32 s28, 0
s_mov_b32 s29, 0
buffer_load_dword v17, v16, s[8:11], s29 offen sc1
s_mov_b32 s29, 4096
buffer_load_dword v18, v16, s[8:11], s29 offen sc1
s_mov_b32 s29, 8192
buffer_load_dword v19, v16, s[8:11], s29 offen sc1
s_mov_b32 s29, 12288
buffer_load_dword v20, v16, s[8:11], s29 offen sc1
s_sleep 2
s_mov_b32 s29, 0
buffer_load_dword v21, v16, s[8:11], s29 offen sc1
s_mov_b32 s29, 4096
buffer_load_dword v22, v16, s[8:11], s29 offen sc1
s_mov_b32 s29, 8192
buffer_load_dword v23, v16, s[8:11], s29 offen sc1
s_mov_b32 s29, 12288
buffer_load_dword v24, v16, s[8:11], s29 offen sc1
s_sleep 2
s_mov_b32 s29, 0
buffer_load_dword v25, v16, s[8:11], s29 offen sc1
s_mov_b32 s29, 4096
buffer_load_dword v26, v16, s[8:11], s29 offen sc1
s_mov_b32 s29, 8192
buffer_load_dword v27, v16, s[8:11], s29 offen sc1
s_mov_b32 s29, 12288
buffer_load_dword v28, v16, s[8:11], s29 offen sc1
POLL_S2B:
s_waitcnt vmcnt(8)
v_xor_b32 v17, s3, v17
v_xor_b32 v18, s3, v18
v_xor_b32 v19, s3, v19
v_xor_b32 v20, s3, v20
v_or_b32 v17, v17, v18
v_or_b32 v17, v17, v19
v_or_b32 v17, v17, v20
v_cmp_ne_u32 vcc, 0, v17
s_nop 1
s_cbranch_vccz POLLD_S2B
s_mov_b32 s29, 0
buffer_load_dword v17, v16, s[8:11], s29 offen sc1
s_mov_b32 s29, 4096
buffer_load_dword v18, v16, s[8:11], s29 offen sc1
s_mov_b32 s29, 8192
buffer_load_dword v19, v16, s[8:11], s29 offen sc1
s_mov_b32 s29, 12288
buffer_load_dword v20, v16, s[8:11], s29 offen sc1
s_waitcnt vmcnt(8)
v_xor_b32 v21, s3, v21
v_xor_b32 v22, s3, v22
v_xor_b32 v23, s3, v23
v_xor_b32 v24, s3, v24
v_or_b32 v21, v21, v22
v_or_b32 v21, v21, v23
v_or_b32 v21, v21, v24
v_cmp_ne_u32 vcc, 0, v21
s_nop 1
s_cbranch_vccz POLLD_S2B
s_mov_b32 s29, 0
buffer_load_dword v21, v16, s[8:11], s29 offen sc1
s_mov_b32 s29, 4096
buffer_load_dword v22, v16, s[8:11], s29 offen sc1
s_mov_b32 s29, 8192
buffer_load_dword v23, v16, s[8:11], s29 offen sc1
s_mov_b32 s29, 12288
buffer_load_dword v24, v16, s[8:11], s29 offen sc1
s_waitcnt vmcnt(8)
v_xor_b32 v25, s3, v25
v_xor_b32 v26, s3, v26
v_xor_b32 v27, s3, v27
v_xor_b32 v28, s3, v28
v_or_b32 v25, v25, v26
v_or_b32 v25, v25, v27
v_or_b32 v25, v25, v28
v_cmp_ne_u32 vcc, 0, v25
s_nop 1
s_cbranch_vccz POLLD_S2B
s_mov_b32 s29, 0
buffer_load_dword v25, v16, s[8:11], s29 offen sc1
s_mov_b32 s29, 4096
buffer_load_dword v26, v16, s[8:11], s29 offen sc1
s_mov_b32 s29, 8192
buffer_load_dword v27, v16, s[8:11], s29 offen sc1
s_mov_b32 s29, 12288
buffer_load_dword v28, v16, s[8:11], s29 offen sc1
s_add_u32 s28, s28, 1
s_cmp_gt_u32 s28, 60000
s_cbranch_scc0 POLL_S2B
POLLD_S2B:
s_cmp_lg_u32 s2, 0
s_cbranch_scc1 FC_B
s_mov_b64 exec, 1
v_mov_b32 v20, 0
v_mov_b32 v21, s3
s_mov_b32 s29, 49152
buffer_store_dword v21, v20, s[8:11], s29 offen sc1
s_mov_b64 exec, -1
FC_B:
s_barrier
s_cmp_lt_u32 s30, 4
s_cbranch_scc1 M_G1C
s_and_b32 s22, s2, 7
s_lshr_b32 s23, s2, 3
s_lshr_b32 s20, s22, 2
s_lshl_b32 s20, s20, 3
s_lshr_b32 s24, s23, 2
s_add_u32 s20, s20, s24
s_and_b32 s21, s22, 3
s_lshl_b32 s21, s21, 2
s_and_b32 s25, s23, 3
s_add_u32 s21, s21, s25
s_load_dwordx4 s[52:55], s[0:1], 80
s_mul_i32 s44, s24, 7
s_lshr_b32 s44, s44, 2
s_mul_i32 s25, s25, 3
s_add_u32 s44, s44, s25
s_cmp_ge_u32 s44, 14
s_cselect_b32 s25, 14, 0
s_sub_u32 s44, s44, s25
s_sub_u32 s31, s30, 4
v_lshrrev_b32 v5, 4, v1
v_and_b32 v6, 15, v1
v_mul_u32_u24 v4, 3584, v5
v_lshl_add_u32 v4, v6, 4, v4
v_lshlrev_b32 v8, 12, v5
v_lshl_add_u32 v8, v6, 4, v8
s_mul_i32 s32, s21, 224
s_and_b32 s33, s21, 1
s_lshl_b32 s33, s33, 5
s_sub_u32 s32, s32, s33
s_lshl_b32 s33, s31, 1
s_mul_i32 s34, s33, 14336
s_add_u32 s32, s32, s34
s_lshl_b32 s35, s33, 14
s_lshl_b32 s36, s20, 8
s_add_u32 s35, s35, s36
s_mul_i32 s37, s33, 1056
s_mov_b32 s14, 1605632
s_mov_b32 s15, 0x20000
s_mov_b32 s18, 1605632
s_mov_b32 s19, 0x20000
v_lshlrev_b32 v9, 4, v1
s_waitcnt lgkmcnt(0)
s_mov_b32 s12, s52
s_mov_b32 s13, s53
s_mov_b32 s16, s54
s_mov_b32 s17, s55
s_add_u32 s40, s4, 4718592
s_addc_u32 s41, s5, 0
s_mov_b32 s42, 1835008
s_mov_b32 s43, 0x20000
s_add_u32 s48, s4, 6750208
s_addc_u32 s49, s5, 0
s_mov_b32 s50, 14336
s_mov_b32 s51, 0x20000
v_lshlrev_b32 v10, 4, v1
v_add_u32 v10, s37, v10
s_add_u32 s45, s44, 0
s_cmp_ge_u32 s45, 14
s_cselect_b32 s46, 14, 0
s_sub_u32 s45, s45, s46
s_mul_i32 s46, s45, 114688
s_add_u32 s46, s46, s32
s_add_u32 s39, s46, 14336
s_add_u32 m0, s37, 76080
s_nop 0
buffer_load_dwordx4 v4, s[12:15], s46 offen lds
s_add_u32 m0, s37, 77136
s_nop 0
buffer_load_dwordx4 v4, s[12:15], s39 offen lds
s_add_u32 m0, s37, 84544
s_nop 0
buffer_load_dwordx4 v4, s[16:19], s46 offen lds
s_add_u32 m0, s37, 85600
s_nop 0
buffer_load_dwordx4 v4, s[16:19], s39 offen lds
s_add_u32 s45, s44, 1
s_cmp_ge_u32 s45, 14
s_cselect_b32 s46, 14, 0
s_sub_u32 s45, s45, s46
s_mul_i32 s46, s45, 114688
s_add_u32 s46, s46, s32
s_add_u32 s39, s46, 14336
s_add_u32 m0, s37, 101440
s_nop 0
buffer_load_dwordx4 v4, s[12:15], s46 offen lds
s_add_u32 m0, s37, 102496
s_nop 0
buffer_load_dwordx4 v4, s[12:15], s39 offen lds
s_add_u32 m0, s37, 109904
s_nop 0
buffer_load_dwordx4 v4, s[16:19], s46 offen lds
s_add_u32 m0, s37, 110960
s_nop 0
buffer_load_dwordx4 v4, s[16:19], s39 offen lds
s_branch M_G1L
M_G1C:
s_and_b32 s22, s2, 7
s_lshr_b32 s23, s2, 3
s_lshr_b32 s20, s22, 2
s_lshl_b32 s20, s20, 3
s_lshr_b32 s24, s23, 2
s_add_u32 s20, s20, s24
s_and_b32 s21, s22, 3
s_lshl_b32 s21, s21, 2
s_and_b32 s25, s23, 3
s_add_u32 s21, s21, s25
s_add_u32 s16, s4, 6815744
s_addc_u32 s17, s5, 0
s_mov_b32 s18, 7340032
s_mov_b32 s19, 0x20000
s_lshr_b32 s31, s30, 1
s_and_b32 s32, s30, 1
v_lshrrev_b32 v2, 4, v1
v_bfe_u32 v3, v1, 2, 2
v_and_b32 v4, 3, v1
v_and_b32 v5, 1, v2
v_lshl_add_u32 v5, v5, 2, v3
v_mul_u32_u24 v5, 1056, v5
v_lshrrev_b32 v6, 1, v2
v_lshl_add_u32 v5, v6, 8, v5
v_and_b32 v7, 1, v4
v_lshl_add_u32 v6, v7, 3, v5
v_lshrrev_b32 v7, 1, v4
v_mul_u32_u24 v7, 8464, v7
v_add_u32 v6, v6, v7
s_and_b32 s33, s21, 1
s_lshl_b32 s33, s33, 5
s_mul_i32 s35, s32, 96
s_add_u32 s35, s35, s33
v_add_u32 v8, s35, v6
v_add_u32 v9, 50720, v8
v_add_u32 v10, 101440, v8
s_lshl_b32 s35, s32, 4
s_add_u32 s35, s35, 192
s_add_u32 s35, s35, s33
v_add_u32 v11, s35, v6
v_add_u32 v12, 50720, v11
v_add_u32 v13, 101440, v11
v_lshl_add_u32 v6, v4, 3, v5
s_lshl_b32 s35, s31, 7
s_add_u32 s35, s35, 16912
s_lshl_b32 s36, s32, 6
s_add_u32 s37, s35, s36
v_add_u32 v14, s37, v6
v_add_u32 v15, 50720, v14
v_add_u32 v16, 101440, v14
s_xor_b32 s36, s36, 64
s_add_u32 s37, s35, s36
v_add_u32 v17, s37, v6
v_add_u32 v18, 50720, v17
v_add_u32 v19, 101440, v17
v_mov_b32 v120, 0x3f803f80
v_mov_b32 v121, 0x3f803f80
v_mov_b32 v122, 0x3f803f80
v_mov_b32 v123, 0x3f803f80
v_and_b32 v20, 15, v1
v_and_b32 v21, 3, v20
v_cmp_eq_u32 s[60:61], 1, v21
v_cmp_eq_u32 s[62:63], 2, v21
v_cmp_eq_u32 s[64:65], 3, v21
v_lshrrev_b32 v21, 2, v20
v_cmp_eq_u32 s[66:67], v21, v2
v_cmp_gt_u32 s[68:69], 32, v1
s_barrier
ds_read_b64_tr_b16 v[60:61], v15 offset:25360
ds_read_b64_tr_b16 v[62:63], v15 offset:25872
ds_read_b64_tr_b16 v[64:65], v15 offset:25392
ds_read_b64_tr_b16 v[66:67], v15 offset:25904
ds_read_b64_tr_b16 v[68:69], v18 offset:25360
ds_read_b64_tr_b16 v[70:71], v18 offset:25872
ds_read_b64_tr_b16 v[72:73], v18 offset:25392
ds_read_b64_tr_b16 v[74:75], v18 offset:25904
ds_read_b64_tr_b16 v[32:33], v9 offset:25360
ds_read_b64_tr_b16 v[34:35], v9 offset:25872
ds_read_b64_tr_b16 v[36:37], v9 offset:25376
ds_read_b64_tr_b16 v[38:39], v9 offset:25888
ds_read_b64_tr_b16 v[40:41], v9 offset:25392
ds_read_b64_tr_b16 v[42:43], v9 offset:25904
ds_read_b64_tr_b16 v[44:45], v9 offset:25408
ds_read_b64_tr_b16 v[46:47], v9 offset:25920
ds_read_b64_tr_b16 v[48:49], v9 offset:25424
ds_read_b64_tr_b16 v[50:51], v9 offset:25936
ds_read_b64_tr_b16 v[52:53], v9 offset:25440
ds_read_b64_tr_b16 v[54:55], v9 offset:25952
ds_read_b64_tr_b16 v[56:57], v12 offset:25360
ds_read_b64_tr_b16 v[58:59], v12 offset:25872
s_waitcnt lgkmcnt(0)
s_barrier
v_mfma_f32_16x16x32_bf16 v[240:243], v[60:63], v[60:63], 0
ds_read_b64_tr_b16 v[104:105], v16 offset:0
v_mfma_f32_16x16x32_bf16 v[244:247], v[120:123], v[60:63], 0
ds_read_b64_tr_b16 v[106:107], v16 offset:512
v_mfma_f32_16x16x32_bf16 v[248:251], v[64:67], v[64:67], 0
ds_read_b64_tr_b16 v[108:109], v16 offset:32
v_mfma_f32_16x16x32_bf16 v[252:255], v[120:123], v[64:67], 0
ds_read_b64_tr_b16 v[110:111], v16 offset:544
v_mfma_f32_16x16x32_bf16 v[128:131], v[32:35], v[60:63], 0
ds_read_b64_tr_b16 v[112:113], v19 offset:0
v_mfma_f32_16x16x32_bf16 v[132:135], v[32:35], v[64:67], 0
ds_read_b64_tr_b16 v[114:115], v19 offset:512
v_mfma_f32_16x16x32_bf16 v[136:139], v[32:35], v[68:71], 0
ds_read_b64_tr_b16 v[116:117], v19 offset:32
v_mfma_f32_16x16x32_bf16 v[140:143], v[32:35], v[72:75], 0
ds_read_b64_tr_b16 v[118:119], v19 offset:544
v_mfma_f32_16x16x32_bf16 v[144:147], v[36:39], v[60:63], 0
ds_read_b64_tr_b16 v[76:77], v10 offset:0
v_mfma_f32_16x16x32_bf16 v[148:151], v[36:39], v[64:67], 0
ds_read_b64_tr_b16 v[78:79], v10 offset:512
v_mfma_f32_16x16x32_bf16 v[152:155], v[36:39], v[68:71], 0
ds_read_b64_tr_b16 v[80:81], v10 offset:16
v_mfma_f32_16x16x32_bf16 v[156:159], v[36:39], v[72:75], 0
ds_read_b64_tr_b16 v[82:83], v10 offset:528
v_mfma_f32_16x16x32_bf16 v[160:163], v[40:43], v[60:63], 0
ds_read_b64_tr_b16 v[84:85], v10 offset:32
v_mfma_f32_16x16x32_bf16 v[164:167], v[40:43], v[64:67], 0
ds_read_b64_tr_b16 v[86:87], v10 offset:544
v_mfma_f32_16x16x32_bf16 v[168:171], v[40:43], v[68:71], 0
ds_read_b64_tr_b16 v[88:89], v10 offset:48
v_mfma_f32_16x16x32_bf16 v[172:175], v[40:43], v[72:75], 0
ds_read_b64_tr_b16 v[90:91], v10 offset:560
v_mfma_f32_16x16x32_bf16 v[176:179], v[44:47], v[60:63], 0
ds_read_b64_tr_b16 v[92:93], v10 offset:64
v_mfma_f32_16x16x32_bf16 v[180:183], v[44:47], v[64:67], 0
ds_read_b64_tr_b16 v[94:95], v10 offset:576
v_mfma_f32_16x16x32_bf16 v[184:187], v[44:47], v[68:71], 0
ds_read_b64_tr_b16 v[96:97], v10 offset:80
v_mfma_f32_16x16x32_bf16 v[188:191], v[44:47], v[72:75], 0
ds_read_b64_tr_b16 v[98:99], v10 offset:592
v_mfma_f32_16x16x32_bf16 v[192:195], v[48:51], v[60:63], 0
ds_read_b64_tr_b16 v[100:101], v13 offset:0
v_mfma_f32_16x16x32_bf16 v[196:199], v[48:51], v[64:67], 0
ds_read_b64_tr_b16 v[102:103], v13 offset:512
v_mfma_f32_16x16x32_bf16 v[200:203], v[48:51], v[68:71], 0
v_mfma_f32_16x16x32_bf16 v[204:207], v[48:51], v[72:75], 0
v_mfma_f32_16x16x32_bf16 v[208:211], v[52:55], v[60:63], 0
v_mfma_f32_16x16x32_bf16 v[212:215], v[52:55], v[64:67], 0
v_mfma_f32_16x16x32_bf16 v[216:219], v[52:55], v[68:71], 0
v_mfma_f32_16x16x32_bf16 v[220:223], v[52:55], v[72:75], 0
v_mfma_f32_16x16x32_bf16 v[224:227], v[56:59], v[60:63], 0
v_mfma_f32_16x16x32_bf16 v[228:231], v[56:59], v[64:67], 0
v_mfma_f32_16x16x32_bf16 v[232:235], v[56:59], v[68:71], 0
v_mfma_f32_16x16x32_bf16 v[236:239], v[56:59], v[72:75], 0
s_waitcnt lgkmcnt(0)
s_barrier
v_mfma_f32_16x16x32_bf16 v[240:243], v[104:107], v[104:107], v[240:243]
ds_read_b64_tr_b16 v[60:61], v14 offset:0
v_mfma_f32_16x16x32_bf16 v[244:247], v[120:123], v[104:107], v[244:247]
ds_read_b64_tr_b16 v[62:63], v14 offset:512
v_mfma_f32_16x16x32_bf16 v[248:251], v[108:111], v[108:111], v[248:251]
ds_read_b64_tr_b16 v[64:65], v14 offset:32
v_mfma_f32_16x16x32_bf16 v[252:255], v[120:123], v[108:111], v[252:255]
ds_read_b64_tr_b16 v[66:67], v14 offset:544
v_mfma_f32_16x16x32_bf16 v[128:131], v[76:79], v[104:107], v[128:131]
ds_read_b64_tr_b16 v[68:69], v17 offset:0
v_mfma_f32_16x16x32_bf16 v[132:135], v[76:79], v[108:111], v[132:135]
ds_read_b64_tr_b16 v[70:71], v17 offset:512
v_mfma_f32_16x16x32_bf16 v[136:139], v[76:79], v[112:115], v[136:139]
ds_read_b64_tr_b16 v[72:73], v17 offset:32
v_mfma_f32_16x16x32_bf16 v[140:143], v[76:79], v[116:119], v[140:143]
ds_read_b64_tr_b16 v[74:75], v17 offset:544
v_mfma_f32_16x16x32_bf16 v[144:147], v[80:83], v[104:107], v[144:147]
ds_read_b64_tr_b16 v[32:33], v8 offset:0
v_mfma_f32_16x16x32_bf16 v[148:151], v[80:83], v[108:111], v[148:151]
ds_read_b64_tr_b16 v[34:35], v8 offset:512
v_mfma_f32_16x16x32_bf16 v[152:155], v[80:83], v[112:115], v[152:155]
ds_read_b64_tr_b16 v[36:37], v8 offset:16
v_mfma_f32_16x16x32_bf16 v[156:159], v[80:83], v[116:119], v[156:159]
ds_read_b64_tr_b16 v[38:39], v8 offset:528
v_mfma_f32_16x16x32_bf16 v[160:163], v[84:87], v[104:107], v[160:163]
ds_read_b64_tr_b16 v[40:41], v8 offset:32
v_mfma_f32_16x16x32_bf16 v[164:167], v[84:87], v[108:111], v[164:167]
ds_read_b64_tr_b16 v[42:43], v8 offset:544
v_mfma_f32_16x16x32_bf16 v[168:171], v[84:87], v[112:115], v[168:171]
ds_read_b64_tr_b16 v[44:45], v8 offset:48
v_mfma_f32_16x16x32_bf16 v[172:175], v[84:87], v[116:119], v[172:175]
ds_read_b64_tr_b16 v[46:47], v8 offset:560
v_mfma_f32_16x16x32_bf16 v[176:179], v[88:91], v[104:107], v[176:179]
ds_read_b64_tr_b16 v[48:49], v8 offset:64
v_mfma_f32_16x16x32_bf16 v[180:183], v[88:91], v[108:111], v[180:183]
ds_read_b64_tr_b16 v[50:51], v8 offset:576
v_mfma_f32_16x16x32_bf16 v[184:187], v[88:91], v[112:115], v[184:187]
ds_read_b64_tr_b16 v[52:53], v8 offset:80
v_mfma_f32_16x16x32_bf16 v[188:191], v[88:91], v[116:119], v[188:191]
ds_read_b64_tr_b16 v[54:55], v8 offset:592
v_mfma_f32_16x16x32_bf16 v[192:195], v[92:95], v[104:107], v[192:195]
ds_read_b64_tr_b16 v[56:57], v11 offset:0
v_mfma_f32_16x16x32_bf16 v[196:199], v[92:95], v[108:111], v[196:199]
ds_read_b64_tr_b16 v[58:59], v11 offset:512
v_mfma_f32_16x16x32_bf16 v[200:203], v[92:95], v[112:115], v[200:203]
v_mfma_f32_16x16x32_bf16 v[204:207], v[92:95], v[116:119], v[204:207]
v_mfma_f32_16x16x32_bf16 v[208:211], v[96:99], v[104:107], v[208:211]
v_mfma_f32_16x16x32_bf16 v[212:215], v[96:99], v[108:111], v[212:215]
v_mfma_f32_16x16x32_bf16 v[216:219], v[96:99], v[112:115], v[216:219]
v_mfma_f32_16x16x32_bf16 v[220:223], v[96:99], v[116:119], v[220:223]
v_mfma_f32_16x16x32_bf16 v[224:227], v[100:103], v[104:107], v[224:227]
v_mfma_f32_16x16x32_bf16 v[228:231], v[100:103], v[108:111], v[228:231]
v_mfma_f32_16x16x32_bf16 v[232:235], v[100:103], v[112:115], v[232:235]
v_mfma_f32_16x16x32_bf16 v[236:239], v[100:103], v[116:119], v[236:239]
s_waitcnt lgkmcnt(0)
s_barrier
v_mfma_f32_16x16x32_bf16 v[240:243], v[60:63], v[60:63], v[240:243]
ds_read_b64_tr_b16 v[104:105], v14 offset:25360
v_mfma_f32_16x16x32_bf16 v[244:247], v[120:123], v[60:63], v[244:247]
ds_read_b64_tr_b16 v[106:107], v14 offset:25872
v_mfma_f32_16x16x32_bf16 v[248:251], v[64:67], v[64:67], v[248:251]
ds_read_b64_tr_b16 v[108:109], v14 offset:25392
v_mfma_f32_16x16x32_bf16 v[252:255], v[120:123], v[64:67], v[252:255]
ds_read_b64_tr_b16 v[110:111], v14 offset:25904
v_mfma_f32_16x16x32_bf16 v[128:131], v[32:35], v[60:63], v[128:131]
ds_read_b64_tr_b16 v[112:113], v17 offset:25360
v_mfma_f32_16x16x32_bf16 v[132:135], v[32:35], v[64:67], v[132:135]
ds_read_b64_tr_b16 v[114:115], v17 offset:25872
v_mfma_f32_16x16x32_bf16 v[136:139], v[32:35], v[68:71], v[136:139]
ds_read_b64_tr_b16 v[116:117], v17 offset:25392
v_mfma_f32_16x16x32_bf16 v[140:143], v[32:35], v[72:75], v[140:143]
ds_read_b64_tr_b16 v[118:119], v17 offset:25904
v_mfma_f32_16x16x32_bf16 v[144:147], v[36:39], v[60:63], v[144:147]
ds_read_b64_tr_b16 v[76:77], v8 offset:25360
v_mfma_f32_16x16x32_bf16 v[148:151], v[36:39], v[64:67], v[148:151]
ds_read_b64_tr_b16 v[78:79], v8 offset:25872
v_mfma_f32_16x16x32_bf16 v[152:155], v[36:39], v[68:71], v[152:155]
ds_read_b64_tr_b16 v[80:81], v8 offset:25376
v_mfma_f32_16x16x32_bf16 v[156:159], v[36:39], v[72:75], v[156:159]
ds_read_b64_tr_b16 v[82:83], v8 offset:25888
v_mfma_f32_16x16x32_bf16 v[160:163], v[40:43], v[60:63], v[160:163]
ds_read_b64_tr_b16 v[84:85], v8 offset:25392
v_mfma_f32_16x16x32_bf16 v[164:167], v[40:43], v[64:67], v[164:167]
ds_read_b64_tr_b16 v[86:87], v8 offset:25904
v_mfma_f32_16x16x32_bf16 v[168:171], v[40:43], v[68:71], v[168:171]
ds_read_b64_tr_b16 v[88:89], v8 offset:25408
v_mfma_f32_16x16x32_bf16 v[172:175], v[40:43], v[72:75], v[172:175]
ds_read_b64_tr_b16 v[90:91], v8 offset:25920
v_mfma_f32_16x16x32_bf16 v[176:179], v[44:47], v[60:63], v[176:179]
ds_read_b64_tr_b16 v[92:93], v8 offset:25424
v_mfma_f32_16x16x32_bf16 v[180:183], v[44:47], v[64:67], v[180:183]
ds_read_b64_tr_b16 v[94:95], v8 offset:25936
v_mfma_f32_16x16x32_bf16 v[184:187], v[44:47], v[68:71], v[184:187]
ds_read_b64_tr_b16 v[96:97], v8 offset:25440
v_mfma_f32_16x16x32_bf16 v[188:191], v[44:47], v[72:75], v[188:191]
ds_read_b64_tr_b16 v[98:99], v8 offset:25952
v_mfma_f32_16x16x32_bf16 v[192:195], v[48:51], v[60:63], v[192:195]
ds_read_b64_tr_b16 v[100:101], v11 offset:25360
v_mfma_f32_16x16x32_bf16 v[196:199], v[48:51], v[64:67], v[196:199]
ds_read_b64_tr_b16 v[102:103], v11 offset:25872
v_mfma_f32_16x16x32_bf16 v[200:203], v[48:51], v[68:71], v[200:203]
v_mfma_f32_16x16x32_bf16 v[204:207], v[48:51], v[72:75], v[204:207]
v_mfma_f32_16x16x32_bf16 v[208:211], v[52:55], v[60:63], v[208:211]
v_mfma_f32_16x16x32_bf16 v[212:215], v[52:55], v[64:67], v[212:215]
v_mfma_f32_16x16x32_bf16 v[216:219], v[52:55], v[68:71], v[216:219]
v_mfma_f32_16x16x32_bf16 v[220:223], v[52:55], v[72:75], v[220:223]
v_mfma_f32_16x16x32_bf16 v[224:227], v[56:59], v[60:63], v[224:227]
v_mfma_f32_16x16x32_bf16 v[228:231], v[56:59], v[64:67], v[228:231]
v_mfma_f32_16x16x32_bf16 v[232:235], v[56:59], v[68:71], v[232:235]
v_mfma_f32_16x16x32_bf16 v[236:239], v[56:59], v[72:75], v[236:239]
s_waitcnt lgkmcnt(0)
s_barrier
v_mfma_f32_16x16x32_bf16 v[240:243], v[104:107], v[104:107], v[240:243]
ds_read_b64_tr_b16 v[60:61], v15 offset:0
v_mfma_f32_16x16x32_bf16 v[244:247], v[120:123], v[104:107], v[244:247]
ds_read_b64_tr_b16 v[62:63], v15 offset:512
v_mfma_f32_16x16x32_bf16 v[248:251], v[108:111], v[108:111], v[248:251]
ds_read_b64_tr_b16 v[64:65], v15 offset:32
v_mfma_f32_16x16x32_bf16 v[252:255], v[120:123], v[108:111], v[252:255]
ds_read_b64_tr_b16 v[66:67], v15 offset:544
v_mfma_f32_16x16x32_bf16 v[128:131], v[76:79], v[104:107], v[128:131]
ds_read_b64_tr_b16 v[68:69], v18 offset:0
v_mfma_f32_16x16x32_bf16 v[132:135], v[76:79], v[108:111], v[132:135]
ds_read_b64_tr_b16 v[70:71], v18 offset:512
v_mfma_f32_16x16x32_bf16 v[136:139], v[76:79], v[112:115], v[136:139]
ds_read_b64_tr_b16 v[72:73], v18 offset:32
v_mfma_f32_16x16x32_bf16 v[140:143], v[76:79], v[116:119], v[140:143]
ds_read_b64_tr_b16 v[74:75], v18 offset:544
v_mfma_f32_16x16x32_bf16 v[144:147], v[80:83], v[104:107], v[144:147]
ds_read_b64_tr_b16 v[32:33], v9 offset:0
v_mfma_f32_16x16x32_bf16 v[148:151], v[80:83], v[108:111], v[148:151]
ds_read_b64_tr_b16 v[34:35], v9 offset:512
v_mfma_f32_16x16x32_bf16 v[152:155], v[80:83], v[112:115], v[152:155]
ds_read_b64_tr_b16 v[36:37], v9 offset:16
v_mfma_f32_16x16x32_bf16 v[156:159], v[80:83], v[116:119], v[156:159]
ds_read_b64_tr_b16 v[38:39], v9 offset:528
v_mfma_f32_16x16x32_bf16 v[160:163], v[84:87], v[104:107], v[160:163]
ds_read_b64_tr_b16 v[40:41], v9 offset:32
v_mfma_f32_16x16x32_bf16 v[164:167], v[84:87], v[108:111], v[164:167]
ds_read_b64_tr_b16 v[42:43], v9 offset:544
v_mfma_f32_16x16x32_bf16 v[168:171], v[84:87], v[112:115], v[168:171]
ds_read_b64_tr_b16 v[44:45], v9 offset:48
v_mfma_f32_16x16x32_bf16 v[172:175], v[84:87], v[116:119], v[172:175]
ds_read_b64_tr_b16 v[46:47], v9 offset:560
v_mfma_f32_16x16x32_bf16 v[176:179], v[88:91], v[104:107], v[176:179]
ds_read_b64_tr_b16 v[48:49], v9 offset:64
v_mfma_f32_16x16x32_bf16 v[180:183], v[88:91], v[108:111], v[180:183]
ds_read_b64_tr_b16 v[50:51], v9 offset:576
v_mfma_f32_16x16x32_bf16 v[184:187], v[88:91], v[112:115], v[184:187]
ds_read_b64_tr_b16 v[52:53], v9 offset:80
v_mfma_f32_16x16x32_bf16 v[188:191], v[88:91], v[116:119], v[188:191]
ds_read_b64_tr_b16 v[54:55], v9 offset:592
v_mfma_f32_16x16x32_bf16 v[192:195], v[92:95], v[104:107], v[192:195]
ds_read_b64_tr_b16 v[56:57], v12 offset:0
v_mfma_f32_16x16x32_bf16 v[196:199], v[92:95], v[108:111], v[196:199]
ds_read_b64_tr_b16 v[58:59], v12 offset:512
v_mfma_f32_16x16x32_bf16 v[200:203], v[92:95], v[112:115], v[200:203]
v_mfma_f32_16x16x32_bf16 v[204:207], v[92:95], v[116:119], v[204:207]
v_mfma_f32_16x16x32_bf16 v[208:211], v[96:99], v[104:107], v[208:211]
v_mfma_f32_16x16x32_bf16 v[212:215], v[96:99], v[108:111], v[212:215]
v_mfma_f32_16x16x32_bf16 v[216:219], v[96:99], v[112:115], v[216:219]
v_mfma_f32_16x16x32_bf16 v[220:223], v[96:99], v[116:119], v[220:223]
v_mfma_f32_16x16x32_bf16 v[224:227], v[100:103], v[104:107], v[224:227]
v_mfma_f32_16x16x32_bf16 v[228:231], v[100:103], v[108:111], v[228:231]
v_mfma_f32_16x16x32_bf16 v[232:235], v[100:103], v[112:115], v[232:235]
v_mfma_f32_16x16x32_bf16 v[236:239], v[100:103], v[116:119], v[236:239]
s_waitcnt lgkmcnt(0)
s_barrier
v_mfma_f32_16x16x32_bf16 v[240:243], v[60:63], v[60:63], v[240:243]
ds_read_b64_tr_b16 v[104:105], v15 offset:25360
v_mfma_f32_16x16x32_bf16 v[244:247], v[120:123], v[60:63], v[244:247]
ds_read_b64_tr_b16 v[106:107], v15 offset:25872
v_mfma_f32_16x16x32_bf16 v[248:251], v[64:67], v[64:67], v[248:251]
ds_read_b64_tr_b16 v[108:109], v15 offset:25392
v_mfma_f32_16x16x32_bf16 v[252:255], v[120:123], v[64:67], v[252:255]
ds_read_b64_tr_b16 v[110:111], v15 offset:25904
v_mfma_f32_16x16x32_bf16 v[128:131], v[32:35], v[60:63], v[128:131]
ds_read_b64_tr_b16 v[112:113], v18 offset:25360
v_mfma_f32_16x16x32_bf16 v[132:135], v[32:35], v[64:67], v[132:135]
ds_read_b64_tr_b16 v[114:115], v18 offset:25872
v_mfma_f32_16x16x32_bf16 v[136:139], v[32:35], v[68:71], v[136:139]
ds_read_b64_tr_b16 v[116:117], v18 offset:25392
v_mfma_f32_16x16x32_bf16 v[140:143], v[32:35], v[72:75], v[140:143]
ds_read_b64_tr_b16 v[118:119], v18 offset:25904
v_mfma_f32_16x16x32_bf16 v[144:147], v[36:39], v[60:63], v[144:147]
ds_read_b64_tr_b16 v[76:77], v9 offset:25360
v_mfma_f32_16x16x32_bf16 v[148:151], v[36:39], v[64:67], v[148:151]
ds_read_b64_tr_b16 v[78:79], v9 offset:25872
v_mfma_f32_16x16x32_bf16 v[152:155], v[36:39], v[68:71], v[152:155]
ds_read_b64_tr_b16 v[80:81], v9 offset:25376
v_mfma_f32_16x16x32_bf16 v[156:159], v[36:39], v[72:75], v[156:159]
ds_read_b64_tr_b16 v[82:83], v9 offset:25888
v_mfma_f32_16x16x32_bf16 v[160:163], v[40:43], v[60:63], v[160:163]
ds_read_b64_tr_b16 v[84:85], v9 offset:25392
v_mfma_f32_16x16x32_bf16 v[164:167], v[40:43], v[64:67], v[164:167]
ds_read_b64_tr_b16 v[86:87], v9 offset:25904
v_mfma_f32_16x16x32_bf16 v[168:171], v[40:43], v[68:71], v[168:171]
ds_read_b64_tr_b16 v[88:89], v9 offset:25408
v_mfma_f32_16x16x32_bf16 v[172:175], v[40:43], v[72:75], v[172:175]
ds_read_b64_tr_b16 v[90:91], v9 offset:25920
v_mfma_f32_16x16x32_bf16 v[176:179], v[44:47], v[60:63], v[176:179]
ds_read_b64_tr_b16 v[92:93], v9 offset:25424
v_mfma_f32_16x16x32_bf16 v[180:183], v[44:47], v[64:67], v[180:183]
ds_read_b64_tr_b16 v[94:95], v9 offset:25936
v_mfma_f32_16x16x32_bf16 v[184:187], v[44:47], v[68:71], v[184:187]
ds_read_b64_tr_b16 v[96:97], v9 offset:25440
v_mfma_f32_16x16x32_bf16 v[188:191], v[44:47], v[72:75], v[188:191]
ds_read_b64_tr_b16 v[98:99], v9 offset:25952
v_mfma_f32_16x16x32_bf16 v[192:195], v[48:51], v[60:63], v[192:195]
ds_read_b64_tr_b16 v[100:101], v12 offset:25360
v_mfma_f32_16x16x32_bf16 v[196:199], v[48:51], v[64:67], v[196:199]
ds_read_b64_tr_b16 v[102:103], v12 offset:25872
v_mfma_f32_16x16x32_bf16 v[200:203], v[48:51], v[68:71], v[200:203]
v_mfma_f32_16x16x32_bf16 v[204:207], v[48:51], v[72:75], v[204:207]
v_mfma_f32_16x16x32_bf16 v[208:211], v[52:55], v[60:63], v[208:211]
v_mfma_f32_16x16x32_bf16 v[212:215], v[52:55], v[64:67], v[212:215]
v_mfma_f32_16x16x32_bf16 v[216:219], v[52:55], v[68:71], v[216:219]
v_mfma_f32_16x16x32_bf16 v[220:223], v[52:55], v[72:75], v[220:223]
v_mfma_f32_16x16x32_bf16 v[224:227], v[56:59], v[60:63], v[224:227]
v_mfma_f32_16x16x32_bf16 v[228:231], v[56:59], v[64:67], v[228:231]
v_mfma_f32_16x16x32_bf16 v[232:235], v[56:59], v[68:71], v[232:235]
v_mfma_f32_16x16x32_bf16 v[236:239], v[56:59], v[72:75], v[236:239]
s_waitcnt lgkmcnt(0)
s_barrier
v_mfma_f32_16x16x32_bf16 v[240:243], v[104:107], v[104:107], v[240:243]
ds_read_b64_tr_b16 v[60:61], v16 offset:0
v_mfma_f32_16x16x32_bf16 v[244:247], v[120:123], v[104:107], v[244:247]
ds_read_b64_tr_b16 v[62:63], v16 offset:512
v_mfma_f32_16x16x32_bf16 v[248:251], v[108:111], v[108:111], v[248:251]
ds_read_b64_tr_b16 v[64:65], v16 offset:32
v_mfma_f32_16x16x32_bf16 v[252:255], v[120:123], v[108:111], v[252:255]
ds_read_b64_tr_b16 v[66:67], v16 offset:544
v_mfma_f32_16x16x32_bf16 v[128:131], v[76:79], v[104:107], v[128:131]
ds_read_b64_tr_b16 v[68:69], v19 offset:0
v_mfma_f32_16x16x32_bf16 v[132:135], v[76:79], v[108:111], v[132:135]
ds_read_b64_tr_b16 v[70:71], v19 offset:512
v_mfma_f32_16x16x32_bf16 v[136:139], v[76:79], v[112:115], v[136:139]
ds_read_b64_tr_b16 v[72:73], v19 offset:32
v_mfma_f32_16x16x32_bf16 v[140:143], v[76:79], v[116:119], v[140:143]
ds_read_b64_tr_b16 v[74:75], v19 offset:544
v_mfma_f32_16x16x32_bf16 v[144:147], v[80:83], v[104:107], v[144:147]
ds_read_b64_tr_b16 v[32:33], v10 offset:0
v_mfma_f32_16x16x32_bf16 v[148:151], v[80:83], v[108:111], v[148:151]
ds_read_b64_tr_b16 v[34:35], v10 offset:512
v_mfma_f32_16x16x32_bf16 v[152:155], v[80:83], v[112:115], v[152:155]
ds_read_b64_tr_b16 v[36:37], v10 offset:16
v_mfma_f32_16x16x32_bf16 v[156:159], v[80:83], v[116:119], v[156:159]
ds_read_b64_tr_b16 v[38:39], v10 offset:528
v_mfma_f32_16x16x32_bf16 v[160:163], v[84:87], v[104:107], v[160:163]
ds_read_b64_tr_b16 v[40:41], v10 offset:32
v_mfma_f32_16x16x32_bf16 v[164:167], v[84:87], v[108:111], v[164:167]
ds_read_b64_tr_b16 v[42:43], v10 offset:544
v_mfma_f32_16x16x32_bf16 v[168:171], v[84:87], v[112:115], v[168:171]
ds_read_b64_tr_b16 v[44:45], v10 offset:48
v_mfma_f32_16x16x32_bf16 v[172:175], v[84:87], v[116:119], v[172:175]
ds_read_b64_tr_b16 v[46:47], v10 offset:560
v_mfma_f32_16x16x32_bf16 v[176:179], v[88:91], v[104:107], v[176:179]
ds_read_b64_tr_b16 v[48:49], v10 offset:64
v_mfma_f32_16x16x32_bf16 v[180:183], v[88:91], v[108:111], v[180:183]
ds_read_b64_tr_b16 v[50:51], v10 offset:576
v_mfma_f32_16x16x32_bf16 v[184:187], v[88:91], v[112:115], v[184:187]
ds_read_b64_tr_b16 v[52:53], v10 offset:80
v_mfma_f32_16x16x32_bf16 v[188:191], v[88:91], v[116:119], v[188:191]
ds_read_b64_tr_b16 v[54:55], v10 offset:592
v_mfma_f32_16x16x32_bf16 v[192:195], v[92:95], v[104:107], v[192:195]
ds_read_b64_tr_b16 v[56:57], v13 offset:0
v_mfma_f32_16x16x32_bf16 v[196:199], v[92:95], v[108:111], v[196:199]
ds_read_b64_tr_b16 v[58:59], v13 offset:512
v_mfma_f32_16x16x32_bf16 v[200:203], v[92:95], v[112:115], v[200:203]
v_mfma_f32_16x16x32_bf16 v[204:207], v[92:95], v[116:119], v[204:207]
v_mfma_f32_16x16x32_bf16 v[208:211], v[96:99], v[104:107], v[208:211]
v_mfma_f32_16x16x32_bf16 v[212:215], v[96:99], v[108:111], v[212:215]
v_mfma_f32_16x16x32_bf16 v[216:219], v[96:99], v[112:115], v[216:219]
v_mfma_f32_16x16x32_bf16 v[220:223], v[96:99], v[116:119], v[220:223]
v_mfma_f32_16x16x32_bf16 v[224:227], v[100:103], v[104:107], v[224:227]
v_mfma_f32_16x16x32_bf16 v[228:231], v[100:103], v[108:111], v[228:231]
v_mfma_f32_16x16x32_bf16 v[232:235], v[100:103], v[112:115], v[232:235]
v_mfma_f32_16x16x32_bf16 v[236:239], v[100:103], v[116:119], v[236:239]
s_waitcnt lgkmcnt(0)
s_barrier
v_mfma_f32_16x16x32_bf16 v[240:243], v[60:63], v[60:63], v[240:243]
ds_read_b64_tr_b16 v[104:105], v14 offset:0
v_mfma_f32_16x16x32_bf16 v[244:247], v[120:123], v[60:63], v[244:247]
ds_read_b64_tr_b16 v[106:107], v14 offset:512
v_mfma_f32_16x16x32_bf16 v[248:251], v[64:67], v[64:67], v[248:251]
ds_read_b64_tr_b16 v[108:109], v14 offset:32
v_mfma_f32_16x16x32_bf16 v[252:255], v[120:123], v[64:67], v[252:255]
ds_read_b64_tr_b16 v[110:111], v14 offset:544
v_mfma_f32_16x16x32_bf16 v[128:131], v[32:35], v[60:63], v[128:131]
ds_read_b64_tr_b16 v[112:113], v17 offset:0
v_mfma_f32_16x16x32_bf16 v[132:135], v[32:35], v[64:67], v[132:135]
ds_read_b64_tr_b16 v[114:115], v17 offset:512
v_mfma_f32_16x16x32_bf16 v[136:139], v[32:35], v[68:71], v[136:139]
ds_read_b64_tr_b16 v[116:117], v17 offset:32
v_mfma_f32_16x16x32_bf16 v[140:143], v[32:35], v[72:75], v[140:143]
ds_read_b64_tr_b16 v[118:119], v17 offset:544
v_mfma_f32_16x16x32_bf16 v[144:147], v[36:39], v[60:63], v[144:147]
ds_read_b64_tr_b16 v[76:77], v8 offset:0
v_mfma_f32_16x16x32_bf16 v[148:151], v[36:39], v[64:67], v[148:151]
ds_read_b64_tr_b16 v[78:79], v8 offset:512
v_mfma_f32_16x16x32_bf16 v[152:155], v[36:39], v[68:71], v[152:155]
ds_read_b64_tr_b16 v[80:81], v8 offset:16
v_mfma_f32_16x16x32_bf16 v[156:159], v[36:39], v[72:75], v[156:159]
ds_read_b64_tr_b16 v[82:83], v8 offset:528
v_mfma_f32_16x16x32_bf16 v[160:163], v[40:43], v[60:63], v[160:163]
ds_read_b64_tr_b16 v[84:85], v8 offset:32
v_mfma_f32_16x16x32_bf16 v[164:167], v[40:43], v[64:67], v[164:167]
ds_read_b64_tr_b16 v[86:87], v8 offset:544
v_mfma_f32_16x16x32_bf16 v[168:171], v[40:43], v[68:71], v[168:171]
ds_read_b64_tr_b16 v[88:89], v8 offset:48
v_mfma_f32_16x16x32_bf16 v[172:175], v[40:43], v[72:75], v[172:175]
ds_read_b64_tr_b16 v[90:91], v8 offset:560
v_mfma_f32_16x16x32_bf16 v[176:179], v[44:47], v[60:63], v[176:179]
ds_read_b64_tr_b16 v[92:93], v8 offset:64
v_mfma_f32_16x16x32_bf16 v[180:183], v[44:47], v[64:67], v[180:183]
ds_read_b64_tr_b16 v[94:95], v8 offset:576
v_mfma_f32_16x16x32_bf16 v[184:187], v[44:47], v[68:71], v[184:187]
ds_read_b64_tr_b16 v[96:97], v8 offset:80
v_mfma_f32_16x16x32_bf16 v[188:191], v[44:47], v[72:75], v[188:191]
ds_read_b64_tr_b16 v[98:99], v8 offset:592
v_mfma_f32_16x16x32_bf16 v[192:195], v[48:51], v[60:63], v[192:195]
ds_read_b64_tr_b16 v[100:101], v11 offset:0
v_mfma_f32_16x16x32_bf16 v[196:199], v[48:51], v[64:67], v[196:199]
ds_read_b64_tr_b16 v[102:103], v11 offset:512
v_mfma_f32_16x16x32_bf16 v[200:203], v[48:51], v[68:71], v[200:203]
v_mfma_f32_16x16x32_bf16 v[204:207], v[48:51], v[72:75], v[204:207]
v_mfma_f32_16x16x32_bf16 v[208:211], v[52:55], v[60:63], v[208:211]
v_mfma_f32_16x16x32_bf16 v[212:215], v[52:55], v[64:67], v[212:215]
v_mfma_f32_16x16x32_bf16 v[216:219], v[52:55], v[68:71], v[216:219]
v_mfma_f32_16x16x32_bf16 v[220:223], v[52:55], v[72:75], v[220:223]
v_mfma_f32_16x16x32_bf16 v[224:227], v[56:59], v[60:63], v[224:227]
v_mfma_f32_16x16x32_bf16 v[228:231], v[56:59], v[64:67], v[228:231]
v_mfma_f32_16x16x32_bf16 v[232:235], v[56:59], v[68:71], v[232:235]
v_mfma_f32_16x16x32_bf16 v[236:239], v[56:59], v[72:75], v[236:239]
s_waitcnt lgkmcnt(0)
s_barrier
v_mfma_f32_16x16x32_bf16 v[240:243], v[104:107], v[104:107], v[240:243]
ds_read_b64_tr_b16 v[60:61], v14 offset:25360
v_mfma_f32_16x16x32_bf16 v[244:247], v[120:123], v[104:107], v[244:247]
ds_read_b64_tr_b16 v[62:63], v14 offset:25872
v_mfma_f32_16x16x32_bf16 v[248:251], v[108:111], v[108:111], v[248:251]
ds_read_b64_tr_b16 v[64:65], v14 offset:25392
v_mfma_f32_16x16x32_bf16 v[252:255], v[120:123], v[108:111], v[252:255]
ds_read_b64_tr_b16 v[66:67], v14 offset:25904
v_mfma_f32_16x16x32_bf16 v[128:131], v[76:79], v[104:107], v[128:131]
ds_read_b64_tr_b16 v[68:69], v17 offset:25360
v_mfma_f32_16x16x32_bf16 v[132:135], v[76:79], v[108:111], v[132:135]
ds_read_b64_tr_b16 v[70:71], v17 offset:25872
v_mfma_f32_16x16x32_bf16 v[136:139], v[76:79], v[112:115], v[136:139]
ds_read_b64_tr_b16 v[72:73], v17 offset:25392
v_mfma_f32_16x16x32_bf16 v[140:143], v[76:79], v[116:119], v[140:143]
ds_read_b64_tr_b16 v[74:75], v17 offset:25904
v_mfma_f32_16x16x32_bf16 v[144:147], v[80:83], v[104:107], v[144:147]
ds_read_b64_tr_b16 v[32:33], v8 offset:25360
v_mfma_f32_16x16x32_bf16 v[148:151], v[80:83], v[108:111], v[148:151]
ds_read_b64_tr_b16 v[34:35], v8 offset:25872
v_mfma_f32_16x16x32_bf16 v[152:155], v[80:83], v[112:115], v[152:155]
ds_read_b64_tr_b16 v[36:37], v8 offset:25376
v_mfma_f32_16x16x32_bf16 v[156:159], v[80:83], v[116:119], v[156:159]
ds_read_b64_tr_b16 v[38:39], v8 offset:25888
v_mfma_f32_16x16x32_bf16 v[160:163], v[84:87], v[104:107], v[160:163]
ds_read_b64_tr_b16 v[40:41], v8 offset:25392
v_mfma_f32_16x16x32_bf16 v[164:167], v[84:87], v[108:111], v[164:167]
ds_read_b64_tr_b16 v[42:43], v8 offset:25904
v_mfma_f32_16x16x32_bf16 v[168:171], v[84:87], v[112:115], v[168:171]
ds_read_b64_tr_b16 v[44:45], v8 offset:25408
v_mfma_f32_16x16x32_bf16 v[172:175], v[84:87], v[116:119], v[172:175]
ds_read_b64_tr_b16 v[46:47], v8 offset:25920
v_mfma_f32_16x16x32_bf16 v[176:179], v[88:91], v[104:107], v[176:179]
ds_read_b64_tr_b16 v[48:49], v8 offset:25424
v_mfma_f32_16x16x32_bf16 v[180:183], v[88:91], v[108:111], v[180:183]
ds_read_b64_tr_b16 v[50:51], v8 offset:25936
v_mfma_f32_16x16x32_bf16 v[184:187], v[88:91], v[112:115], v[184:187]
ds_read_b64_tr_b16 v[52:53], v8 offset:25440
v_mfma_f32_16x16x32_bf16 v[188:191], v[88:91], v[116:119], v[188:191]
ds_read_b64_tr_b16 v[54:55], v8 offset:25952
v_mfma_f32_16x16x32_bf16 v[192:195], v[92:95], v[104:107], v[192:195]
ds_read_b64_tr_b16 v[56:57], v11 offset:25360
v_mfma_f32_16x16x32_bf16 v[196:199], v[92:95], v[108:111], v[196:199]
ds_read_b64_tr_b16 v[58:59], v11 offset:25872
v_mfma_f32_16x16x32_bf16 v[200:203], v[92:95], v[112:115], v[200:203]
v_mfma_f32_16x16x32_bf16 v[204:207], v[92:95], v[116:119], v[204:207]
v_mfma_f32_16x16x32_bf16 v[208:211], v[96:99], v[104:107], v[208:211]
v_mfma_f32_16x16x32_bf16 v[212:215], v[96:99], v[108:111], v[212:215]
v_mfma_f32_16x16x32_bf16 v[216:219], v[96:99], v[112:115], v[216:219]
v_mfma_f32_16x16x32_bf16 v[220:223], v[96:99], v[116:119], v[220:223]
v_mfma_f32_16x16x32_bf16 v[224:227], v[100:103], v[104:107], v[224:227]
v_mfma_f32_16x16x32_bf16 v[228:231], v[100:103], v[108:111], v[228:231]
v_mfma_f32_16x16x32_bf16 v[232:235], v[100:103], v[112:115], v[232:235]
v_mfma_f32_16x16x32_bf16 v[236:239], v[100:103], v[116:119], v[236:239]
s_waitcnt lgkmcnt(0)
s_barrier
v_mfma_f32_16x16x32_bf16 v[240:243], v[60:63], v[60:63], v[240:243]
ds_read_b64_tr_b16 v[104:105], v15 offset:0
v_mfma_f32_16x16x32_bf16 v[244:247], v[120:123], v[60:63], v[244:247]
ds_read_b64_tr_b16 v[106:107], v15 offset:512
v_mfma_f32_16x16x32_bf16 v[248:251], v[64:67], v[64:67], v[248:251]
ds_read_b64_tr_b16 v[108:109], v15 offset:32
v_mfma_f32_16x16x32_bf16 v[252:255], v[120:123], v[64:67], v[252:255]
ds_read_b64_tr_b16 v[110:111], v15 offset:544
v_mfma_f32_16x16x32_bf16 v[128:131], v[32:35], v[60:63], v[128:131]
ds_read_b64_tr_b16 v[112:113], v18 offset:0
v_mfma_f32_16x16x32_bf16 v[132:135], v[32:35], v[64:67], v[132:135]
ds_read_b64_tr_b16 v[114:115], v18 offset:512
v_mfma_f32_16x16x32_bf16 v[136:139], v[32:35], v[68:71], v[136:139]
ds_read_b64_tr_b16 v[116:117], v18 offset:32
v_mfma_f32_16x16x32_bf16 v[140:143], v[32:35], v[72:75], v[140:143]
ds_read_b64_tr_b16 v[118:119], v18 offset:544
v_mfma_f32_16x16x32_bf16 v[144:147], v[36:39], v[60:63], v[144:147]
ds_read_b64_tr_b16 v[76:77], v9 offset:0
v_mfma_f32_16x16x32_bf16 v[148:151], v[36:39], v[64:67], v[148:151]
ds_read_b64_tr_b16 v[78:79], v9 offset:512
v_mfma_f32_16x16x32_bf16 v[152:155], v[36:39], v[68:71], v[152:155]
ds_read_b64_tr_b16 v[80:81], v9 offset:16
v_mfma_f32_16x16x32_bf16 v[156:159], v[36:39], v[72:75], v[156:159]
ds_read_b64_tr_b16 v[82:83], v9 offset:528
v_mfma_f32_16x16x32_bf16 v[160:163], v[40:43], v[60:63], v[160:163]
ds_read_b64_tr_b16 v[84:85], v9 offset:32
v_mfma_f32_16x16x32_bf16 v[164:167], v[40:43], v[64:67], v[164:167]
ds_read_b64_tr_b16 v[86:87], v9 offset:544
v_mfma_f32_16x16x32_bf16 v[168:171], v[40:43], v[68:71], v[168:171]
ds_read_b64_tr_b16 v[88:89], v9 offset:48
v_mfma_f32_16x16x32_bf16 v[172:175], v[40:43], v[72:75], v[172:175]
ds_read_b64_tr_b16 v[90:91], v9 offset:560
v_mfma_f32_16x16x32_bf16 v[176:179], v[44:47], v[60:63], v[176:179]
ds_read_b64_tr_b16 v[92:93], v9 offset:64
v_mfma_f32_16x16x32_bf16 v[180:183], v[44:47], v[64:67], v[180:183]
ds_read_b64_tr_b16 v[94:95], v9 offset:576
v_mfma_f32_16x16x32_bf16 v[184:187], v[44:47], v[68:71], v[184:187]
ds_read_b64_tr_b16 v[96:97], v9 offset:80
v_mfma_f32_16x16x32_bf16 v[188:191], v[44:47], v[72:75], v[188:191]
ds_read_b64_tr_b16 v[98:99], v9 offset:592
v_mfma_f32_16x16x32_bf16 v[192:195], v[48:51], v[60:63], v[192:195]
ds_read_b64_tr_b16 v[100:101], v12 offset:0
v_mfma_f32_16x16x32_bf16 v[196:199], v[48:51], v[64:67], v[196:199]
ds_read_b64_tr_b16 v[102:103], v12 offset:512
v_mfma_f32_16x16x32_bf16 v[200:203], v[48:51], v[68:71], v[200:203]
v_mfma_f32_16x16x32_bf16 v[204:207], v[48:51], v[72:75], v[204:207]
v_mfma_f32_16x16x32_bf16 v[208:211], v[52:55], v[60:63], v[208:211]
v_mfma_f32_16x16x32_bf16 v[212:215], v[52:55], v[64:67], v[212:215]
v_mfma_f32_16x16x32_bf16 v[216:219], v[52:55], v[68:71], v[216:219]
v_mfma_f32_16x16x32_bf16 v[220:223], v[52:55], v[72:75], v[220:223]
v_mfma_f32_16x16x32_bf16 v[224:227], v[56:59], v[60:63], v[224:227]
v_mfma_f32_16x16x32_bf16 v[228:231], v[56:59], v[64:67], v[228:231]
v_mfma_f32_16x16x32_bf16 v[232:235], v[56:59], v[68:71], v[232:235]
v_mfma_f32_16x16x32_bf16 v[236:239], v[56:59], v[72:75], v[236:239]
s_waitcnt lgkmcnt(0)
s_barrier
v_mfma_f32_16x16x32_bf16 v[240:243], v[104:107], v[104:107], v[240:243]
ds_read_b64_tr_b16 v[60:61], v15 offset:25360
v_mfma_f32_16x16x32_bf16 v[244:247], v[120:123], v[104:107], v[244:247]
ds_read_b64_tr_b16 v[62:63], v15 offset:25872
v_mfma_f32_16x16x32_bf16 v[248:251], v[108:111], v[108:111], v[248:251]
ds_read_b64_tr_b16 v[64:65], v15 offset:25392
v_mfma_f32_16x16x32_bf16 v[252:255], v[120:123], v[108:111], v[252:255]
ds_read_b64_tr_b16 v[66:67], v15 offset:25904
v_mfma_f32_16x16x32_bf16 v[128:131], v[76:79], v[104:107], v[128:131]
ds_read_b64_tr_b16 v[68:69], v18 offset:25360
v_mfma_f32_16x16x32_bf16 v[132:135], v[76:79], v[108:111], v[132:135]
ds_read_b64_tr_b16 v[70:71], v18 offset:25872
v_mfma_f32_16x16x32_bf16 v[136:139], v[76:79], v[112:115], v[136:139]
ds_read_b64_tr_b16 v[72:73], v18 offset:25392
v_mfma_f32_16x16x32_bf16 v[140:143], v[76:79], v[116:119], v[140:143]
ds_read_b64_tr_b16 v[74:75], v18 offset:25904
v_mfma_f32_16x16x32_bf16 v[144:147], v[80:83], v[104:107], v[144:147]
ds_read_b64_tr_b16 v[32:33], v9 offset:25360
v_mfma_f32_16x16x32_bf16 v[148:151], v[80:83], v[108:111], v[148:151]
ds_read_b64_tr_b16 v[34:35], v9 offset:25872
v_mfma_f32_16x16x32_bf16 v[152:155], v[80:83], v[112:115], v[152:155]
ds_read_b64_tr_b16 v[36:37], v9 offset:25376
v_mfma_f32_16x16x32_bf16 v[156:159], v[80:83], v[116:119], v[156:159]
ds_read_b64_tr_b16 v[38:39], v9 offset:25888
v_mfma_f32_16x16x32_bf16 v[160:163], v[84:87], v[104:107], v[160:163]
ds_read_b64_tr_b16 v[40:41], v9 offset:25392
v_mfma_f32_16x16x32_bf16 v[164:167], v[84:87], v[108:111], v[164:167]
ds_read_b64_tr_b16 v[42:43], v9 offset:25904
v_mfma_f32_16x16x32_bf16 v[168:171], v[84:87], v[112:115], v[168:171]
ds_read_b64_tr_b16 v[44:45], v9 offset:25408
v_mfma_f32_16x16x32_bf16 v[172:175], v[84:87], v[116:119], v[172:175]
ds_read_b64_tr_b16 v[46:47], v9 offset:25920
v_mfma_f32_16x16x32_bf16 v[176:179], v[88:91], v[104:107], v[176:179]
ds_read_b64_tr_b16 v[48:49], v9 offset:25424
v_mfma_f32_16x16x32_bf16 v[180:183], v[88:91], v[108:111], v[180:183]
ds_read_b64_tr_b16 v[50:51], v9 offset:25936
v_mfma_f32_16x16x32_bf16 v[184:187], v[88:91], v[112:115], v[184:187]
ds_read_b64_tr_b16 v[52:53], v9 offset:25440
v_mfma_f32_16x16x32_bf16 v[188:191], v[88:91], v[116:119], v[188:191]
ds_read_b64_tr_b16 v[54:55], v9 offset:25952
v_mfma_f32_16x16x32_bf16 v[192:195], v[92:95], v[104:107], v[192:195]
ds_read_b64_tr_b16 v[56:57], v12 offset:25360
v_mfma_f32_16x16x32_bf16 v[196:199], v[92:95], v[108:111], v[196:199]
ds_read_b64_tr_b16 v[58:59], v12 offset:25872
v_mfma_f32_16x16x32_bf16 v[200:203], v[92:95], v[112:115], v[200:203]
v_mfma_f32_16x16x32_bf16 v[204:207], v[92:95], v[116:119], v[204:207]
v_mfma_f32_16x16x32_bf16 v[208:211], v[96:99], v[104:107], v[208:211]
v_mfma_f32_16x16x32_bf16 v[212:215], v[96:99], v[108:111], v[212:215]
v_mfma_f32_16x16x32_bf16 v[216:219], v[96:99], v[112:115], v[216:219]
v_mfma_f32_16x16x32_bf16 v[220:223], v[96:99], v[116:119], v[220:223]
v_mfma_f32_16x16x32_bf16 v[224:227], v[100:103], v[104:107], v[224:227]
v_mfma_f32_16x16x32_bf16 v[228:231], v[100:103], v[108:111], v[228:231]
v_mfma_f32_16x16x32_bf16 v[232:235], v[100:103], v[112:115], v[232:235]
v_mfma_f32_16x16x32_bf16 v[236:239], v[100:103], v[116:119], v[236:239]
s_waitcnt lgkmcnt(0)
s_barrier
v_mfma_f32_16x16x32_bf16 v[240:243], v[60:63], v[60:63], v[240:243]
ds_read_b64_tr_b16 v[104:105], v16 offset:0
v_mfma_f32_16x16x32_bf16 v[244:247], v[120:123], v[60:63], v[244:247]
ds_read_b64_tr_b16 v[106:107], v16 offset:512
v_mfma_f32_16x16x32_bf16 v[248:251], v[64:67], v[64:67], v[248:251]
ds_read_b64_tr_b16 v[108:109], v16 offset:32
v_mfma_f32_16x16x32_bf16 v[252:255], v[120:123], v[64:67], v[252:255]
ds_read_b64_tr_b16 v[110:111], v16 offset:544
v_mfma_f32_16x16x32_bf16 v[128:131], v[32:35], v[60:63], v[128:131]
ds_read_b64_tr_b16 v[112:113], v19 offset:0
v_mfma_f32_16x16x32_bf16 v[132:135], v[32:35], v[64:67], v[132:135]
ds_read_b64_tr_b16 v[114:115], v19 offset:512
v_mfma_f32_16x16x32_bf16 v[136:139], v[32:35], v[68:71], v[136:139]
ds_read_b64_tr_b16 v[116:117], v19 offset:32
v_mfma_f32_16x16x32_bf16 v[140:143], v[32:35], v[72:75], v[140:143]
ds_read_b64_tr_b16 v[118:119], v19 offset:544
v_mfma_f32_16x16x32_bf16 v[144:147], v[36:39], v[60:63], v[144:147]
ds_read_b64_tr_b16 v[76:77], v10 offset:0
v_mfma_f32_16x16x32_bf16 v[148:151], v[36:39], v[64:67], v[148:151]
ds_read_b64_tr_b16 v[78:79], v10 offset:512
v_mfma_f32_16x16x32_bf16 v[152:155], v[36:39], v[68:71], v[152:155]
ds_read_b64_tr_b16 v[80:81], v10 offset:16
v_mfma_f32_16x16x32_bf16 v[156:159], v[36:39], v[72:75], v[156:159]
ds_read_b64_tr_b16 v[82:83], v10 offset:528
v_mfma_f32_16x16x32_bf16 v[160:163], v[40:43], v[60:63], v[160:163]
ds_read_b64_tr_b16 v[84:85], v10 offset:32
v_mfma_f32_16x16x32_bf16 v[164:167], v[40:43], v[64:67], v[164:167]
ds_read_b64_tr_b16 v[86:87], v10 offset:544
v_mfma_f32_16x16x32_bf16 v[168:171], v[40:43], v[68:71], v[168:171]
ds_read_b64_tr_b16 v[88:89], v10 offset:48
v_mfma_f32_16x16x32_bf16 v[172:175], v[40:43], v[72:75], v[172:175]
ds_read_b64_tr_b16 v[90:91], v10 offset:560
v_mfma_f32_16x16x32_bf16 v[176:179], v[44:47], v[60:63], v[176:179]
ds_read_b64_tr_b16 v[92:93], v10 offset:64
v_mfma_f32_16x16x32_bf16 v[180:183], v[44:47], v[64:67], v[180:183]
ds_read_b64_tr_b16 v[94:95], v10 offset:576
v_mfma_f32_16x16x32_bf16 v[184:187], v[44:47], v[68:71], v[184:187]
ds_read_b64_tr_b16 v[96:97], v10 offset:80
v_mfma_f32_16x16x32_bf16 v[188:191], v[44:47], v[72:75], v[188:191]
ds_read_b64_tr_b16 v[98:99], v10 offset:592
v_mfma_f32_16x16x32_bf16 v[192:195], v[48:51], v[60:63], v[192:195]
ds_read_b64_tr_b16 v[100:101], v13 offset:0
v_mfma_f32_16x16x32_bf16 v[196:199], v[48:51], v[64:67], v[196:199]
ds_read_b64_tr_b16 v[102:103], v13 offset:512
v_mfma_f32_16x16x32_bf16 v[200:203], v[48:51], v[68:71], v[200:203]
v_mfma_f32_16x16x32_bf16 v[204:207], v[48:51], v[72:75], v[204:207]
v_mfma_f32_16x16x32_bf16 v[208:211], v[52:55], v[60:63], v[208:211]
v_mfma_f32_16x16x32_bf16 v[212:215], v[52:55], v[64:67], v[212:215]
v_mfma_f32_16x16x32_bf16 v[216:219], v[52:55], v[68:71], v[216:219]
v_mfma_f32_16x16x32_bf16 v[220:223], v[52:55], v[72:75], v[220:223]
v_mfma_f32_16x16x32_bf16 v[224:227], v[56:59], v[60:63], v[224:227]
v_mfma_f32_16x16x32_bf16 v[228:231], v[56:59], v[64:67], v[228:231]
v_mfma_f32_16x16x32_bf16 v[232:235], v[56:59], v[68:71], v[232:235]
v_mfma_f32_16x16x32_bf16 v[236:239], v[56:59], v[72:75], v[236:239]
s_waitcnt lgkmcnt(0)
s_barrier
v_mfma_f32_16x16x32_bf16 v[240:243], v[104:107], v[104:107], v[240:243]
ds_read_b64_tr_b16 v[60:61], v14 offset:0
v_mfma_f32_16x16x32_bf16 v[244:247], v[120:123], v[104:107], v[244:247]
ds_read_b64_tr_b16 v[62:63], v14 offset:512
v_mfma_f32_16x16x32_bf16 v[248:251], v[108:111], v[108:111], v[248:251]
ds_read_b64_tr_b16 v[64:65], v14 offset:32
v_mfma_f32_16x16x32_bf16 v[252:255], v[120:123], v[108:111], v[252:255]
ds_read_b64_tr_b16 v[66:67], v14 offset:544
v_mfma_f32_16x16x32_bf16 v[128:131], v[76:79], v[104:107], v[128:131]
ds_read_b64_tr_b16 v[68:69], v17 offset:0
v_mfma_f32_16x16x32_bf16 v[132:135], v[76:79], v[108:111], v[132:135]
ds_read_b64_tr_b16 v[70:71], v17 offset:512
v_mfma_f32_16x16x32_bf16 v[136:139], v[76:79], v[112:115], v[136:139]
ds_read_b64_tr_b16 v[72:73], v17 offset:32
v_mfma_f32_16x16x32_bf16 v[140:143], v[76:79], v[116:119], v[140:143]
ds_read_b64_tr_b16 v[74:75], v17 offset:544
v_mfma_f32_16x16x32_bf16 v[144:147], v[80:83], v[104:107], v[144:147]
ds_read_b64_tr_b16 v[32:33], v8 offset:0
v_mfma_f32_16x16x32_bf16 v[148:151], v[80:83], v[108:111], v[148:151]
ds_read_b64_tr_b16 v[34:35], v8 offset:512
v_mfma_f32_16x16x32_bf16 v[152:155], v[80:83], v[112:115], v[152:155]
ds_read_b64_tr_b16 v[36:37], v8 offset:16
v_mfma_f32_16x16x32_bf16 v[156:159], v[80:83], v[116:119], v[156:159]
ds_read_b64_tr_b16 v[38:39], v8 offset:528
v_mfma_f32_16x16x32_bf16 v[160:163], v[84:87], v[104:107], v[160:163]
ds_read_b64_tr_b16 v[40:41], v8 offset:32
v_mfma_f32_16x16x32_bf16 v[164:167], v[84:87], v[108:111], v[164:167]
ds_read_b64_tr_b16 v[42:43], v8 offset:544
v_mfma_f32_16x16x32_bf16 v[168:171], v[84:87], v[112:115], v[168:171]
ds_read_b64_tr_b16 v[44:45], v8 offset:48
v_mfma_f32_16x16x32_bf16 v[172:175], v[84:87], v[116:119], v[172:175]
ds_read_b64_tr_b16 v[46:47], v8 offset:560
v_mfma_f32_16x16x32_bf16 v[176:179], v[88:91], v[104:107], v[176:179]
ds_read_b64_tr_b16 v[48:49], v8 offset:64
v_mfma_f32_16x16x32_bf16 v[180:183], v[88:91], v[108:111], v[180:183]
ds_read_b64_tr_b16 v[50:51], v8 offset:576
v_mfma_f32_16x16x32_bf16 v[184:187], v[88:91], v[112:115], v[184:187]
ds_read_b64_tr_b16 v[52:53], v8 offset:80
v_mfma_f32_16x16x32_bf16 v[188:191], v[88:91], v[116:119], v[188:191]
ds_read_b64_tr_b16 v[54:55], v8 offset:592
v_mfma_f32_16x16x32_bf16 v[192:195], v[92:95], v[104:107], v[192:195]
ds_read_b64_tr_b16 v[56:57], v11 offset:0
v_mfma_f32_16x16x32_bf16 v[196:199], v[92:95], v[108:111], v[196:199]
ds_read_b64_tr_b16 v[58:59], v11 offset:512
v_mfma_f32_16x16x32_bf16 v[200:203], v[92:95], v[112:115], v[200:203]
v_mfma_f32_16x16x32_bf16 v[204:207], v[92:95], v[116:119], v[204:207]
v_mfma_f32_16x16x32_bf16 v[208:211], v[96:99], v[104:107], v[208:211]
v_mfma_f32_16x16x32_bf16 v[212:215], v[96:99], v[108:111], v[212:215]
v_mfma_f32_16x16x32_bf16 v[216:219], v[96:99], v[112:115], v[216:219]
v_mfma_f32_16x16x32_bf16 v[220:223], v[96:99], v[116:119], v[220:223]
v_mfma_f32_16x16x32_bf16 v[224:227], v[100:103], v[104:107], v[224:227]
v_mfma_f32_16x16x32_bf16 v[228:231], v[100:103], v[108:111], v[228:231]
v_mfma_f32_16x16x32_bf16 v[232:235], v[100:103], v[112:115], v[232:235]
v_mfma_f32_16x16x32_bf16 v[236:239], v[100:103], v[116:119], v[236:239]
s_waitcnt lgkmcnt(0)
s_barrier
v_mfma_f32_16x16x32_bf16 v[240:243], v[60:63], v[60:63], v[240:243]
ds_read_b64_tr_b16 v[104:105], v14 offset:25360
v_mfma_f32_16x16x32_bf16 v[244:247], v[120:123], v[60:63], v[244:247]
ds_read_b64_tr_b16 v[106:107], v14 offset:25872
v_mfma_f32_16x16x32_bf16 v[248:251], v[64:67], v[64:67], v[248:251]
ds_read_b64_tr_b16 v[108:109], v14 offset:25392
v_mfma_f32_16x16x32_bf16 v[252:255], v[120:123], v[64:67], v[252:255]
ds_read_b64_tr_b16 v[110:111], v14 offset:25904
v_mfma_f32_16x16x32_bf16 v[128:131], v[32:35], v[60:63], v[128:131]
ds_read_b64_tr_b16 v[112:113], v17 offset:25360
v_mfma_f32_16x16x32_bf16 v[132:135], v[32:35], v[64:67], v[132:135]
ds_read_b64_tr_b16 v[114:115], v17 offset:25872
v_mfma_f32_16x16x32_bf16 v[136:139], v[32:35], v[68:71], v[136:139]
ds_read_b64_tr_b16 v[116:117], v17 offset:25392
v_mfma_f32_16x16x32_bf16 v[140:143], v[32:35], v[72:75], v[140:143]
ds_read_b64_tr_b16 v[118:119], v17 offset:25904
v_mfma_f32_16x16x32_bf16 v[144:147], v[36:39], v[60:63], v[144:147]
ds_read_b64_tr_b16 v[76:77], v8 offset:25360
v_mfma_f32_16x16x32_bf16 v[148:151], v[36:39], v[64:67], v[148:151]
ds_read_b64_tr_b16 v[78:79], v8 offset:25872
v_mfma_f32_16x16x32_bf16 v[152:155], v[36:39], v[68:71], v[152:155]
ds_read_b64_tr_b16 v[80:81], v8 offset:25376
v_mfma_f32_16x16x32_bf16 v[156:159], v[36:39], v[72:75], v[156:159]
ds_read_b64_tr_b16 v[82:83], v8 offset:25888
v_mfma_f32_16x16x32_bf16 v[160:163], v[40:43], v[60:63], v[160:163]
ds_read_b64_tr_b16 v[84:85], v8 offset:25392
v_mfma_f32_16x16x32_bf16 v[164:167], v[40:43], v[64:67], v[164:167]
ds_read_b64_tr_b16 v[86:87], v8 offset:25904
v_mfma_f32_16x16x32_bf16 v[168:171], v[40:43], v[68:71], v[168:171]
ds_read_b64_tr_b16 v[88:89], v8 offset:25408
v_mfma_f32_16x16x32_bf16 v[172:175], v[40:43], v[72:75], v[172:175]
ds_read_b64_tr_b16 v[90:91], v8 offset:25920
v_mfma_f32_16x16x32_bf16 v[176:179], v[44:47], v[60:63], v[176:179]
ds_read_b64_tr_b16 v[92:93], v8 offset:25424
v_mfma_f32_16x16x32_bf16 v[180:183], v[44:47], v[64:67], v[180:183]
ds_read_b64_tr_b16 v[94:95], v8 offset:25936
v_mfma_f32_16x16x32_bf16 v[184:187], v[44:47], v[68:71], v[184:187]
ds_read_b64_tr_b16 v[96:97], v8 offset:25440
v_mfma_f32_16x16x32_bf16 v[188:191], v[44:47], v[72:75], v[188:191]
ds_read_b64_tr_b16 v[98:99], v8 offset:25952
v_mfma_f32_16x16x32_bf16 v[192:195], v[48:51], v[60:63], v[192:195]
ds_read_b64_tr_b16 v[100:101], v11 offset:25360
v_mfma_f32_16x16x32_bf16 v[196:199], v[48:51], v[64:67], v[196:199]
ds_read_b64_tr_b16 v[102:103], v11 offset:25872
v_mfma_f32_16x16x32_bf16 v[200:203], v[48:51], v[68:71], v[200:203]
v_mfma_f32_16x16x32_bf16 v[204:207], v[48:51], v[72:75], v[204:207]
v_mfma_f32_16x16x32_bf16 v[208:211], v[52:55], v[60:63], v[208:211]
v_mfma_f32_16x16x32_bf16 v[212:215], v[52:55], v[64:67], v[212:215]
v_mfma_f32_16x16x32_bf16 v[216:219], v[52:55], v[68:71], v[216:219]
v_mfma_f32_16x16x32_bf16 v[220:223], v[52:55], v[72:75], v[220:223]
v_mfma_f32_16x16x32_bf16 v[224:227], v[56:59], v[60:63], v[224:227]
v_mfma_f32_16x16x32_bf16 v[228:231], v[56:59], v[64:67], v[228:231]
v_mfma_f32_16x16x32_bf16 v[232:235], v[56:59], v[68:71], v[232:235]
v_mfma_f32_16x16x32_bf16 v[236:239], v[56:59], v[72:75], v[236:239]
s_waitcnt lgkmcnt(0)
v_mfma_f32_16x16x32_bf16 v[240:243], v[104:107], v[104:107], v[240:243]
v_mfma_f32_16x16x32_bf16 v[244:247], v[120:123], v[104:107], v[244:247]
v_mfma_f32_16x16x32_bf16 v[248:251], v[108:111], v[108:111], v[248:251]
v_mfma_f32_16x16x32_bf16 v[252:255], v[120:123], v[108:111], v[252:255]
v_mfma_f32_16x16x32_bf16 v[128:131], v[76:79], v[104:107], v[128:131]
v_mfma_f32_16x16x32_bf16 v[132:135], v[76:79], v[108:111], v[132:135]
v_mfma_f32_16x16x32_bf16 v[136:139], v[76:79], v[112:115], v[136:139]
v_mfma_f32_16x16x32_bf16 v[140:143], v[76:79], v[116:119], v[140:143]
s_nop 3
v_cndmask_b32 v24, v252, v244, s[68:69]
v_cndmask_b32 v25, v240, v241, s[60:61]
v_cndmask_b32 v26, v248, v249, s[60:61]
v_mfma_f32_16x16x32_bf16 v[144:147], v[80:83], v[104:107], v[144:147]
v_cndmask_b32 v25, v25, v242, s[62:63]
v_cndmask_b32 v26, v26, v250, s[62:63]
v_cndmask_b32 v25, v25, v243, s[64:65]
v_mfma_f32_16x16x32_bf16 v[148:151], v[80:83], v[108:111], v[148:151]
v_cndmask_b32 v26, v26, v251, s[64:65]
v_mov_b32 v27, 0
v_cndmask_b32 v25, v27, v25, s[66:67]
v_mfma_f32_16x16x32_bf16 v[152:155], v[80:83], v[112:115], v[152:155]
v_cndmask_b32 v26, v27, v26, s[66:67]
s_nop 1
v_permlane32_swap_b32 v25, v26
v_add_f32 v26, v25, v26
v_mfma_f32_16x16x32_bf16 v[156:159], v[80:83], v[116:119], v[156:159]
v_mov_b32 v27, v26
s_nop 1
v_permlane16_swap_b32 v26, v27
v_add_f32 v26, v26, v27
v_mfma_f32_16x16x32_bf16 v[160:163], v[84:87], v[104:107], v[160:163]
v_mul_f32 v24, 0x3b124925, v24
v_mul_f32 v26, 0x3b124925, v26
v_fma_f32 v26, -v24, v24, v26
v_mfma_f32_16x16x32_bf16 v[164:167], v[84:87], v[108:111], v[164:167]
v_max_f32 v26, 0, v26
v_cvt_pk_bf16_f32 v25, v24, v26
v_lshlrev_b32 v24, 16, v25
v_mfma_f32_16x16x32_bf16 v[168:171], v[84:87], v[112:115], v[168:171]
v_and_b32 v26, 0xffff0000, v25
v_add_f32 v26, 0x3727c5ac, v26
v_cvt_pk_bf16_f32 v26, v26, v26
v_mfma_f32_16x16x32_bf16 v[172:175], v[84:87], v[116:119], v[172:175]
v_and_b32 v26, 0xffff0000, v26
v_sqrt_f32 v26, v26
s_nop 0
v_cvt_pk_bf16_f32 v26, v26, v26
v_mfma_f32_16x16x32_bf16 v[176:179], v[88:91], v[104:107], v[176:179]
v_and_b32 v26, 0xffff0000, v26
v_rcp_f32 v26, v26
v_lshlrev_b32 v21, 3, v1
v_mfma_f32_16x16x32_bf16 v[180:183], v[88:91], v[108:111], v[180:183]
v_add_u32 v21, 160640, v21
s_lshl_b32 s36, s30, 9
v_add_u32 v22, s36, v21
v_mfma_f32_16x16x32_bf16 v[184:187], v[88:91], v[112:115], v[184:187]
v_mul_f32 v25, v26, v26
ds_write_b64 v22, v[24:25]
v_lshrrev_b32 v3, 5, v1
v_mfma_f32_16x16x32_bf16 v[188:191], v[88:91], v[116:119], v[188:191]
v_bfe_u32 v4, v1, 4, 1
s_mul_i32 s37, s32, 192
v_lshlrev_b32 v6, 4, v4
v_mfma_f32_16x16x32_bf16 v[192:195], v[92:95], v[104:107], v[192:195]
v_add_u32 v6, 159744, v6
v_add_u32 v9, s37, v6
s_lshl_b32 s37, s32, 5
v_mfma_f32_16x16x32_bf16 v[196:199], v[92:95], v[108:111], v[196:199]
s_add_u32 s37, s37, 384
v_add_u32 v10, s37, v6
v_mul_u32_u24 v7, 57344, v3
v_mfma_f32_16x16x32_bf16 v[200:203], v[92:95], v[112:115], v[200:203]
v_and_b32 v8, 31, v1
v_lshl_add_u32 v7, v8, 4, v7
s_lshl_b32 s38, s20, 3
v_mfma_f32_16x16x32_bf16 v[204:207], v[92:95], v[116:119], v[204:207]
s_lshl_b32 s34, s31, 2
s_add_u32 s38, s38, s34
s_lshl_b32 s34, s32, 1
v_mfma_f32_16x16x32_bf16 v[208:211], v[96:99], v[104:107], v[208:211]
s_add_u32 s39, s38, s34
s_xor_b32 s34, s34, 2
s_add_u32 s38, s38, s34
v_mfma_f32_16x16x32_bf16 v[212:215], v[96:99], v[108:111], v[212:215]
s_lshl_b32 s44, s39, 4
s_mul_i32 s39, s39, 57344
s_mul_i32 s38, s38, 57344
v_mfma_f32_16x16x32_bf16 v[216:219], v[96:99], v[112:115], v[216:219]
s_mul_i32 s45, s21, 3584
s_mul_i32 s46, s32, 1536
s_add_u32 s46, s46, s45
v_mfma_f32_16x16x32_bf16 v[220:223], v[96:99], v[116:119], v[220:223]
s_lshl_b32 s47, s32, 3
s_add_u32 s47, s47, s45
s_add_u32 s47, s47, 3072
v_mfma_f32_16x16x32_bf16 v[224:227], v[100:103], v[104:107], v[224:227]
s_add_u32 s40, s39, s46
s_add_u32 s41, s39, s47
s_add_u32 s42, s38, s46
v_mfma_f32_16x16x32_bf16 v[228:231], v[100:103], v[108:111], v[228:231]
s_add_u32 s43, s38, s47
s_xor_b32 s36, s30, 1
s_lshl_b32 s36, s36, 9
v_mfma_f32_16x16x32_bf16 v[232:235], v[100:103], v[112:115], v[232:235]
v_add_u32 v22, s36, v21
v_mfma_f32_16x16x32_bf16 v[236:239], v[100:103], v[116:119], v[236:239]
ds_read_b128 v[32:35], v9 offset:0
ds_read_b128 v[36:39], v9 offset:448
ds_read_b128 v[40:43], v9 offset:32
ds_read_b128 v[44:47], v9 offset:480
ds_read_b128 v[48:51], v9 offset:64
ds_read_b128 v[52:55], v9 offset:512
ds_read_b128 v[56:59], v9 offset:96
ds_read_b128 v[60:63], v9 offset:544
ds_read_b128 v[64:67], v9 offset:128
ds_read_b128 v[68:71], v9 offset:576
ds_read_b128 v[72:75], v9 offset:160
ds_read_b128 v[76:79], v9 offset:608
ds_read_b128 v[80:83], v10 offset:0
ds_read_b128 v[84:87], v10 offset:448
v_permlane32_swap_b32 v128, v132
v_permlane32_swap_b32 v129, v133
v_permlane32_swap_b32 v130, v134
v_permlane32_swap_b32 v131, v135
v_permlane32_swap_b32 v144, v148
v_permlane32_swap_b32 v145, v149
v_permlane32_swap_b32 v146, v150
v_permlane32_swap_b32 v147, v151
v_permlane32_swap_b32 v160, v164
v_permlane32_swap_b32 v161, v165
v_permlane32_swap_b32 v162, v166
v_permlane32_swap_b32 v163, v167
v_permlane32_swap_b32 v176, v180
v_permlane32_swap_b32 v177, v181
v_permlane32_swap_b32 v178, v182
v_permlane32_swap_b32 v179, v183
v_permlane32_swap_b32 v192, v196
v_permlane32_swap_b32 v193, v197
v_permlane32_swap_b32 v194, v198
v_permlane32_swap_b32 v195, v199
v_permlane32_swap_b32 v208, v212
v_permlane32_swap_b32 v209, v213
v_permlane32_swap_b32 v210, v214
v_permlane32_swap_b32 v211, v215
v_permlane32_swap_b32 v224, v228
v_permlane32_swap_b32 v225, v229
v_permlane32_swap_b32 v226, v230
v_permlane32_swap_b32 v227, v231
s_waitcnt lgkmcnt(0)
s_barrier
ds_read_b64 v[28:29], v22
v_pk_fma_f32 v[128:129], v[32:33], v[24:25], v[128:129] op_sel:[0,0,0] op_sel_hi:[1,0,1] neg_lo:[0,1,0] neg_hi:[0,1,0]
v_pk_fma_f32 v[132:133], v[36:37], v[24:25], v[132:133] op_sel:[0,0,0] op_sel_hi:[1,0,1] neg_lo:[0,1,0] neg_hi:[0,1,0]
v_pk_fma_f32 v[130:131], v[34:35], v[24:25], v[130:131] op_sel:[0,0,0] op_sel_hi:[1,0,1] neg_lo:[0,1,0] neg_hi:[0,1,0]
v_pk_fma_f32 v[134:135], v[38:39], v[24:25], v[134:135] op_sel:[0,0,0] op_sel_hi:[1,0,1] neg_lo:[0,1,0] neg_hi:[0,1,0]
v_pk_mul_f32 v[128:129], v[128:129], v[132:133]
v_pk_mul_f32 v[130:131], v[130:131], v[134:135]
v_pk_mul_f32 v[128:129], v[128:129], v[24:25] op_sel:[0,1] op_sel_hi:[1,1]
v_pk_mul_f32 v[130:131], v[130:131], v[24:25] op_sel:[0,1] op_sel_hi:[1,1]
v_cvt_pk_bf16_f32 v88, v128, v129
v_cvt_pk_bf16_f32 v89, v130, v131
v_pk_fma_f32 v[144:145], v[40:41], v[24:25], v[144:145] op_sel:[0,0,0] op_sel_hi:[1,0,1] neg_lo:[0,1,0] neg_hi:[0,1,0]
v_pk_fma_f32 v[148:149], v[44:45], v[24:25], v[148:149] op_sel:[0,0,0] op_sel_hi:[1,0,1] neg_lo:[0,1,0] neg_hi:[0,1,0]
v_pk_fma_f32 v[146:147], v[42:43], v[24:25], v[146:147] op_sel:[0,0,0] op_sel_hi:[1,0,1] neg_lo:[0,1,0] neg_hi:[0,1,0]
v_pk_fma_f32 v[150:151], v[46:47], v[24:25], v[150:151] op_sel:[0,0,0] op_sel_hi:[1,0,1] neg_lo:[0,1,0] neg_hi:[0,1,0]
v_pk_mul_f32 v[144:145], v[144:145], v[148:149]
v_pk_mul_f32 v[146:147], v[146:147], v[150:151]
v_pk_mul_f32 v[144:145], v[144:145], v[24:25] op_sel:[0,1] op_sel_hi:[1,1]
v_pk_mul_f32 v[146:147], v[146:147], v[24:25] op_sel:[0,1] op_sel_hi:[1,1]
v_cvt_pk_bf16_f32 v90, v144, v145
v_cvt_pk_bf16_f32 v91, v146, v147
buffer_store_dwordx4 v[88:91], v7, s[16:19], s40 offen offset:0 sc1
v_pk_fma_f32 v[160:161], v[48:49], v[24:25], v[160:161] op_sel:[0,0,0] op_sel_hi:[1,0,1] neg_lo:[0,1,0] neg_hi:[0,1,0]
v_pk_fma_f32 v[164:165], v[52:53], v[24:25], v[164:165] op_sel:[0,0,0] op_sel_hi:[1,0,1] neg_lo:[0,1,0] neg_hi:[0,1,0]
v_pk_fma_f32 v[162:163], v[50:51], v[24:25], v[162:163] op_sel:[0,0,0] op_sel_hi:[1,0,1] neg_lo:[0,1,0] neg_hi:[0,1,0]
v_pk_fma_f32 v[166:167], v[54:55], v[24:25], v[166:167] op_sel:[0,0,0] op_sel_hi:[1,0,1] neg_lo:[0,1,0] neg_hi:[0,1,0]
v_pk_mul_f32 v[160:161], v[160:161], v[164:165]
v_pk_mul_f32 v[162:163], v[162:163], v[166:167]
v_pk_mul_f32 v[160:161], v[160:161], v[24:25] op_sel:[0,1] op_sel_hi:[1,1]
v_pk_mul_f32 v[162:163], v[162:163], v[24:25] op_sel:[0,1] op_sel_hi:[1,1]
v_cvt_pk_bf16_f32 v92, v160, v161
v_cvt_pk_bf16_f32 v93, v162, v163
v_pk_fma_f32 v[176:177], v[56:57], v[24:25], v[176:177] op_sel:[0,0,0] op_sel_hi:[1,0,1] neg_lo:[0,1,0] neg_hi:[0,1,0]
v_pk_fma_f32 v[180:181], v[60:61], v[24:25], v[180:181] op_sel:[0,0,0] op_sel_hi:[1,0,1] neg_lo:[0,1,0] neg_hi:[0,1,0]
v_pk_fma_f32 v[178:179], v[58:59], v[24:25], v[178:179] op_sel:[0,0,0] op_sel_hi:[1,0,1] neg_lo:[0,1,0] neg_hi:[0,1,0]
v_pk_fma_f32 v[182:183], v[62:63], v[24:25], v[182:183] op_sel:[0,0,0] op_sel_hi:[1,0,1] neg_lo:[0,1,0] neg_hi:[0,1,0]
v_pk_mul_f32 v[176:177], v[176:177], v[180:181]
v_pk_mul_f32 v[178:179], v[178:179], v[182:183]
v_pk_mul_f32 v[176:177], v[176:177], v[24:25] op_sel:[0,1] op_sel_hi:[1,1]
v_pk_mul_f32 v[178:179], v[178:179], v[24:25] op_sel:[0,1] op_sel_hi:[1,1]
v_cvt_pk_bf16_f32 v94, v176, v177
v_cvt_pk_bf16_f32 v95, v178, v179
buffer_store_dwordx4 v[92:95], v7, s[16:19], s40 offen offset:512 sc1
v_pk_fma_f32 v[192:193], v[64:65], v[24:25], v[192:193] op_sel:[0,0,0] op_sel_hi:[1,0,1] neg_lo:[0,1,0] neg_hi:[0,1,0]
v_pk_fma_f32 v[196:197], v[68:69], v[24:25], v[196:197] op_sel:[0,0,0] op_sel_hi:[1,0,1] neg_lo:[0,1,0] neg_hi:[0,1,0]
v_pk_fma_f32 v[194:195], v[66:67], v[24:25], v[194:195] op_sel:[0,0,0] op_sel_hi:[1,0,1] neg_lo:[0,1,0] neg_hi:[0,1,0]
v_pk_fma_f32 v[198:199], v[70:71], v[24:25], v[198:199] op_sel:[0,0,0] op_sel_hi:[1,0,1] neg_lo:[0,1,0] neg_hi:[0,1,0]
v_pk_mul_f32 v[192:193], v[192:193], v[196:197]
v_pk_mul_f32 v[194:195], v[194:195], v[198:199]
v_pk_mul_f32 v[192:193], v[192:193], v[24:25] op_sel:[0,1] op_sel_hi:[1,1]
v_pk_mul_f32 v[194:195], v[194:195], v[24:25] op_sel:[0,1] op_sel_hi:[1,1]
v_cvt_pk_bf16_f32 v96, v192, v193
v_cvt_pk_bf16_f32 v97, v194, v195
v_pk_fma_f32 v[208:209], v[72:73], v[24:25], v[208:209] op_sel:[0,0,0] op_sel_hi:[1,0,1] neg_lo:[0,1,0] neg_hi:[0,1,0]
v_pk_fma_f32 v[212:213], v[76:77], v[24:25], v[212:213] op_sel:[0,0,0] op_sel_hi:[1,0,1] neg_lo:[0,1,0] neg_hi:[0,1,0]
v_pk_fma_f32 v[210:211], v[74:75], v[24:25], v[210:211] op_sel:[0,0,0] op_sel_hi:[1,0,1] neg_lo:[0,1,0] neg_hi:[0,1,0]
v_pk_fma_f32 v[214:215], v[78:79], v[24:25], v[214:215] op_sel:[0,0,0] op_sel_hi:[1,0,1] neg_lo:[0,1,0] neg_hi:[0,1,0]
v_pk_mul_f32 v[208:209], v[208:209], v[212:213]
v_pk_mul_f32 v[210:211], v[210:211], v[214:215]
v_pk_mul_f32 v[208:209], v[208:209], v[24:25] op_sel:[0,1] op_sel_hi:[1,1]
v_pk_mul_f32 v[210:211], v[210:211], v[24:25] op_sel:[0,1] op_sel_hi:[1,1]
v_cvt_pk_bf16_f32 v98, v208, v209
v_cvt_pk_bf16_f32 v99, v210, v211
buffer_store_dwordx4 v[96:99], v7, s[16:19], s40 offen offset:1024 sc1
v_pk_fma_f32 v[224:225], v[80:81], v[24:25], v[224:225] op_sel:[0,0,0] op_sel_hi:[1,0,1] neg_lo:[0,1,0] neg_hi:[0,1,0]
v_pk_fma_f32 v[228:229], v[84:85], v[24:25], v[228:229] op_sel:[0,0,0] op_sel_hi:[1,0,1] neg_lo:[0,1,0] neg_hi:[0,1,0]
v_pk_fma_f32 v[226:227], v[82:83], v[24:25], v[226:227] op_sel:[0,0,0] op_sel_hi:[1,0,1] neg_lo:[0,1,0] neg_hi:[0,1,0]
v_pk_fma_f32 v[230:231], v[86:87], v[24:25], v[230:231] op_sel:[0,0,0] op_sel_hi:[1,0,1] neg_lo:[0,1,0] neg_hi:[0,1,0]
v_pk_mul_f32 v[224:225], v[224:225], v[228:229]
v_pk_mul_f32 v[226:227], v[226:227], v[230:231]
v_pk_mul_f32 v[224:225], v[224:225], v[24:25] op_sel:[0,1] op_sel_hi:[1,1]
v_pk_mul_f32 v[226:227], v[226:227], v[24:25] op_sel:[0,1] op_sel_hi:[1,1]
v_cvt_pk_bf16_f32 v100, v224, v225
v_cvt_pk_bf16_f32 v101, v226, v227
buffer_store_dwordx2 v[100:101], v7, s[16:19], s41 offen sc1
v_permlane32_swap_b32 v136, v140
v_permlane32_swap_b32 v137, v141
v_permlane32_swap_b32 v138, v142
v_permlane32_swap_b32 v139, v143
v_permlane32_swap_b32 v152, v156
v_permlane32_swap_b32 v153, v157
v_permlane32_swap_b32 v154, v158
v_permlane32_swap_b32 v155, v159
v_permlane32_swap_b32 v168, v172
v_permlane32_swap_b32 v169, v173
v_permlane32_swap_b32 v170, v174
v_permlane32_swap_b32 v171, v175
v_permlane32_swap_b32 v184, v188
v_permlane32_swap_b32 v185, v189
v_permlane32_swap_b32 v186, v190
v_permlane32_swap_b32 v187, v191
v_permlane32_swap_b32 v200, v204
v_permlane32_swap_b32 v201, v205
v_permlane32_swap_b32 v202, v206
v_permlane32_swap_b32 v203, v207
v_permlane32_swap_b32 v216, v220
v_permlane32_swap_b32 v217, v221
v_permlane32_swap_b32 v218, v222
v_permlane32_swap_b32 v219, v223
v_permlane32_swap_b32 v232, v236
v_permlane32_swap_b32 v233, v237
v_permlane32_swap_b32 v234, v238
v_permlane32_swap_b32 v235, v239
s_waitcnt lgkmcnt(0)
v_pk_fma_f32 v[136:137], v[32:33], v[28:29], v[136:137] op_sel:[0,0,0] op_sel_hi:[1,0,1] neg_lo:[0,1,0] neg_hi:[0,1,0]
v_pk_fma_f32 v[140:141], v[36:37], v[28:29], v[140:141] op_sel:[0,0,0] op_sel_hi:[1,0,1] neg_lo:[0,1,0] neg_hi:[0,1,0]
v_pk_fma_f32 v[138:139], v[34:35], v[28:29], v[138:139] op_sel:[0,0,0] op_sel_hi:[1,0,1] neg_lo:[0,1,0] neg_hi:[0,1,0]
v_pk_fma_f32 v[142:143], v[38:39], v[28:29], v[142:143] op_sel:[0,0,0] op_sel_hi:[1,0,1] neg_lo:[0,1,0] neg_hi:[0,1,0]
v_pk_mul_f32 v[136:137], v[136:137], v[140:141]
v_pk_mul_f32 v[138:139], v[138:139], v[142:143]
v_pk_mul_f32 v[136:137], v[136:137], v[28:29] op_sel:[0,1] op_sel_hi:[1,1]
v_pk_mul_f32 v[138:139], v[138:139], v[28:29] op_sel:[0,1] op_sel_hi:[1,1]
v_cvt_pk_bf16_f32 v104, v136, v137
v_cvt_pk_bf16_f32 v105, v138, v139
v_pk_fma_f32 v[152:153], v[40:41], v[28:29], v[152:153] op_sel:[0,0,0] op_sel_hi:[1,0,1] neg_lo:[0,1,0] neg_hi:[0,1,0]
v_pk_fma_f32 v[156:157], v[44:45], v[28:29], v[156:157] op_sel:[0,0,0] op_sel_hi:[1,0,1] neg_lo:[0,1,0] neg_hi:[0,1,0]
v_pk_fma_f32 v[154:155], v[42:43], v[28:29], v[154:155] op_sel:[0,0,0] op_sel_hi:[1,0,1] neg_lo:[0,1,0] neg_hi:[0,1,0]
v_pk_fma_f32 v[158:159], v[46:47], v[28:29], v[158:159] op_sel:[0,0,0] op_sel_hi:[1,0,1] neg_lo:[0,1,0] neg_hi:[0,1,0]
v_pk_mul_f32 v[152:153], v[152:153], v[156:157]
v_pk_mul_f32 v[154:155], v[154:155], v[158:159]
v_pk_mul_f32 v[152:153], v[152:153], v[28:29] op_sel:[0,1] op_sel_hi:[1,1]
v_pk_mul_f32 v[154:155], v[154:155], v[28:29] op_sel:[0,1] op_sel_hi:[1,1]
v_cvt_pk_bf16_f32 v106, v152, v153
v_cvt_pk_bf16_f32 v107, v154, v155
buffer_store_dwordx4 v[104:107], v7, s[16:19], s42 offen offset:0 sc1
v_pk_fma_f32 v[168:169], v[48:49], v[28:29], v[168:169] op_sel:[0,0,0] op_sel_hi:[1,0,1] neg_lo:[0,1,0] neg_hi:[0,1,0]
v_pk_fma_f32 v[172:173], v[52:53], v[28:29], v[172:173] op_sel:[0,0,0] op_sel_hi:[1,0,1] neg_lo:[0,1,0] neg_hi:[0,1,0]
v_pk_fma_f32 v[170:171], v[50:51], v[28:29], v[170:171] op_sel:[0,0,0] op_sel_hi:[1,0,1] neg_lo:[0,1,0] neg_hi:[0,1,0]
v_pk_fma_f32 v[174:175], v[54:55], v[28:29], v[174:175] op_sel:[0,0,0] op_sel_hi:[1,0,1] neg_lo:[0,1,0] neg_hi:[0,1,0]
v_pk_mul_f32 v[168:169], v[168:169], v[172:173]
v_pk_mul_f32 v[170:171], v[170:171], v[174:175]
v_pk_mul_f32 v[168:169], v[168:169], v[28:29] op_sel:[0,1] op_sel_hi:[1,1]
v_pk_mul_f32 v[170:171], v[170:171], v[28:29] op_sel:[0,1] op_sel_hi:[1,1]
v_cvt_pk_bf16_f32 v108, v168, v169
v_cvt_pk_bf16_f32 v109, v170, v171
v_pk_fma_f32 v[184:185], v[56:57], v[28:29], v[184:185] op_sel:[0,0,0] op_sel_hi:[1,0,1] neg_lo:[0,1,0] neg_hi:[0,1,0]
v_pk_fma_f32 v[188:189], v[60:61], v[28:29], v[188:189] op_sel:[0,0,0] op_sel_hi:[1,0,1] neg_lo:[0,1,0] neg_hi:[0,1,0]
v_pk_fma_f32 v[186:187], v[58:59], v[28:29], v[186:187] op_sel:[0,0,0] op_sel_hi:[1,0,1] neg_lo:[0,1,0] neg_hi:[0,1,0]
v_pk_fma_f32 v[190:191], v[62:63], v[28:29], v[190:191] op_sel:[0,0,0] op_sel_hi:[1,0,1] neg_lo:[0,1,0] neg_hi:[0,1,0]
v_pk_mul_f32 v[184:185], v[184:185], v[188:189]
v_pk_mul_f32 v[186:187], v[186:187], v[190:191]
v_pk_mul_f32 v[184:185], v[184:185], v[28:29] op_sel:[0,1] op_sel_hi:[1,1]
v_pk_mul_f32 v[186:187], v[186:187], v[28:29] op_sel:[0,1] op_sel_hi:[1,1]
v_cvt_pk_bf16_f32 v110, v184, v185
v_cvt_pk_bf16_f32 v111, v186, v187
buffer_store_dwordx4 v[108:111], v7, s[16:19], s42 offen offset:512 sc1
v_pk_fma_f32 v[200:201], v[64:65], v[28:29], v[200:201] op_sel:[0,0,0] op_sel_hi:[1,0,1] neg_lo:[0,1,0] neg_hi:[0,1,0]
v_pk_fma_f32 v[204:205], v[68:69], v[28:29], v[204:205] op_sel:[0,0,0] op_sel_hi:[1,0,1] neg_lo:[0,1,0] neg_hi:[0,1,0]
v_pk_fma_f32 v[202:203], v[66:67], v[28:29], v[202:203] op_sel:[0,0,0] op_sel_hi:[1,0,1] neg_lo:[0,1,0] neg_hi:[0,1,0]
v_pk_fma_f32 v[206:207], v[70:71], v[28:29], v[206:207] op_sel:[0,0,0] op_sel_hi:[1,0,1] neg_lo:[0,1,0] neg_hi:[0,1,0]
v_pk_mul_f32 v[200:201], v[200:201], v[204:205]
v_pk_mul_f32 v[202:203], v[202:203], v[206:207]
v_pk_mul_f32 v[200:201], v[200:201], v[28:29] op_sel:[0,1] op_sel_hi:[1,1]
v_pk_mul_f32 v[202:203], v[202:203], v[28:29] op_sel:[0,1] op_sel_hi:[1,1]
v_cvt_pk_bf16_f32 v112, v200, v201
v_cvt_pk_bf16_f32 v113, v202, v203
v_pk_fma_f32 v[216:217], v[72:73], v[28:29], v[216:217] op_sel:[0,0,0] op_sel_hi:[1,0,1] neg_lo:[0,1,0] neg_hi:[0,1,0]
v_pk_fma_f32 v[220:221], v[76:77], v[28:29], v[220:221] op_sel:[0,0,0] op_sel_hi:[1,0,1] neg_lo:[0,1,0] neg_hi:[0,1,0]
v_pk_fma_f32 v[218:219], v[74:75], v[28:29], v[218:219] op_sel:[0,0,0] op_sel_hi:[1,0,1] neg_lo:[0,1,0] neg_hi:[0,1,0]
v_pk_fma_f32 v[222:223], v[78:79], v[28:29], v[222:223] op_sel:[0,0,0] op_sel_hi:[1,0,1] neg_lo:[0,1,0] neg_hi:[0,1,0]
v_pk_mul_f32 v[216:217], v[216:217], v[220:221]
v_pk_mul_f32 v[218:219], v[218:219], v[222:223]
v_pk_mul_f32 v[216:217], v[216:217], v[28:29] op_sel:[0,1] op_sel_hi:[1,1]
v_pk_mul_f32 v[218:219], v[218:219], v[28:29] op_sel:[0,1] op_sel_hi:[1,1]
v_cvt_pk_bf16_f32 v114, v216, v217
v_cvt_pk_bf16_f32 v115, v218, v219
buffer_store_dwordx4 v[112:115], v7, s[16:19], s42 offen offset:1024 sc1
v_pk_fma_f32 v[232:233], v[80:81], v[28:29], v[232:233] op_sel:[0,0,0] op_sel_hi:[1,0,1] neg_lo:[0,1,0] neg_hi:[0,1,0]
v_pk_fma_f32 v[236:237], v[84:85], v[28:29], v[236:237] op_sel:[0,0,0] op_sel_hi:[1,0,1] neg_lo:[0,1,0] neg_hi:[0,1,0]
v_pk_fma_f32 v[234:235], v[82:83], v[28:29], v[234:235] op_sel:[0,0,0] op_sel_hi:[1,0,1] neg_lo:[0,1,0] neg_hi:[0,1,0]
v_pk_fma_f32 v[238:239], v[86:87], v[28:29], v[238:239] op_sel:[0,0,0] op_sel_hi:[1,0,1] neg_lo:[0,1,0] neg_hi:[0,1,0]
v_pk_mul_f32 v[232:233], v[232:233], v[236:237]
v_pk_mul_f32 v[234:235], v[234:235], v[238:239]
v_pk_mul_f32 v[232:233], v[232:233], v[28:29] op_sel:[0,1] op_sel_hi:[1,1]
v_pk_mul_f32 v[234:235], v[234:235], v[28:29] op_sel:[0,1] op_sel_hi:[1,1]
v_cvt_pk_bf16_f32 v116, v232, v233
v_cvt_pk_bf16_f32 v117, v234, v235
buffer_store_dwordx2 v[116:117], v7, s[16:19], s43 offen sc1
s_barrier
s_branch M_FIN
M_G1L:
s_add_u32 s45, s44, 0
s_cmp_ge_u32 s45, 14
s_cselect_b32 s46, 14, 0
s_sub_u32 s45, s45, s46
s_lshl_b32 s47, s45, 17
s_add_u32 s47, s47, s35
s_add_u32 s39, s47, 16384
s_add_u32 m0, s37, 92992
s_nop 0
buffer_load_dwordx4 v8, s[40:43], s47 offen sc1 lds
s_add_u32 m0, s37, 94048
s_nop 0
buffer_load_dwordx4 v8, s[40:43], s39 offen sc1 lds
s_waitcnt vmcnt(0)
s_mov_b32 s28, 0
HV_0:
v_add_u32 v11, 92992, v10
ds_read_b128 v[16:19], v11
ds_read_b128 v[20:23], v11 offset:1056
s_waitcnt lgkmcnt(0)
v_max3_u32 v16, v16, v17, v18
v_max3_u32 v20, v20, v21, v22
v_max3_u32 v16, v16, v19, v23
v_max_u32 v16, v16, v20
v_cmp_eq_u32 vcc, -1, v16
s_nop 1
s_cbranch_vccz HD_0
s_add_u32 s28, s28, 1
s_cmp_gt_u32 s28, 20000
s_cbranch_scc1 HD_0
s_add_u32 s45, s44, 0
s_cmp_ge_u32 s45, 14
s_cselect_b32 s46, 14, 0
s_sub_u32 s45, s45, s46
s_lshl_b32 s47, s45, 17
s_add_u32 s47, s47, s35
s_add_u32 s39, s47, 16384
s_add_u32 m0, s37, 92992
s_nop 0
buffer_load_dwordx4 v8, s[40:43], s47 offen sc1 lds
s_add_u32 m0, s37, 94048
s_nop 0
buffer_load_dwordx4 v8, s[40:43], s39 offen sc1 lds
s_waitcnt vmcnt(0)
s_branch HV_0
HD_0:
s_add_u32 s45, s44, 1
s_cmp_ge_u32 s45, 14
s_cselect_b32 s46, 14, 0
s_sub_u32 s45, s45, s46
s_lshl_b32 s47, s45, 17
s_add_u32 s47, s47, s35
s_add_u32 s39, s47, 16384
s_add_u32 m0, s37, 118352
s_nop 0
buffer_load_dwordx4 v8, s[40:43], s47 offen sc1 lds
s_add_u32 m0, s37, 119408
s_nop 0
buffer_load_dwordx4 v8, s[40:43], s39 offen sc1 lds
s_add_u32 s45, s44, 2
s_cmp_ge_u32 s45, 14
s_cselect_b32 s46, 14, 0
s_sub_u32 s45, s45, s46
s_mul_i32 s46, s45, 114688
s_add_u32 s46, s46, s32
s_add_u32 s39, s46, 14336
s_add_u32 m0, s37, 0
s_nop 0
buffer_load_dwordx4 v4, s[12:15], s46 offen lds
s_add_u32 m0, s37, 1056
s_nop 0
buffer_load_dwordx4 v4, s[12:15], s39 offen lds
s_add_u32 m0, s37, 8464
s_nop 0
buffer_load_dwordx4 v4, s[16:19], s46 offen lds
s_add_u32 m0, s37, 9520
s_nop 0
buffer_load_dwordx4 v4, s[16:19], s39 offen lds
s_add_u32 s45, s44, 2
s_cmp_ge_u32 s45, 14
s_cselect_b32 s46, 14, 0
s_sub_u32 s45, s45, s46
s_lshl_b32 s47, s45, 17
s_add_u32 s47, s47, s35
s_add_u32 s39, s47, 16384
s_add_u32 m0, s37, 16912
s_nop 0
buffer_load_dwordx4 v8, s[40:43], s47 offen sc1 lds
s_add_u32 m0, s37, 17968
s_nop 0
buffer_load_dwordx4 v8, s[40:43], s39 offen sc1 lds
s_add_u32 s45, s44, 3
s_cmp_ge_u32 s45, 14
s_cselect_b32 s46, 14, 0
s_sub_u32 s45, s45, s46
s_mul_i32 s46, s45, 114688
s_add_u32 s46, s46, s32
s_add_u32 s39, s46, 14336
s_add_u32 m0, s37, 25360
s_nop 0
buffer_load_dwordx4 v4, s[12:15], s46 offen lds
s_add_u32 m0, s37, 26416
s_nop 0
buffer_load_dwordx4 v4, s[12:15], s39 offen lds
s_add_u32 m0, s37, 33824
s_nop 0
buffer_load_dwordx4 v4, s[16:19], s46 offen lds
s_add_u32 m0, s37, 34880
s_nop 0
buffer_load_dwordx4 v4, s[16:19], s39 offen lds
s_add_u32 s45, s44, 3
s_cmp_ge_u32 s45, 14
s_cselect_b32 s46, 14, 0
s_sub_u32 s45, s45, s46
s_lshl_b32 s47, s45, 17
s_add_u32 s47, s47, s35
s_add_u32 s39, s47, 16384
s_add_u32 m0, s37, 42272
s_nop 0
buffer_load_dwordx4 v8, s[40:43], s47 offen sc1 lds
s_add_u32 m0, s37, 43328
s_nop 0
buffer_load_dwordx4 v8, s[40:43], s39 offen sc1 lds
s_add_u32 s45, s44, 4
s_cmp_ge_u32 s45, 14
s_cselect_b32 s46, 14, 0
s_sub_u32 s45, s45, s46
s_mul_i32 s46, s45, 114688
s_add_u32 s46, s46, s32
s_add_u32 s39, s46, 14336
s_add_u32 m0, s37, 50720
s_nop 0
buffer_load_dwordx4 v4, s[12:15], s46 offen lds
s_add_u32 m0, s37, 51776
s_nop 0
buffer_load_dwordx4 v4, s[12:15], s39 offen lds
s_add_u32 m0, s37, 59184
s_nop 0
buffer_load_dwordx4 v4, s[16:19], s46 offen lds
s_add_u32 m0, s37, 60240
s_nop 0
buffer_load_dwordx4 v4, s[16:19], s39 offen lds
s_add_u32 s45, s44, 4
s_cmp_ge_u32 s45, 14
s_cselect_b32 s46, 14, 0
s_sub_u32 s45, s45, s46
s_lshl_b32 s47, s45, 17
s_add_u32 s47, s47, s35
s_add_u32 s39, s47, 16384
s_add_u32 m0, s37, 67632
s_nop 0
buffer_load_dwordx4 v8, s[40:43], s47 offen sc1 lds
s_add_u32 m0, s37, 68688
s_nop 0
buffer_load_dwordx4 v8, s[40:43], s39 offen sc1 lds
s_barrier
s_waitcnt vmcnt(18)
s_mov_b32 s28, 0
HV_1:
v_add_u32 v11, 118352, v10
ds_read_b128 v[16:19], v11
ds_read_b128 v[20:23], v11 offset:1056
s_waitcnt lgkmcnt(0)
v_max3_u32 v16, v16, v17, v18
v_max3_u32 v20, v20, v21, v22
v_max3_u32 v16, v16, v19, v23
v_max_u32 v16, v16, v20
v_cmp_eq_u32 vcc, -1, v16
s_nop 1
s_cbranch_vccz HD_1
s_add_u32 s28, s28, 1
s_cmp_gt_u32 s28, 20000
s_cbranch_scc1 HD_1
s_add_u32 s45, s44, 1
s_cmp_ge_u32 s45, 14
s_cselect_b32 s46, 14, 0
s_sub_u32 s45, s45, s46
s_lshl_b32 s47, s45, 17
s_add_u32 s47, s47, s35
s_add_u32 s39, s47, 16384
s_add_u32 m0, s37, 118352
s_nop 0
buffer_load_dwordx4 v8, s[40:43], s47 offen sc1 lds
s_add_u32 m0, s37, 119408
s_nop 0
buffer_load_dwordx4 v8, s[40:43], s39 offen sc1 lds
s_waitcnt vmcnt(0)
s_branch HV_1
HD_1:
s_barrier
s_add_u32 s45, s44, 5
s_cmp_ge_u32 s45, 14
s_cselect_b32 s46, 14, 0
s_sub_u32 s45, s45, s46
s_mul_i32 s46, s45, 114688
s_add_u32 s46, s46, s32
s_add_u32 s39, s46, 14336
s_add_u32 m0, s37, 76080
s_nop 0
buffer_load_dwordx4 v4, s[12:15], s46 offen lds
s_add_u32 m0, s37, 77136
s_nop 0
buffer_load_dwordx4 v4, s[12:15], s39 offen lds
s_add_u32 m0, s37, 84544
s_nop 0
buffer_load_dwordx4 v4, s[16:19], s46 offen lds
s_add_u32 m0, s37, 85600
s_nop 0
buffer_load_dwordx4 v4, s[16:19], s39 offen lds
s_add_u32 s45, s44, 5
s_cmp_ge_u32 s45, 14
s_cselect_b32 s46, 14, 0
s_sub_u32 s45, s45, s46
s_lshl_b32 s47, s45, 17
s_add_u32 s47, s47, s35
s_add_u32 s39, s47, 16384
s_add_u32 m0, s37, 92992
s_nop 0
buffer_load_dwordx4 v8, s[40:43], s47 offen sc1 lds
s_add_u32 m0, s37, 94048
s_nop 0
buffer_load_dwordx4 v8, s[40:43], s39 offen sc1 lds
v_and_b32 v12, 31, v1
v_lshlrev_b32 v12, 6, v12
s_cmp_lg_u32 s31, 0
s_cbranch_scc1 P3_NOCF
s_mov_b32 s56, 16384
buffer_load_dword v24, v12, s[8:11], s56 offen sc1
P3_NOCF:
s_waitcnt vmcnt(18)
s_mov_b32 s28, 0
HV_2:
v_add_u32 v11, 16912, v10
ds_read_b128 v[16:19], v11
ds_read_b128 v[20:23], v11 offset:1056
s_waitcnt lgkmcnt(0)
v_max3_u32 v16, v16, v17, v18
v_max3_u32 v20, v20, v21, v22
v_max3_u32 v16, v16, v19, v23
v_max_u32 v16, v16, v20
v_cmp_eq_u32 vcc, -1, v16
s_nop 1
s_cbranch_vccz HD_2
s_add_u32 s28, s28, 1
s_cmp_gt_u32 s28, 20000
s_cbranch_scc1 HD_2
s_add_u32 s45, s44, 2
s_cmp_ge_u32 s45, 14
s_cselect_b32 s46, 14, 0
s_sub_u32 s45, s45, s46
s_lshl_b32 s47, s45, 17
s_add_u32 s47, s47, s35
s_add_u32 s39, s47, 16384
s_add_u32 m0, s37, 16912
s_nop 0
buffer_load_dwordx4 v8, s[40:43], s47 offen sc1 lds
s_add_u32 m0, s37, 17968
s_nop 0
buffer_load_dwordx4 v8, s[40:43], s39 offen sc1 lds
s_waitcnt vmcnt(0)
s_branch HV_2
HD_2:
s_barrier
s_add_u32 s45, s44, 6
s_cmp_ge_u32 s45, 14
s_cselect_b32 s46, 14, 0
s_sub_u32 s45, s45, s46
s_mul_i32 s46, s45, 114688
s_add_u32 s46, s46, s32
s_add_u32 s39, s46, 14336
s_add_u32 m0, s37, 101440
s_nop 0
buffer_load_dwordx4 v4, s[12:15], s46 offen lds
s_add_u32 m0, s37, 102496
s_nop 0
buffer_load_dwordx4 v4, s[12:15], s39 offen lds
s_add_u32 m0, s37, 109904
s_nop 0
buffer_load_dwordx4 v4, s[16:19], s46 offen lds
s_add_u32 m0, s37, 110960
s_nop 0
buffer_load_dwordx4 v4, s[16:19], s39 offen lds
s_add_u32 s45, s44, 6
s_cmp_ge_u32 s45, 14
s_cselect_b32 s46, 14, 0
s_sub_u32 s45, s45, s46
s_lshl_b32 s47, s45, 17
s_add_u32 s47, s47, s35
s_add_u32 s39, s47, 16384
s_add_u32 m0, s37, 118352
s_nop 0
buffer_load_dwordx4 v8, s[40:43], s47 offen sc1 lds
s_add_u32 m0, s37, 119408
s_nop 0
buffer_load_dwordx4 v8, s[40:43], s39 offen sc1 lds
s_waitcnt vmcnt(18)
s_mov_b32 s28, 0
HV_3:
v_add_u32 v11, 42272, v10
ds_read_b128 v[16:19], v11
ds_read_b128 v[20:23], v11 offset:1056
s_waitcnt lgkmcnt(0)
v_max3_u32 v16, v16, v17, v18
v_max3_u32 v20, v20, v21, v22
v_max3_u32 v16, v16, v19, v23
v_max_u32 v16, v16, v20
v_cmp_eq_u32 vcc, -1, v16
s_nop 1
s_cbranch_vccz HD_3
s_add_u32 s28, s28, 1
s_cmp_gt_u32 s28, 20000
s_cbranch_scc1 HD_3
s_add_u32 s45, s44, 3
s_cmp_ge_u32 s45, 14
s_cselect_b32 s46, 14, 0
s_sub_u32 s45, s45, s46
s_lshl_b32 s47, s45, 17
s_add_u32 s47, s47, s35
s_add_u32 s39, s47, 16384
s_add_u32 m0, s37, 42272
s_nop 0
buffer_load_dwordx4 v8, s[40:43], s47 offen sc1 lds
s_add_u32 m0, s37, 43328
s_nop 0
buffer_load_dwordx4 v8, s[40:43], s39 offen sc1 lds
s_waitcnt vmcnt(0)
s_branch HV_3
HD_3:
s_barrier
s_add_u32 s45, s44, 7
s_cmp_ge_u32 s45, 14
s_cselect_b32 s46, 14, 0
s_sub_u32 s45, s45, s46
s_mul_i32 s46, s45, 114688
s_add_u32 s46, s46, s32
s_add_u32 s39, s46, 14336
s_add_u32 m0, s37, 0
s_nop 0
buffer_load_dwordx4 v4, s[12:15], s46 offen lds
s_add_u32 m0, s37, 1056
s_nop 0
buffer_load_dwordx4 v4, s[12:15], s39 offen lds
s_add_u32 m0, s37, 8464
s_nop 0
buffer_load_dwordx4 v4, s[16:19], s46 offen lds
s_add_u32 m0, s37, 9520
s_nop 0
buffer_load_dwordx4 v4, s[16:19], s39 offen lds
s_add_u32 s45, s44, 7
s_cmp_ge_u32 s45, 14
s_cselect_b32 s46, 14, 0
s_sub_u32 s45, s45, s46
s_lshl_b32 s47, s45, 17
s_add_u32 s47, s47, s35
s_add_u32 s39, s47, 16384
s_add_u32 m0, s37, 16912
s_nop 0
buffer_load_dwordx4 v8, s[40:43], s47 offen sc1 lds
s_add_u32 m0, s37, 17968
s_nop 0
buffer_load_dwordx4 v8, s[40:43], s39 offen sc1 lds
s_waitcnt vmcnt(18)
s_mov_b32 s28, 0
HV_4:
v_add_u32 v11, 67632, v10
ds_read_b128 v[16:19], v11
ds_read_b128 v[20:23], v11 offset:1056
s_waitcnt lgkmcnt(0)
v_max3_u32 v16, v16, v17, v18
v_max3_u32 v20, v20, v21, v22
v_max3_u32 v16, v16, v19, v23
v_max_u32 v16, v16, v20
v_cmp_eq_u32 vcc, -1, v16
s_nop 1
s_cbranch_vccz HD_4
s_add_u32 s28, s28, 1
s_cmp_gt_u32 s28, 20000
s_cbranch_scc1 HD_4
s_add_u32 s45, s44, 4
s_cmp_ge_u32 s45, 14
s_cselect_b32 s46, 14, 0
s_sub_u32 s45, s45, s46
s_lshl_b32 s47, s45, 17
s_add_u32 s47, s47, s35
s_add_u32 s39, s47, 16384
s_add_u32 m0, s37, 67632
s_nop 0
buffer_load_dwordx4 v8, s[40:43], s47 offen sc1 lds
s_add_u32 m0, s37, 68688
s_nop 0
buffer_load_dwordx4 v8, s[40:43], s39 offen sc1 lds
s_waitcnt vmcnt(0)
s_branch HV_4
HD_4:
s_barrier
s_add_u32 s45, s44, 8
s_cmp_ge_u32 s45, 14
s_cselect_b32 s46, 14, 0
s_sub_u32 s45, s45, s46
s_mul_i32 s46, s45, 114688
s_add_u32 s46, s46, s32
s_add_u32 s39, s46, 14336
s_add_u32 m0, s37, 25360
s_nop 0
buffer_load_dwordx4 v4, s[12:15], s46 offen lds
s_add_u32 m0, s37, 26416
s_nop 0
buffer_load_dwordx4 v4, s[12:15], s39 offen lds
s_add_u32 m0, s37, 33824
s_nop 0
buffer_load_dwordx4 v4, s[16:19], s46 offen lds
s_add_u32 m0, s37, 34880
s_nop 0
buffer_load_dwordx4 v4, s[16:19], s39 offen lds
s_add_u32 s45, s44, 8
s_cmp_ge_u32 s45, 14
s_cselect_b32 s46, 14, 0
s_sub_u32 s45, s45, s46
s_lshl_b32 s47, s45, 17
s_add_u32 s47, s47, s35
s_add_u32 s39, s47, 16384
s_add_u32 m0, s37, 42272
s_nop 0
buffer_load_dwordx4 v8, s[40:43], s47 offen sc1 lds
s_add_u32 m0, s37, 43328
s_nop 0
buffer_load_dwordx4 v8, s[40:43], s39 offen sc1 lds
s_waitcnt vmcnt(18)
s_mov_b32 s28, 0
HV_5:
v_add_u32 v11, 92992, v10
ds_read_b128 v[16:19], v11
ds_read_b128 v[20:23], v11 offset:1056
s_waitcnt lgkmcnt(0)
v_max3_u32 v16, v16, v17, v18
v_max3_u32 v20, v20, v21, v22
v_max3_u32 v16, v16, v19, v23
v_max_u32 v16, v16, v20
v_cmp_eq_u32 vcc, -1, v16
s_nop 1
s_cbranch_vccz HD_5
s_add_u32 s28, s28, 1
s_cmp_gt_u32 s28, 20000
s_cbranch_scc1 HD_5
s_add_u32 s45, s44, 5
s_cmp_ge_u32 s45, 14
s_cselect_b32 s46, 14, 0
s_sub_u32 s45, s45, s46
s_lshl_b32 s47, s45, 17
s_add_u32 s47, s47, s35
s_add_u32 s39, s47, 16384
s_add_u32 m0, s37, 92992
s_nop 0
buffer_load_dwordx4 v8, s[40:43], s47 offen sc1 lds
s_add_u32 m0, s37, 94048
s_nop 0
buffer_load_dwordx4 v8, s[40:43], s39 offen sc1 lds
s_waitcnt vmcnt(0)
s_branch HV_5
HD_5:
s_barrier
s_add_u32 s45, s44, 9
s_cmp_ge_u32 s45, 14
s_cselect_b32 s46, 14, 0
s_sub_u32 s45, s45, s46
s_mul_i32 s46, s45, 114688
s_add_u32 s46, s46, s32
s_add_u32 s39, s46, 14336
s_add_u32 m0, s37, 50720
s_nop 0
buffer_load_dwordx4 v4, s[12:15], s46 offen lds
s_add_u32 m0, s37, 51776
s_nop 0
buffer_load_dwordx4 v4, s[12:15], s39 offen lds
s_add_u32 m0, s37, 59184
s_nop 0
buffer_load_dwordx4 v4, s[16:19], s46 offen lds
s_add_u32 m0, s37, 60240
s_nop 0
buffer_load_dwordx4 v4, s[16:19], s39 offen lds
s_add_u32 s45, s44, 9
s_cmp_ge_u32 s45, 14
s_cselect_b32 s46, 14, 0
s_sub_u32 s45, s45, s46
s_lshl_b32 s47, s45, 17
s_add_u32 s47, s47, s35
s_add_u32 s39, s47, 16384
s_add_u32 m0, s37, 67632
s_nop 0
buffer_load_dwordx4 v8, s[40:43], s47 offen sc1 lds
s_add_u32 m0, s37, 68688
s_nop 0
buffer_load_dwordx4 v8, s[40:43], s39 offen sc1 lds
s_waitcnt vmcnt(18)
s_mov_b32 s28, 0
HV_6:
v_add_u32 v11, 118352, v10
ds_read_b128 v[16:19], v11
ds_read_b128 v[20:23], v11 offset:1056
s_waitcnt lgkmcnt(0)
v_max3_u32 v16, v16, v17, v18
v_max3_u32 v20, v20, v21, v22
v_max3_u32 v16, v16, v19, v23
v_max_u32 v16, v16, v20
v_cmp_eq_u32 vcc, -1, v16
s_nop 1
s_cbranch_vccz HD_6
s_add_u32 s28, s28, 1
s_cmp_gt_u32 s28, 20000
s_cbranch_scc1 HD_6
s_add_u32 s45, s44, 6
s_cmp_ge_u32 s45, 14
s_cselect_b32 s46, 14, 0
s_sub_u32 s45, s45, s46
s_lshl_b32 s47, s45, 17
s_add_u32 s47, s47, s35
s_add_u32 s39, s47, 16384
s_add_u32 m0, s37, 118352
s_nop 0
buffer_load_dwordx4 v8, s[40:43], s47 offen sc1 lds
s_add_u32 m0, s37, 119408
s_nop 0
buffer_load_dwordx4 v8, s[40:43], s39 offen sc1 lds
s_waitcnt vmcnt(0)
s_branch HV_6
HD_6:
s_barrier
s_add_u32 s45, s44, 10
s_cmp_ge_u32 s45, 14
s_cselect_b32 s46, 14, 0
s_sub_u32 s45, s45, s46
s_mul_i32 s46, s45, 114688
s_add_u32 s46, s46, s32
s_add_u32 s39, s46, 14336
s_add_u32 m0, s37, 76080
s_nop 0
buffer_load_dwordx4 v4, s[12:15], s46 offen lds
s_add_u32 m0, s37, 77136
s_nop 0
buffer_load_dwordx4 v4, s[12:15], s39 offen lds
s_add_u32 m0, s37, 84544
s_nop 0
buffer_load_dwordx4 v4, s[16:19], s46 offen lds
s_add_u32 m0, s37, 85600
s_nop 0
buffer_load_dwordx4 v4, s[16:19], s39 offen lds
s_add_u32 s45, s44, 10
s_cmp_ge_u32 s45, 14
s_cselect_b32 s46, 14, 0
s_sub_u32 s45, s45, s46
s_lshl_b32 s47, s45, 17
s_add_u32 s47, s47, s35
s_add_u32 s39, s47, 16384
s_add_u32 m0, s37, 92992
s_nop 0
buffer_load_dwordx4 v8, s[40:43], s47 offen sc1 lds
s_add_u32 m0, s37, 94048
s_nop 0
buffer_load_dwordx4 v8, s[40:43], s39 offen sc1 lds
s_waitcnt vmcnt(18)
s_mov_b32 s28, 0
HV_7:
v_add_u32 v11, 16912, v10
ds_read_b128 v[16:19], v11
ds_read_b128 v[20:23], v11 offset:1056
s_waitcnt lgkmcnt(0)
v_max3_u32 v16, v16, v17, v18
v_max3_u32 v20, v20, v21, v22
v_max3_u32 v16, v16, v19, v23
v_max_u32 v16, v16, v20
v_cmp_eq_u32 vcc, -1, v16
s_nop 1
s_cbranch_vccz HD_7
s_add_u32 s28, s28, 1
s_cmp_gt_u32 s28, 20000
s_cbranch_scc1 HD_7
s_add_u32 s45, s44, 7
s_cmp_ge_u32 s45, 14
s_cselect_b32 s46, 14, 0
s_sub_u32 s45, s45, s46
s_lshl_b32 s47, s45, 17
s_add_u32 s47, s47, s35
s_add_u32 s39, s47, 16384
s_add_u32 m0, s37, 16912
s_nop 0
buffer_load_dwordx4 v8, s[40:43], s47 offen sc1 lds
s_add_u32 m0, s37, 17968
s_nop 0
buffer_load_dwordx4 v8, s[40:43], s39 offen sc1 lds
s_waitcnt vmcnt(0)
s_branch HV_7
HD_7:
s_barrier
s_add_u32 s45, s44, 11
s_cmp_ge_u32 s45, 14
s_cselect_b32 s46, 14, 0
s_sub_u32 s45, s45, s46
s_mul_i32 s46, s45, 114688
s_add_u32 s46, s46, s32
s_add_u32 s39, s46, 14336
s_add_u32 m0, s37, 101440
s_nop 0
buffer_load_dwordx4 v4, s[12:15], s46 offen lds
s_add_u32 m0, s37, 102496
s_nop 0
buffer_load_dwordx4 v4, s[12:15], s39 offen lds
s_add_u32 m0, s37, 109904
s_nop 0
buffer_load_dwordx4 v4, s[16:19], s46 offen lds
s_add_u32 m0, s37, 110960
s_nop 0
buffer_load_dwordx4 v4, s[16:19], s39 offen lds
s_add_u32 s45, s44, 11
s_cmp_ge_u32 s45, 14
s_cselect_b32 s46, 14, 0
s_sub_u32 s45, s45, s46
s_lshl_b32 s47, s45, 17
s_add_u32 s47, s47, s35
s_add_u32 s39, s47, 16384
s_add_u32 m0, s37, 118352
s_nop 0
buffer_load_dwordx4 v8, s[40:43], s47 offen sc1 lds
s_add_u32 m0, s37, 119408
s_nop 0
buffer_load_dwordx4 v8, s[40:43], s39 offen sc1 lds
s_waitcnt vmcnt(18)
s_mov_b32 s28, 0
HV_8:
v_add_u32 v11, 42272, v10
ds_read_b128 v[16:19], v11
ds_read_b128 v[20:23], v11 offset:1056
s_waitcnt lgkmcnt(0)
v_max3_u32 v16, v16, v17, v18
v_max3_u32 v20, v20, v21, v22
v_max3_u32 v16, v16, v19, v23
v_max_u32 v16, v16, v20
v_cmp_eq_u32 vcc, -1, v16
s_nop 1
s_cbranch_vccz HD_8
s_add_u32 s28, s28, 1
s_cmp_gt_u32 s28, 20000
s_cbranch_scc1 HD_8
s_add_u32 s45, s44, 8
s_cmp_ge_u32 s45, 14
s_cselect_b32 s46, 14, 0
s_sub_u32 s45, s45, s46
s_lshl_b32 s47, s45, 17
s_add_u32 s47, s47, s35
s_add_u32 s39, s47, 16384
s_add_u32 m0, s37, 42272
s_nop 0
buffer_load_dwordx4 v8, s[40:43], s47 offen sc1 lds
s_add_u32 m0, s37, 43328
s_nop 0
buffer_load_dwordx4 v8, s[40:43], s39 offen sc1 lds
s_waitcnt vmcnt(0)
s_branch HV_8
HD_8:
s_barrier
s_add_u32 s45, s44, 12
s_cmp_ge_u32 s45, 14
s_cselect_b32 s46, 14, 0
s_sub_u32 s45, s45, s46
s_mul_i32 s46, s45, 114688
s_add_u32 s46, s46, s32
s_add_u32 s39, s46, 14336
s_add_u32 m0, s37, 0
s_nop 0
buffer_load_dwordx4 v4, s[12:15], s46 offen lds
s_add_u32 m0, s37, 1056
s_nop 0
buffer_load_dwordx4 v4, s[12:15], s39 offen lds
s_add_u32 m0, s37, 8464
s_nop 0
buffer_load_dwordx4 v4, s[16:19], s46 offen lds
s_add_u32 m0, s37, 9520
s_nop 0
buffer_load_dwordx4 v4, s[16:19], s39 offen lds
s_add_u32 s45, s44, 12
s_cmp_ge_u32 s45, 14
s_cselect_b32 s46, 14, 0
s_sub_u32 s45, s45, s46
s_lshl_b32 s47, s45, 17
s_add_u32 s47, s47, s35
s_add_u32 s39, s47, 16384
s_add_u32 m0, s37, 16912
s_nop 0
buffer_load_dwordx4 v8, s[40:43], s47 offen sc1 lds
s_add_u32 m0, s37, 17968
s_nop 0
buffer_load_dwordx4 v8, s[40:43], s39 offen sc1 lds
s_cmp_lg_u32 s31, 0
s_cbranch_scc1 P3_NOCS
v_cmp_ne_u32 vcc, s3, v24
s_nop 1
s_cbranch_vccz P3_CSOK
s_mov_b32 s56, 16384
s_mov_b32 s28, 0
buffer_load_dword v24, v12, s[8:11], s56 offen sc1
POLL_S2c:
s_waitcnt vmcnt(0)
v_xor_b32 v24, s3, v24
v_cmp_ne_u32 vcc, 0, v24
s_nop 1
s_cbranch_vccz POLLD_S2c
buffer_load_dword v24, v12, s[8:11], s56 offen sc1
s_add_u32 s28, s28, 1
s_cmp_gt_u32 s28, 60000
s_cbranch_scc0 POLL_S2c
POLLD_S2c:
P3_CSOK:
v_cmp_gt_u32 vcc, 28, v1
v_subrev_u32 v15, 448, v9
v_add_u32 v15, 7168, v15
v_cndmask_b32 v15, v15, v9, vcc
s_mul_i32 s58, s21, 448
s_mov_b32 s56, -1
s_mov_b32 s57, 0x00ffffff
s_mov_b64 exec, s[56:57]
s_mov_b32 m0, 159744
s_nop 0
buffer_load_dwordx4 v15, s[48:51], s58 offen sc1 lds
s_mov_b64 exec, -1
P3_NOCS:
s_waitcnt vmcnt(18)
s_mov_b32 s28, 0
HV_9:
v_add_u32 v11, 67632, v10
ds_read_b128 v[16:19], v11
ds_read_b128 v[20:23], v11 offset:1056
s_waitcnt lgkmcnt(0)
v_max3_u32 v16, v16, v17, v18
v_max3_u32 v20, v20, v21, v22
v_max3_u32 v16, v16, v19, v23
v_max_u32 v16, v16, v20
v_cmp_eq_u32 vcc, -1, v16
s_nop 1
s_cbranch_vccz HD_9
s_add_u32 s28, s28, 1
s_cmp_gt_u32 s28, 20000
s_cbranch_scc1 HD_9
s_add_u32 s45, s44, 9
s_cmp_ge_u32 s45, 14
s_cselect_b32 s46, 14, 0
s_sub_u32 s45, s45, s46
s_lshl_b32 s47, s45, 17
s_add_u32 s47, s47, s35
s_add_u32 s39, s47, 16384
s_add_u32 m0, s37, 67632
s_nop 0
buffer_load_dwordx4 v8, s[40:43], s47 offen sc1 lds
s_add_u32 m0, s37, 68688
s_nop 0
buffer_load_dwordx4 v8, s[40:43], s39 offen sc1 lds
s_waitcnt vmcnt(0)
s_branch HV_9
HD_9:
s_barrier
s_add_u32 s45, s44, 13
s_cmp_ge_u32 s45, 14
s_cselect_b32 s46, 14, 0
s_sub_u32 s45, s45, s46
s_mul_i32 s46, s45, 114688
s_add_u32 s46, s46, s32
s_add_u32 s39, s46, 14336
s_add_u32 m0, s37, 25360
s_nop 0
buffer_load_dwordx4 v4, s[12:15], s46 offen lds
s_add_u32 m0, s37, 26416
s_nop 0
buffer_load_dwordx4 v4, s[12:15], s39 offen lds
s_add_u32 m0, s37, 33824
s_nop 0
buffer_load_dwordx4 v4, s[16:19], s46 offen lds
s_add_u32 m0, s37, 34880
s_nop 0
buffer_load_dwordx4 v4, s[16:19], s39 offen lds
s_add_u32 s45, s44, 13
s_cmp_ge_u32 s45, 14
s_cselect_b32 s46, 14, 0
s_sub_u32 s45, s45, s46
s_lshl_b32 s47, s45, 17
s_add_u32 s47, s47, s35
s_add_u32 s39, s47, 16384
s_add_u32 m0, s37, 42272
s_nop 0
buffer_load_dwordx4 v8, s[40:43], s47 offen sc1 lds
s_add_u32 m0, s37, 43328
s_nop 0
buffer_load_dwordx4 v8, s[40:43], s39 offen sc1 lds
s_waitcnt vmcnt(18)
s_mov_b32 s28, 0
HV_10:
v_add_u32 v11, 92992, v10
ds_read_b128 v[16:19], v11
ds_read_b128 v[20:23], v11 offset:1056
s_waitcnt lgkmcnt(0)
v_max3_u32 v16, v16, v17, v18
v_max3_u32 v20, v20, v21, v22
v_max3_u32 v16, v16, v19, v23
v_max_u32 v16, v16, v20
v_cmp_eq_u32 vcc, -1, v16
s_nop 1
s_cbranch_vccz HD_10
s_add_u32 s28, s28, 1
s_cmp_gt_u32 s28, 20000
s_cbranch_scc1 HD_10
s_add_u32 s45, s44, 10
s_cmp_ge_u32 s45, 14
s_cselect_b32 s46, 14, 0
s_sub_u32 s45, s45, s46
s_lshl_b32 s47, s45, 17
s_add_u32 s47, s47, s35
s_add_u32 s39, s47, 16384
s_add_u32 m0, s37, 92992
s_nop 0
buffer_load_dwordx4 v8, s[40:43], s47 offen sc1 lds
s_add_u32 m0, s37, 94048
s_nop 0
buffer_load_dwordx4 v8, s[40:43], s39 offen sc1 lds
s_waitcnt vmcnt(0)
s_branch HV_10
HD_10:
s_barrier
s_cmp_ge_u32 s2, 224
s_cbranch_scc1 P3_NOWD
s_load_dwordx2 s[60:61], s[0:1], 96
s_lshr_b32 s56, s2, 3
s_mul_i32 s56, s56, 57344
s_mul_i32 s57, s31, 14336
s_add_u32 s56, s56, s57
v_lshlrev_b32 v12, 7, v1
s_mov_b32 s62, 1605632
s_mov_b32 s63, 0x20000
s_waitcnt lgkmcnt(0)
buffer_load_dword v254, v12, s[60:63], s56 offen
s_add_u32 s56, s56, 8192
s_mov_b32 s58, -1
s_mov_b32 s59, 0xffff
s_mov_b64 exec, s[58:59]
buffer_load_dword v253, v12, s[60:63], s56 offen
s_mov_b64 exec, -1
s_branch P3_WD2
P3_NOWD:
buffer_load_dword v254, v9, s[40:43], 0 offen
buffer_load_dword v253, v9, s[40:43], 0 offen
P3_WD2:
s_waitcnt vmcnt(14)
s_mov_b32 s28, 0
HV_11:
v_add_u32 v11, 118352, v10
ds_read_b128 v[16:19], v11
ds_read_b128 v[20:23], v11 offset:1056
s_waitcnt lgkmcnt(0)
v_max3_u32 v16, v16, v17, v18
v_max3_u32 v20, v20, v21, v22
v_max3_u32 v16, v16, v19, v23
v_max_u32 v16, v16, v20
v_cmp_eq_u32 vcc, -1, v16
s_nop 1
s_cbranch_vccz HD_11
s_add_u32 s28, s28, 1
s_cmp_gt_u32 s28, 20000
s_cbranch_scc1 HD_11
s_add_u32 s45, s44, 11
s_cmp_ge_u32 s45, 14
s_cselect_b32 s46, 14, 0
s_sub_u32 s45, s45, s46
s_lshl_b32 s47, s45, 17
s_add_u32 s47, s47, s35
s_add_u32 s39, s47, 16384
s_add_u32 m0, s37, 118352
s_nop 0
buffer_load_dwordx4 v8, s[40:43], s47 offen sc1 lds
s_add_u32 m0, s37, 119408
s_nop 0
buffer_load_dwordx4 v8, s[40:43], s39 offen sc1 lds
s_waitcnt vmcnt(0)
s_branch HV_11
HD_11:
s_barrier
s_waitcnt vmcnt(8)
s_mov_b32 s28, 0
HV_12:
v_add_u32 v11, 16912, v10
ds_read_b128 v[16:19], v11
ds_read_b128 v[20:23], v11 offset:1056
s_waitcnt lgkmcnt(0)
v_max3_u32 v16, v16, v17, v18
v_max3_u32 v20, v20, v21, v22
v_max3_u32 v16, v16, v19, v23
v_max_u32 v16, v16, v20
v_cmp_eq_u32 vcc, -1, v16
s_nop 1
s_cbranch_vccz HD_12
s_add_u32 s28, s28, 1
s_cmp_gt_u32 s28, 20000
s_cbranch_scc1 HD_12
s_add_u32 s45, s44, 12
s_cmp_ge_u32 s45, 14
s_cselect_b32 s46, 14, 0
s_sub_u32 s45, s45, s46
s_lshl_b32 s47, s45, 17
s_add_u32 s47, s47, s35
s_add_u32 s39, s47, 16384
s_add_u32 m0, s37, 16912
s_nop 0
buffer_load_dwordx4 v8, s[40:43], s47 offen sc1 lds
s_add_u32 m0, s37, 17968
s_nop 0
buffer_load_dwordx4 v8, s[40:43], s39 offen sc1 lds
s_waitcnt vmcnt(0)
s_branch HV_12
HD_12:
s_barrier
s_waitcnt vmcnt(2)
s_mov_b32 s28, 0
HV_13:
v_add_u32 v11, 42272, v10
ds_read_b128 v[16:19], v11
ds_read_b128 v[20:23], v11 offset:1056
s_waitcnt lgkmcnt(0)
v_max3_u32 v16, v16, v17, v18
v_max3_u32 v20, v20, v21, v22
v_max3_u32 v16, v16, v19, v23
v_max_u32 v16, v16, v20
v_cmp_eq_u32 vcc, -1, v16
s_nop 1
s_cbranch_vccz HD_13
s_add_u32 s28, s28, 1
s_cmp_gt_u32 s28, 20000
s_cbranch_scc1 HD_13
s_add_u32 s45, s44, 13
s_cmp_ge_u32 s45, 14
s_cselect_b32 s46, 14, 0
s_sub_u32 s45, s45, s46
s_lshl_b32 s47, s45, 17
s_add_u32 s47, s47, s35
s_add_u32 s39, s47, 16384
s_add_u32 m0, s37, 42272
s_nop 0
buffer_load_dwordx4 v8, s[40:43], s47 offen sc1 lds
s_add_u32 m0, s37, 43328
s_nop 0
buffer_load_dwordx4 v8, s[40:43], s39 offen sc1 lds
s_waitcnt vmcnt(0)
s_branch HV_13
HD_13:
s_barrier
s_cmp_ge_u32 s2, 224
s_cbranch_scc1 P3_NOG2
s_load_dwordx4 s[44:47], s[0:1], 96
s_sub_u32 s31, s30, 4
s_and_b32 s22, s2, 7
s_lshr_b32 s23, s2, 3
s_lshl_b32 s20, s22, 2
s_and_b32 s24, s23, 3
s_add_u32 s20, s20, s24
s_lshr_b32 s21, s23, 2
s_mul_i32 s40, s24, 7
s_lshr_b32 s40, s40, 1
s_lshl_b32 s41, s21, 1
s_add_u32 s40, s40, s41
s_cmp_ge_u32 s40, 14
s_cselect_b32 s41, 14, 0
s_sub_u32 s40, s40, s41
v_lshrrev_b32 v3, 3, v1
v_and_b32 v4, 7, v1
v_bfe_u32 v5, v1, 4, 2
v_lshlrev_b32 v5, 1, v5
v_xor_b32 v4, v4, v5
v_mul_u32_u24 v6, 896, v3
v_lshl_add_u32 v6, v4, 4, v6
v_lshlrev_b32 v7, 4, v1
s_mul_i32 s32, s31, 401408
s_lshl_b32 s33, s21, 7
s_add_u32 s32, s32, s33
s_lshl_b32 s33, s20, 2
s_mul_i32 s33, s33, 57344
s_mul_i32 s34, s31, 14336
s_add_u32 s33, s33, s34
s_add_u32 s35, s31, 2
s_mul_i32 s35, s35, 25360
s_cmp_eq_u32 s31, 3
s_cselect_b32 s35, 0, s35
s_mov_b32 s14, 1605632
s_mov_b32 s15, 0x20000
s_mov_b32 s18, 1835008
s_mov_b32 s19, 0x20000
s_waitcnt lgkmcnt(0)
s_mov_b32 s12, s44
s_mov_b32 s13, s45
s_mov_b32 s16, s46
s_mov_b32 s17, s47
s_add_u32 s48, s4, 4718592
s_addc_u32 s49, s5, 0
s_mov_b32 s50, 1835008
s_mov_b32 s51, 0x20000
s_add_u32 s52, s4, 6815744
s_addc_u32 s53, s5, 0
s_mov_b32 s54, 7340032
s_mov_b32 s55, 0x20000
s_add_u32 s41, s40, 0
s_cmp_ge_u32 s41, 14
s_cselect_b32 s42, 14, 0
s_sub_u32 s41, s41, s42
s_mul_i32 s42, s41, 28672
s_add_u32 s42, s42, s32
s_add_u32 m0, s35, 0
s_nop 0
buffer_load_dwordx4 v6, s[12:15], s42 offen lds
s_add_u32 m0, s35, 1024
s_add_u32 s42, s42, 7168
buffer_load_dwordx4 v6, s[12:15], s42 offen lds
s_add_u32 m0, s35, 2048
s_add_u32 s42, s42, 7168
buffer_load_dwordx4 v6, s[12:15], s42 offen lds
s_add_u32 m0, s35, 3072
s_add_u32 s42, s42, 7168
buffer_load_dwordx4 v6, s[12:15], s42 offen lds
s_add_u32 s41, s40, 1
s_cmp_ge_u32 s41, 14
s_cselect_b32 s42, 14, 0
s_sub_u32 s41, s41, s42
s_mul_i32 s42, s41, 28672
s_add_u32 s42, s42, s32
s_add_u32 m0, s35, 4096
s_nop 0
buffer_load_dwordx4 v6, s[12:15], s42 offen lds
s_add_u32 m0, s35, 5120
s_add_u32 s42, s42, 7168
buffer_load_dwordx4 v6, s[12:15], s42 offen lds
s_add_u32 m0, s35, 6144
s_add_u32 s42, s42, 7168
buffer_load_dwordx4 v6, s[12:15], s42 offen lds
s_add_u32 m0, s35, 7168
s_add_u32 s42, s42, 7168
buffer_load_dwordx4 v6, s[12:15], s42 offen lds
s_add_u32 s41, s40, 2
s_cmp_ge_u32 s41, 14
s_cselect_b32 s42, 14, 0
s_sub_u32 s41, s41, s42
s_mul_i32 s42, s41, 28672
s_add_u32 s42, s42, s32
s_add_u32 m0, s35, 8192
s_nop 0
buffer_load_dwordx4 v6, s[12:15], s42 offen lds
s_add_u32 m0, s35, 9216
s_add_u32 s42, s42, 7168
buffer_load_dwordx4 v6, s[12:15], s42 offen lds
s_add_u32 m0, s35, 10240
s_add_u32 s42, s42, 7168
buffer_load_dwordx4 v6, s[12:15], s42 offen lds
s_add_u32 m0, s35, 11264
s_add_u32 s42, s42, 7168
buffer_load_dwordx4 v6, s[12:15], s42 offen lds
s_add_u32 s41, s40, 3
s_cmp_ge_u32 s41, 14
s_cselect_b32 s42, 14, 0
s_sub_u32 s41, s41, s42
s_mul_i32 s42, s41, 28672
s_add_u32 s42, s42, s32
s_add_u32 m0, s35, 12288
s_nop 0
buffer_load_dwordx4 v6, s[12:15], s42 offen lds
s_add_u32 m0, s35, 13312
s_add_u32 s42, s42, 7168
buffer_load_dwordx4 v6, s[12:15], s42 offen lds
s_add_u32 m0, s35, 14336
s_add_u32 s42, s42, 7168
buffer_load_dwordx4 v6, s[12:15], s42 offen lds
s_add_u32 m0, s35, 15360
s_add_u32 s42, s42, 7168
buffer_load_dwordx4 v6, s[12:15], s42 offen lds
s_add_u32 s41, s40, 4
s_cmp_ge_u32 s41, 14
s_cselect_b32 s42, 14, 0
s_sub_u32 s41, s41, s42
s_mul_i32 s42, s41, 28672
s_add_u32 s42, s42, s32
s_add_u32 m0, s35, 16384
s_nop 0
buffer_load_dwordx4 v6, s[12:15], s42 offen lds
s_add_u32 m0, s35, 17408
s_add_u32 s42, s42, 7168
buffer_load_dwordx4 v6, s[12:15], s42 offen lds
s_add_u32 m0, s35, 18432
s_add_u32 s42, s42, 7168
buffer_load_dwordx4 v6, s[12:15], s42 offen lds
s_add_u32 m0, s35, 19456
s_add_u32 s42, s42, 7168
buffer_load_dwordx4 v6, s[12:15], s42 offen lds
s_add_u32 s41, s40, 5
s_cmp_ge_u32 s41, 14
s_cselect_b32 s42, 14, 0
s_sub_u32 s41, s41, s42
s_mul_i32 s42, s41, 28672
s_add_u32 s42, s42, s32
s_add_u32 m0, s35, 20480
s_nop 0
buffer_load_dwordx4 v6, s[12:15], s42 offen lds
s_add_u32 m0, s35, 21504
s_add_u32 s42, s42, 7168
buffer_load_dwordx4 v6, s[12:15], s42 offen lds
s_add_u32 m0, s35, 22528
s_add_u32 s42, s42, 7168
buffer_load_dwordx4 v6, s[12:15], s42 offen lds
s_add_u32 m0, s35, 23552
s_add_u32 s42, s42, 7168
buffer_load_dwordx4 v6, s[12:15], s42 offen lds
v_lshrrev_b32 v2, 4, v1
v_bfe_u32 v3, v1, 2, 2
v_and_b32 v4, 3, v1
v_lshrrev_b32 v5, 1, v2
v_lshlrev_b32 v5, 4, v5
v_and_b32 v8, 1, v2
v_lshl_add_u32 v5, v8, 2, v5
v_add_u32 v5, v5, v3
v_bfe_u32 v9, v5, 1, 2
v_lshlrev_b32 v5, 7, v5
v_lshl_add_u32 v5, v4, 3, v5
v_add_u32 v5, s35, v5
v_xor_b32 v8, 0, v9
v_lshl_add_u32 v10, v8, 5, v5
v_xor_b32 v8, 1, v9
v_lshl_add_u32 v11, v8, 5, v5
v_xor_b32 v8, 2, v9
v_lshl_add_u32 v12, v8, 5, v5
v_xor_b32 v8, 3, v9
v_lshl_add_u32 v13, v8, 5, v5
P3_NOG2:
s_barrier
s_barrier
s_cmp_ge_u32 s2, 224
s_cbranch_scc1 M_FIN
s_add_u32 s41, s40, 0
s_cmp_ge_u32 s41, 14
s_cselect_b32 s42, 14, 0
s_sub_u32 s41, s41, s42
s_lshl_b32 s42, s41, 10
s_add_u32 s42, s42, s33
buffer_load_dwordx4 v[96:99], v7, s[52:55], s42 offen sc1
s_add_u32 s42, s42, 57344
buffer_load_dwordx4 v[100:103], v7, s[52:55], s42 offen sc1
s_add_u32 s42, s42, 57344
buffer_load_dwordx4 v[104:107], v7, s[52:55], s42 offen sc1
s_add_u32 s42, s42, 57344
buffer_load_dwordx4 v[108:111], v7, s[52:55], s42 offen sc1
s_waitcnt vmcnt(0)
s_mov_b32 s28, 0
GV_0:
v_max3_u32 v14, v96, v97, v98
v_max3_u32 v15, v99, v100, v101
v_max3_u32 v14, v14, v102, v103
v_max3_u32 v15, v15, v104, v105
v_max3_u32 v14, v14, v106, v107
v_max3_u32 v15, v15, v108, v109
v_max3_u32 v14, v14, v110, v111
v_max_u32 v14, v14, v15
v_cmp_eq_u32 vcc, -1, v14
s_nop 1
s_cbranch_vccz GD_0
s_add_u32 s28, s28, 1
s_cmp_gt_u32 s28, 20000
s_cbranch_scc1 GD_0
s_add_u32 s41, s40, 0
s_cmp_ge_u32 s41, 14
s_cselect_b32 s42, 14, 0
s_sub_u32 s41, s41, s42
s_lshl_b32 s42, s41, 10
s_add_u32 s42, s42, s33
buffer_load_dwordx4 v[96:99], v7, s[52:55], s42 offen sc1
s_add_u32 s42, s42, 57344
buffer_load_dwordx4 v[100:103], v7, s[52:55], s42 offen sc1
s_add_u32 s42, s42, 57344
buffer_load_dwordx4 v[104:107], v7, s[52:55], s42 offen sc1
s_add_u32 s42, s42, 57344
buffer_load_dwordx4 v[108:111], v7, s[52:55], s42 offen sc1
s_waitcnt vmcnt(0)
s_branch GV_0
GD_0:
s_add_u32 s41, s40, 1
s_cmp_ge_u32 s41, 14
s_cselect_b32 s42, 14, 0
s_sub_u32 s41, s41, s42
s_lshl_b32 s42, s41, 10
s_add_u32 s42, s42, s33
buffer_load_dwordx4 v[112:115], v7, s[52:55], s42 offen sc1
s_add_u32 s42, s42, 57344
buffer_load_dwordx4 v[116:119], v7, s[52:55], s42 offen sc1
s_add_u32 s42, s42, 57344
buffer_load_dwordx4 v[120:123], v7, s[52:55], s42 offen sc1
s_add_u32 s42, s42, 57344
buffer_load_dwordx4 v[124:127], v7, s[52:55], s42 offen sc1
s_add_u32 s41, s40, 2
s_cmp_ge_u32 s41, 14
s_cselect_b32 s42, 14, 0
s_sub_u32 s41, s41, s42
s_lshl_b32 s42, s41, 10
s_add_u32 s42, s42, s33
buffer_load_dwordx4 v[128:131], v7, s[52:55], s42 offen sc1
s_add_u32 s42, s42, 57344
buffer_load_dwordx4 v[132:135], v7, s[52:55], s42 offen sc1
s_add_u32 s42, s42, 57344
buffer_load_dwordx4 v[136:139], v7, s[52:55], s42 offen sc1
s_add_u32 s42, s42, 57344
buffer_load_dwordx4 v[140:143], v7, s[52:55], s42 offen sc1
s_add_u32 s41, s40, 3
s_cmp_ge_u32 s41, 14
s_cselect_b32 s42, 14, 0
s_sub_u32 s41, s41, s42
s_lshl_b32 s42, s41, 10
s_add_u32 s42, s42, s33
buffer_load_dwordx4 v[144:147], v7, s[52:55], s42 offen sc1
s_add_u32 s42, s42, 57344
buffer_load_dwordx4 v[148:151], v7, s[52:55], s42 offen sc1
s_add_u32 s42, s42, 57344
buffer_load_dwordx4 v[152:155], v7, s[52:55], s42 offen sc1
s_add_u32 s42, s42, 57344
buffer_load_dwordx4 v[156:159], v7, s[52:55], s42 offen sc1
s_add_u32 s41, s40, 4
s_cmp_ge_u32 s41, 14
s_cselect_b32 s42, 14, 0
s_sub_u32 s41, s41, s42
s_lshl_b32 s42, s41, 10
s_add_u32 s42, s42, s33
buffer_load_dwordx4 v[160:163], v7, s[52:55], s42 offen sc1
s_add_u32 s42, s42, 57344
buffer_load_dwordx4 v[164:167], v7, s[52:55], s42 offen sc1
s_add_u32 s42, s42, 57344
buffer_load_dwordx4 v[168:171], v7, s[52:55], s42 offen sc1
s_add_u32 s42, s42, 57344
buffer_load_dwordx4 v[172:175], v7, s[52:55], s42 offen sc1
s_add_u32 s41, s40, 5
s_cmp_ge_u32 s41, 14
s_cselect_b32 s42, 14, 0
s_sub_u32 s41, s41, s42
s_lshl_b32 s42, s41, 10
s_add_u32 s42, s42, s33
buffer_load_dwordx4 v[176:179], v7, s[52:55], s42 offen sc1
s_add_u32 s42, s42, 57344
buffer_load_dwordx4 v[180:183], v7, s[52:55], s42 offen sc1
s_add_u32 s42, s42, 57344
buffer_load_dwordx4 v[184:187], v7, s[52:55], s42 offen sc1
s_add_u32 s42, s42, 57344
buffer_load_dwordx4 v[188:191], v7, s[52:55], s42 offen sc1
v_lshrrev_b32 v8, 3, v1
v_lshlrev_b32 v8, 12, v8
v_and_b32 v9, 7, v1
v_lshl_add_u32 v8, v9, 4, v8
s_lshl_b32 s37, s21, 6
s_lshl_b32 s38, s31, 4
s_add_u32 s37, s37, s38
s_lshl_b32 s37, s37, 12
s_lshl_b32 s38, s20, 7
s_add_u32 s37, s37, s38
s_lshl_b32 s39, s31, 11
s_add_u32 m0, s39, 126800
s_nop 0
buffer_load_dwordx4 v8, s[48:51], s37 offen sc1 lds
s_add_u32 m0, s39, 127824
s_add_u32 s37, s37, 32768
buffer_load_dwordx4 v8, s[48:51], s37 offen sc1 lds
ds_read_b64_tr_b16 v[80:81], v10 offset:0
ds_read_b64_tr_b16 v[82:83], v10 offset:1024
ds_read_b64_tr_b16 v[84:85], v11 offset:0
ds_read_b64_tr_b16 v[86:87], v11 offset:1024
ds_read_b64_tr_b16 v[88:89], v12 offset:0
ds_read_b64_tr_b16 v[90:91], v12 offset:1024
ds_read_b64_tr_b16 v[92:93], v13 offset:0
ds_read_b64_tr_b16 v[94:95], v13 offset:1024
s_waitcnt lgkmcnt(6)
v_mfma_f32_16x16x32_bf16 v[16:19], v[80:83], v[96:99], 0
v_mfma_f32_16x16x32_bf16 v[20:23], v[80:83], v[100:103], 0
v_mfma_f32_16x16x32_bf16 v[24:27], v[80:83], v[104:107], 0
v_mfma_f32_16x16x32_bf16 v[28:31], v[80:83], v[108:111], 0
s_waitcnt lgkmcnt(4)
v_mfma_f32_16x16x32_bf16 v[32:35], v[84:87], v[96:99], 0
v_mfma_f32_16x16x32_bf16 v[36:39], v[84:87], v[100:103], 0
v_mfma_f32_16x16x32_bf16 v[40:43], v[84:87], v[104:107], 0
v_mfma_f32_16x16x32_bf16 v[44:47], v[84:87], v[108:111], 0
s_waitcnt lgkmcnt(2)
v_mfma_f32_16x16x32_bf16 v[48:51], v[88:91], v[96:99], 0
v_mfma_f32_16x16x32_bf16 v[52:55], v[88:91], v[100:103], 0
v_mfma_f32_16x16x32_bf16 v[56:59], v[88:91], v[104:107], 0
v_mfma_f32_16x16x32_bf16 v[60:63], v[88:91], v[108:111], 0
s_waitcnt lgkmcnt(0)
v_mfma_f32_16x16x32_bf16 v[64:67], v[92:95], v[96:99], 0
v_mfma_f32_16x16x32_bf16 v[68:71], v[92:95], v[100:103], 0
v_mfma_f32_16x16x32_bf16 v[72:75], v[92:95], v[104:107], 0
v_mfma_f32_16x16x32_bf16 v[76:79], v[92:95], v[108:111], 0
s_add_u32 s41, s40, 6
s_cmp_ge_u32 s41, 14
s_cselect_b32 s42, 14, 0
s_sub_u32 s41, s41, s42
s_mul_i32 s42, s41, 28672
s_add_u32 s42, s42, s32
s_add_u32 m0, s35, 0
s_nop 0
buffer_load_dwordx4 v6, s[12:15], s42 offen lds
s_add_u32 m0, s35, 1024
s_add_u32 s42, s42, 7168
buffer_load_dwordx4 v6, s[12:15], s42 offen lds
s_add_u32 m0, s35, 2048
s_add_u32 s42, s42, 7168
buffer_load_dwordx4 v6, s[12:15], s42 offen lds
s_add_u32 m0, s35, 3072
s_add_u32 s42, s42, 7168
buffer_load_dwordx4 v6, s[12:15], s42 offen lds
s_add_u32 s41, s40, 6
s_cmp_ge_u32 s41, 14
s_cselect_b32 s42, 14, 0
s_sub_u32 s41, s41, s42
s_lshl_b32 s42, s41, 10
s_add_u32 s42, s42, s33
buffer_load_dwordx4 v[96:99], v7, s[52:55], s42 offen sc1
s_add_u32 s42, s42, 57344
buffer_load_dwordx4 v[100:103], v7, s[52:55], s42 offen sc1
s_add_u32 s42, s42, 57344
buffer_load_dwordx4 v[104:107], v7, s[52:55], s42 offen sc1
s_add_u32 s42, s42, 57344
buffer_load_dwordx4 v[108:111], v7, s[52:55], s42 offen sc1
s_waitcnt vmcnt(26)
s_mov_b32 s28, 0
GV_1:
v_max3_u32 v14, v112, v113, v114
v_max3_u32 v15, v115, v116, v117
v_max3_u32 v14, v14, v118, v119
v_max3_u32 v15, v15, v120, v121
v_max3_u32 v14, v14, v122, v123
v_max3_u32 v15, v15, v124, v125
v_max3_u32 v14, v14, v126, v127
v_max_u32 v14, v14, v15
v_cmp_eq_u32 vcc, -1, v14
s_nop 1
s_cbranch_vccz GD_1
s_add_u32 s28, s28, 1
s_cmp_gt_u32 s28, 20000
s_cbranch_scc1 GD_1
s_add_u32 s41, s40, 1
s_cmp_ge_u32 s41, 14
s_cselect_b32 s42, 14, 0
s_sub_u32 s41, s41, s42
s_lshl_b32 s42, s41, 10
s_add_u32 s42, s42, s33
buffer_load_dwordx4 v[112:115], v7, s[52:55], s42 offen sc1
s_add_u32 s42, s42, 57344
buffer_load_dwordx4 v[116:119], v7, s[52:55], s42 offen sc1
s_add_u32 s42, s42, 57344
buffer_load_dwordx4 v[120:123], v7, s[52:55], s42 offen sc1
s_add_u32 s42, s42, 57344
buffer_load_dwordx4 v[124:127], v7, s[52:55], s42 offen sc1
s_waitcnt vmcnt(0)
s_branch GV_1
GD_1:
ds_read_b64_tr_b16 v[80:81], v10 offset:4096
ds_read_b64_tr_b16 v[82:83], v10 offset:5120
ds_read_b64_tr_b16 v[84:85], v11 offset:4096
ds_read_b64_tr_b16 v[86:87], v11 offset:5120
ds_read_b64_tr_b16 v[88:89], v12 offset:4096
ds_read_b64_tr_b16 v[90:91], v12 offset:5120
ds_read_b64_tr_b16 v[92:93], v13 offset:4096
ds_read_b64_tr_b16 v[94:95], v13 offset:5120
s_waitcnt lgkmcnt(6)
v_mfma_f32_16x16x32_bf16 v[16:19], v[80:83], v[112:115], v[16:19]
v_mfma_f32_16x16x32_bf16 v[20:23], v[80:83], v[116:119], v[20:23]
v_mfma_f32_16x16x32_bf16 v[24:27], v[80:83], v[120:123], v[24:27]
v_mfma_f32_16x16x32_bf16 v[28:31], v[80:83], v[124:127], v[28:31]
s_waitcnt lgkmcnt(4)
v_mfma_f32_16x16x32_bf16 v[32:35], v[84:87], v[112:115], v[32:35]
v_mfma_f32_16x16x32_bf16 v[36:39], v[84:87], v[116:119], v[36:39]
v_mfma_f32_16x16x32_bf16 v[40:43], v[84:87], v[120:123], v[40:43]
v_mfma_f32_16x16x32_bf16 v[44:47], v[84:87], v[124:127], v[44:47]
s_waitcnt lgkmcnt(2)
v_mfma_f32_16x16x32_bf16 v[48:51], v[88:91], v[112:115], v[48:51]
v_mfma_f32_16x16x32_bf16 v[52:55], v[88:91], v[116:119], v[52:55]
v_mfma_f32_16x16x32_bf16 v[56:59], v[88:91], v[120:123], v[56:59]
v_mfma_f32_16x16x32_bf16 v[60:63], v[88:91], v[124:127], v[60:63]
s_waitcnt lgkmcnt(0)
v_mfma_f32_16x16x32_bf16 v[64:67], v[92:95], v[112:115], v[64:67]
v_mfma_f32_16x16x32_bf16 v[68:71], v[92:95], v[116:119], v[68:71]
v_mfma_f32_16x16x32_bf16 v[72:75], v[92:95], v[120:123], v[72:75]
v_mfma_f32_16x16x32_bf16 v[76:79], v[92:95], v[124:127], v[76:79]
s_add_u32 s41, s40, 7
s_cmp_ge_u32 s41, 14
s_cselect_b32 s42, 14, 0
s_sub_u32 s41, s41, s42
s_mul_i32 s42, s41, 28672
s_add_u32 s42, s42, s32
s_add_u32 m0, s35, 4096
s_nop 0
buffer_load_dwordx4 v6, s[12:15], s42 offen lds
s_add_u32 m0, s35, 5120
s_add_u32 s42, s42, 7168
buffer_load_dwordx4 v6, s[12:15], s42 offen lds
s_add_u32 m0, s35, 6144
s_add_u32 s42, s42, 7168
buffer_load_dwordx4 v6, s[12:15], s42 offen lds
s_add_u32 m0, s35, 7168
s_add_u32 s42, s42, 7168
buffer_load_dwordx4 v6, s[12:15], s42 offen lds
s_add_u32 s41, s40, 7
s_cmp_ge_u32 s41, 14
s_cselect_b32 s42, 14, 0
s_sub_u32 s41, s41, s42
s_lshl_b32 s42, s41, 10
s_add_u32 s42, s42, s33
buffer_load_dwordx4 v[112:115], v7, s[52:55], s42 offen sc1
s_add_u32 s42, s42, 57344
buffer_load_dwordx4 v[116:119], v7, s[52:55], s42 offen sc1
s_add_u32 s42, s42, 57344
buffer_load_dwordx4 v[120:123], v7, s[52:55], s42 offen sc1
s_add_u32 s42, s42, 57344
buffer_load_dwordx4 v[124:127], v7, s[52:55], s42 offen sc1
s_waitcnt vmcnt(30)
s_mov_b32 s28, 0
GV_2:
v_max3_u32 v14, v128, v129, v130
v_max3_u32 v15, v131, v132, v133
v_max3_u32 v14, v14, v134, v135
v_max3_u32 v15, v15, v136, v137
v_max3_u32 v14, v14, v138, v139
v_max3_u32 v15, v15, v140, v141
v_max3_u32 v14, v14, v142, v143
v_max_u32 v14, v14, v15
v_cmp_eq_u32 vcc, -1, v14
s_nop 1
s_cbranch_vccz GD_2
s_add_u32 s28, s28, 1
s_cmp_gt_u32 s28, 20000
s_cbranch_scc1 GD_2
s_add_u32 s41, s40, 2
s_cmp_ge_u32 s41, 14
s_cselect_b32 s42, 14, 0
s_sub_u32 s41, s41, s42
s_lshl_b32 s42, s41, 10
s_add_u32 s42, s42, s33
buffer_load_dwordx4 v[128:131], v7, s[52:55], s42 offen sc1
s_add_u32 s42, s42, 57344
buffer_load_dwordx4 v[132:135], v7, s[52:55], s42 offen sc1
s_add_u32 s42, s42, 57344
buffer_load_dwordx4 v[136:139], v7, s[52:55], s42 offen sc1
s_add_u32 s42, s42, 57344
buffer_load_dwordx4 v[140:143], v7, s[52:55], s42 offen sc1
s_waitcnt vmcnt(0)
s_branch GV_2
GD_2:
ds_read_b64_tr_b16 v[80:81], v10 offset:8192
ds_read_b64_tr_b16 v[82:83], v10 offset:9216
ds_read_b64_tr_b16 v[84:85], v11 offset:8192
ds_read_b64_tr_b16 v[86:87], v11 offset:9216
ds_read_b64_tr_b16 v[88:89], v12 offset:8192
ds_read_b64_tr_b16 v[90:91], v12 offset:9216
ds_read_b64_tr_b16 v[92:93], v13 offset:8192
ds_read_b64_tr_b16 v[94:95], v13 offset:9216
s_waitcnt lgkmcnt(6)
v_mfma_f32_16x16x32_bf16 v[16:19], v[80:83], v[128:131], v[16:19]
v_mfma_f32_16x16x32_bf16 v[20:23], v[80:83], v[132:135], v[20:23]
v_mfma_f32_16x16x32_bf16 v[24:27], v[80:83], v[136:139], v[24:27]
v_mfma_f32_16x16x32_bf16 v[28:31], v[80:83], v[140:143], v[28:31]
s_waitcnt lgkmcnt(4)
v_mfma_f32_16x16x32_bf16 v[32:35], v[84:87], v[128:131], v[32:35]
v_mfma_f32_16x16x32_bf16 v[36:39], v[84:87], v[132:135], v[36:39]
v_mfma_f32_16x16x32_bf16 v[40:43], v[84:87], v[136:139], v[40:43]
v_mfma_f32_16x16x32_bf16 v[44:47], v[84:87], v[140:143], v[44:47]
s_waitcnt lgkmcnt(2)
v_mfma_f32_16x16x32_bf16 v[48:51], v[88:91], v[128:131], v[48:51]
v_mfma_f32_16x16x32_bf16 v[52:55], v[88:91], v[132:135], v[52:55]
v_mfma_f32_16x16x32_bf16 v[56:59], v[88:91], v[136:139], v[56:59]
v_mfma_f32_16x16x32_bf16 v[60:63], v[88:91], v[140:143], v[60:63]
s_waitcnt lgkmcnt(0)
v_mfma_f32_16x16x32_bf16 v[64:67], v[92:95], v[128:131], v[64:67]
v_mfma_f32_16x16x32_bf16 v[68:71], v[92:95], v[132:135], v[68:71]
v_mfma_f32_16x16x32_bf16 v[72:75], v[92:95], v[136:139], v[72:75]
v_mfma_f32_16x16x32_bf16 v[76:79], v[92:95], v[140:143], v[76:79]
s_add_u32 s41, s40, 8
s_cmp_ge_u32 s41, 14
s_cselect_b32 s42, 14, 0
s_sub_u32 s41, s41, s42
s_mul_i32 s42, s41, 28672
s_add_u32 s42, s42, s32
s_add_u32 m0, s35, 8192
s_nop 0
buffer_load_dwordx4 v6, s[12:15], s42 offen lds
s_add_u32 m0, s35, 9216
s_add_u32 s42, s42, 7168
buffer_load_dwordx4 v6, s[12:15], s42 offen lds
s_add_u32 m0, s35, 10240
s_add_u32 s42, s42, 7168
buffer_load_dwordx4 v6, s[12:15], s42 offen lds
s_add_u32 m0, s35, 11264
s_add_u32 s42, s42, 7168
buffer_load_dwordx4 v6, s[12:15], s42 offen lds
s_add_u32 s41, s40, 8
s_cmp_ge_u32 s41, 14
s_cselect_b32 s42, 14, 0
s_sub_u32 s41, s41, s42
s_lshl_b32 s42, s41, 10
s_add_u32 s42, s42, s33
buffer_load_dwordx4 v[128:131], v7, s[52:55], s42 offen sc1
s_add_u32 s42, s42, 57344
buffer_load_dwordx4 v[132:135], v7, s[52:55], s42 offen sc1
s_add_u32 s42, s42, 57344
buffer_load_dwordx4 v[136:139], v7, s[52:55], s42 offen sc1
s_add_u32 s42, s42, 57344
buffer_load_dwordx4 v[140:143], v7, s[52:55], s42 offen sc1
s_waitcnt vmcnt(34)
s_mov_b32 s28, 0
GV_3:
v_max3_u32 v14, v144, v145, v146
v_max3_u32 v15, v147, v148, v149
v_max3_u32 v14, v14, v150, v151
v_max3_u32 v15, v15, v152, v153
v_max3_u32 v14, v14, v154, v155
v_max3_u32 v15, v15, v156, v157
v_max3_u32 v14, v14, v158, v159
v_max_u32 v14, v14, v15
v_cmp_eq_u32 vcc, -1, v14
s_nop 1
s_cbranch_vccz GD_3
s_add_u32 s28, s28, 1
s_cmp_gt_u32 s28, 20000
s_cbranch_scc1 GD_3
s_add_u32 s41, s40, 3
s_cmp_ge_u32 s41, 14
s_cselect_b32 s42, 14, 0
s_sub_u32 s41, s41, s42
s_lshl_b32 s42, s41, 10
s_add_u32 s42, s42, s33
buffer_load_dwordx4 v[144:147], v7, s[52:55], s42 offen sc1
s_add_u32 s42, s42, 57344
buffer_load_dwordx4 v[148:151], v7, s[52:55], s42 offen sc1
s_add_u32 s42, s42, 57344
buffer_load_dwordx4 v[152:155], v7, s[52:55], s42 offen sc1
s_add_u32 s42, s42, 57344
buffer_load_dwordx4 v[156:159], v7, s[52:55], s42 offen sc1
s_waitcnt vmcnt(0)
s_branch GV_3
GD_3:
ds_read_b64_tr_b16 v[80:81], v10 offset:12288
ds_read_b64_tr_b16 v[82:83], v10 offset:13312
ds_read_b64_tr_b16 v[84:85], v11 offset:12288
ds_read_b64_tr_b16 v[86:87], v11 offset:13312
ds_read_b64_tr_b16 v[88:89], v12 offset:12288
ds_read_b64_tr_b16 v[90:91], v12 offset:13312
ds_read_b64_tr_b16 v[92:93], v13 offset:12288
ds_read_b64_tr_b16 v[94:95], v13 offset:13312
s_waitcnt lgkmcnt(6)
v_mfma_f32_16x16x32_bf16 v[16:19], v[80:83], v[144:147], v[16:19]
v_mfma_f32_16x16x32_bf16 v[20:23], v[80:83], v[148:151], v[20:23]
v_mfma_f32_16x16x32_bf16 v[24:27], v[80:83], v[152:155], v[24:27]
v_mfma_f32_16x16x32_bf16 v[28:31], v[80:83], v[156:159], v[28:31]
s_waitcnt lgkmcnt(4)
v_mfma_f32_16x16x32_bf16 v[32:35], v[84:87], v[144:147], v[32:35]
v_mfma_f32_16x16x32_bf16 v[36:39], v[84:87], v[148:151], v[36:39]
v_mfma_f32_16x16x32_bf16 v[40:43], v[84:87], v[152:155], v[40:43]
v_mfma_f32_16x16x32_bf16 v[44:47], v[84:87], v[156:159], v[44:47]
s_waitcnt lgkmcnt(2)
v_mfma_f32_16x16x32_bf16 v[48:51], v[88:91], v[144:147], v[48:51]
v_mfma_f32_16x16x32_bf16 v[52:55], v[88:91], v[148:151], v[52:55]
v_mfma_f32_16x16x32_bf16 v[56:59], v[88:91], v[152:155], v[56:59]
v_mfma_f32_16x16x32_bf16 v[60:63], v[88:91], v[156:159], v[60:63]
s_waitcnt lgkmcnt(0)
v_mfma_f32_16x16x32_bf16 v[64:67], v[92:95], v[144:147], v[64:67]
v_mfma_f32_16x16x32_bf16 v[68:71], v[92:95], v[148:151], v[68:71]
v_mfma_f32_16x16x32_bf16 v[72:75], v[92:95], v[152:155], v[72:75]
v_mfma_f32_16x16x32_bf16 v[76:79], v[92:95], v[156:159], v[76:79]
s_add_u32 s41, s40, 9
s_cmp_ge_u32 s41, 14
s_cselect_b32 s42, 14, 0
s_sub_u32 s41, s41, s42
s_mul_i32 s42, s41, 28672
s_add_u32 s42, s42, s32
s_add_u32 m0, s35, 12288
s_nop 0
buffer_load_dwordx4 v6, s[12:15], s42 offen lds
s_add_u32 m0, s35, 13312
s_add_u32 s42, s42, 7168
buffer_load_dwordx4 v6, s[12:15], s42 offen lds
s_add_u32 m0, s35, 14336
s_add_u32 s42, s42, 7168
buffer_load_dwordx4 v6, s[12:15], s42 offen lds
s_add_u32 m0, s35, 15360
s_add_u32 s42, s42, 7168
buffer_load_dwordx4 v6, s[12:15], s42 offen lds
s_add_u32 s41, s40, 9
s_cmp_ge_u32 s41, 14
s_cselect_b32 s42, 14, 0
s_sub_u32 s41, s41, s42
s_lshl_b32 s42, s41, 10
s_add_u32 s42, s42, s33
buffer_load_dwordx4 v[144:147], v7, s[52:55], s42 offen sc1
s_add_u32 s42, s42, 57344
buffer_load_dwordx4 v[148:151], v7, s[52:55], s42 offen sc1
s_add_u32 s42, s42, 57344
buffer_load_dwordx4 v[152:155], v7, s[52:55], s42 offen sc1
s_add_u32 s42, s42, 57344
buffer_load_dwordx4 v[156:159], v7, s[52:55], s42 offen sc1
s_waitcnt vmcnt(38)
s_mov_b32 s28, 0
GV_4:
v_max3_u32 v14, v160, v161, v162
v_max3_u32 v15, v163, v164, v165
v_max3_u32 v14, v14, v166, v167
v_max3_u32 v15, v15, v168, v169
v_max3_u32 v14, v14, v170, v171
v_max3_u32 v15, v15, v172, v173
v_max3_u32 v14, v14, v174, v175
v_max_u32 v14, v14, v15
v_cmp_eq_u32 vcc, -1, v14
s_nop 1
s_cbranch_vccz GD_4
s_add_u32 s28, s28, 1
s_cmp_gt_u32 s28, 20000
s_cbranch_scc1 GD_4
s_add_u32 s41, s40, 4
s_cmp_ge_u32 s41, 14
s_cselect_b32 s42, 14, 0
s_sub_u32 s41, s41, s42
s_lshl_b32 s42, s41, 10
s_add_u32 s42, s42, s33
buffer_load_dwordx4 v[160:163], v7, s[52:55], s42 offen sc1
s_add_u32 s42, s42, 57344
buffer_load_dwordx4 v[164:167], v7, s[52:55], s42 offen sc1
s_add_u32 s42, s42, 57344
buffer_load_dwordx4 v[168:171], v7, s[52:55], s42 offen sc1
s_add_u32 s42, s42, 57344
buffer_load_dwordx4 v[172:175], v7, s[52:55], s42 offen sc1
s_waitcnt vmcnt(0)
s_branch GV_4
GD_4:
ds_read_b64_tr_b16 v[80:81], v10 offset:16384
ds_read_b64_tr_b16 v[82:83], v10 offset:17408
ds_read_b64_tr_b16 v[84:85], v11 offset:16384
ds_read_b64_tr_b16 v[86:87], v11 offset:17408
ds_read_b64_tr_b16 v[88:89], v12 offset:16384
ds_read_b64_tr_b16 v[90:91], v12 offset:17408
ds_read_b64_tr_b16 v[92:93], v13 offset:16384
ds_read_b64_tr_b16 v[94:95], v13 offset:17408
s_waitcnt lgkmcnt(6)
v_mfma_f32_16x16x32_bf16 v[16:19], v[80:83], v[160:163], v[16:19]
v_mfma_f32_16x16x32_bf16 v[20:23], v[80:83], v[164:167], v[20:23]
v_mfma_f32_16x16x32_bf16 v[24:27], v[80:83], v[168:171], v[24:27]
v_mfma_f32_16x16x32_bf16 v[28:31], v[80:83], v[172:175], v[28:31]
s_waitcnt lgkmcnt(4)
v_mfma_f32_16x16x32_bf16 v[32:35], v[84:87], v[160:163], v[32:35]
v_mfma_f32_16x16x32_bf16 v[36:39], v[84:87], v[164:167], v[36:39]
v_mfma_f32_16x16x32_bf16 v[40:43], v[84:87], v[168:171], v[40:43]
v_mfma_f32_16x16x32_bf16 v[44:47], v[84:87], v[172:175], v[44:47]
s_waitcnt lgkmcnt(2)
v_mfma_f32_16x16x32_bf16 v[48:51], v[88:91], v[160:163], v[48:51]
v_mfma_f32_16x16x32_bf16 v[52:55], v[88:91], v[164:167], v[52:55]
v_mfma_f32_16x16x32_bf16 v[56:59], v[88:91], v[168:171], v[56:59]
v_mfma_f32_16x16x32_bf16 v[60:63], v[88:91], v[172:175], v[60:63]
s_waitcnt lgkmcnt(0)
v_mfma_f32_16x16x32_bf16 v[64:67], v[92:95], v[160:163], v[64:67]
v_mfma_f32_16x16x32_bf16 v[68:71], v[92:95], v[164:167], v[68:71]
v_mfma_f32_16x16x32_bf16 v[72:75], v[92:95], v[168:171], v[72:75]
v_mfma_f32_16x16x32_bf16 v[76:79], v[92:95], v[172:175], v[76:79]
s_add_u32 s41, s40, 10
s_cmp_ge_u32 s41, 14
s_cselect_b32 s42, 14, 0
s_sub_u32 s41, s41, s42
s_mul_i32 s42, s41, 28672
s_add_u32 s42, s42, s32
s_add_u32 m0, s35, 16384
s_nop 0
buffer_load_dwordx4 v6, s[12:15], s42 offen lds
s_add_u32 m0, s35, 17408
s_add_u32 s42, s42, 7168
buffer_load_dwordx4 v6, s[12:15], s42 offen lds
s_add_u32 m0, s35, 18432
s_add_u32 s42, s42, 7168
buffer_load_dwordx4 v6, s[12:15], s42 offen lds
s_add_u32 m0, s35, 19456
s_add_u32 s42, s42, 7168
buffer_load_dwordx4 v6, s[12:15], s42 offen lds
s_add_u32 s41, s40, 10
s_cmp_ge_u32 s41, 14
s_cselect_b32 s42, 14, 0
s_sub_u32 s41, s41, s42
s_lshl_b32 s42, s41, 10
s_add_u32 s42, s42, s33
buffer_load_dwordx4 v[160:163], v7, s[52:55], s42 offen sc1
s_add_u32 s42, s42, 57344
buffer_load_dwordx4 v[164:167], v7, s[52:55], s42 offen sc1
s_add_u32 s42, s42, 57344
buffer_load_dwordx4 v[168:171], v7, s[52:55], s42 offen sc1
s_add_u32 s42, s42, 57344
buffer_load_dwordx4 v[172:175], v7, s[52:55], s42 offen sc1
s_waitcnt vmcnt(42)
s_mov_b32 s28, 0
GV_5:
v_max3_u32 v14, v176, v177, v178
v_max3_u32 v15, v179, v180, v181
v_max3_u32 v14, v14, v182, v183
v_max3_u32 v15, v15, v184, v185
v_max3_u32 v14, v14, v186, v187
v_max3_u32 v15, v15, v188, v189
v_max3_u32 v14, v14, v190, v191
v_max_u32 v14, v14, v15
v_cmp_eq_u32 vcc, -1, v14
s_nop 1
s_cbranch_vccz GD_5
s_add_u32 s28, s28, 1
s_cmp_gt_u32 s28, 20000
s_cbranch_scc1 GD_5
s_add_u32 s41, s40, 5
s_cmp_ge_u32 s41, 14
s_cselect_b32 s42, 14, 0
s_sub_u32 s41, s41, s42
s_lshl_b32 s42, s41, 10
s_add_u32 s42, s42, s33
buffer_load_dwordx4 v[176:179], v7, s[52:55], s42 offen sc1
s_add_u32 s42, s42, 57344
buffer_load_dwordx4 v[180:183], v7, s[52:55], s42 offen sc1
s_add_u32 s42, s42, 57344
buffer_load_dwordx4 v[184:187], v7, s[52:55], s42 offen sc1
s_add_u32 s42, s42, 57344
buffer_load_dwordx4 v[188:191], v7, s[52:55], s42 offen sc1
s_waitcnt vmcnt(0)
s_branch GV_5
GD_5:
ds_read_b64_tr_b16 v[80:81], v10 offset:20480
ds_read_b64_tr_b16 v[82:83], v10 offset:21504
ds_read_b64_tr_b16 v[84:85], v11 offset:20480
ds_read_b64_tr_b16 v[86:87], v11 offset:21504
ds_read_b64_tr_b16 v[88:89], v12 offset:20480
ds_read_b64_tr_b16 v[90:91], v12 offset:21504
ds_read_b64_tr_b16 v[92:93], v13 offset:20480
ds_read_b64_tr_b16 v[94:95], v13 offset:21504
s_waitcnt lgkmcnt(6)
v_mfma_f32_16x16x32_bf16 v[16:19], v[80:83], v[176:179], v[16:19]
v_mfma_f32_16x16x32_bf16 v[20:23], v[80:83], v[180:183], v[20:23]
v_mfma_f32_16x16x32_bf16 v[24:27], v[80:83], v[184:187], v[24:27]
v_mfma_f32_16x16x32_bf16 v[28:31], v[80:83], v[188:191], v[28:31]
s_waitcnt lgkmcnt(4)
v_mfma_f32_16x16x32_bf16 v[32:35], v[84:87], v[176:179], v[32:35]
v_mfma_f32_16x16x32_bf16 v[36:39], v[84:87], v[180:183], v[36:39]
v_mfma_f32_16x16x32_bf16 v[40:43], v[84:87], v[184:187], v[40:43]
v_mfma_f32_16x16x32_bf16 v[44:47], v[84:87], v[188:191], v[44:47]
s_waitcnt lgkmcnt(2)
v_mfma_f32_16x16x32_bf16 v[48:51], v[88:91], v[176:179], v[48:51]
v_mfma_f32_16x16x32_bf16 v[52:55], v[88:91], v[180:183], v[52:55]
v_mfma_f32_16x16x32_bf16 v[56:59], v[88:91], v[184:187], v[56:59]
v_mfma_f32_16x16x32_bf16 v[60:63], v[88:91], v[188:191], v[60:63]
s_waitcnt lgkmcnt(0)
v_mfma_f32_16x16x32_bf16 v[64:67], v[92:95], v[176:179], v[64:67]
v_mfma_f32_16x16x32_bf16 v[68:71], v[92:95], v[180:183], v[68:71]
v_mfma_f32_16x16x32_bf16 v[72:75], v[92:95], v[184:187], v[72:75]
v_mfma_f32_16x16x32_bf16 v[76:79], v[92:95], v[188:191], v[76:79]
s_add_u32 s41, s40, 11
s_cmp_ge_u32 s41, 14
s_cselect_b32 s42, 14, 0
s_sub_u32 s41, s41, s42
s_mul_i32 s42, s41, 28672
s_add_u32 s42, s42, s32
s_add_u32 m0, s35, 20480
s_nop 0
buffer_load_dwordx4 v6, s[12:15], s42 offen lds
s_add_u32 m0, s35, 21504
s_add_u32 s42, s42, 7168
buffer_load_dwordx4 v6, s[12:15], s42 offen lds
s_add_u32 m0, s35, 22528
s_add_u32 s42, s42, 7168
buffer_load_dwordx4 v6, s[12:15], s42 offen lds
s_add_u32 m0, s35, 23552
s_add_u32 s42, s42, 7168
buffer_load_dwordx4 v6, s[12:15], s42 offen lds
s_add_u32 s41, s40, 11
s_cmp_ge_u32 s41, 14
s_cselect_b32 s42, 14, 0
s_sub_u32 s41, s41, s42
s_lshl_b32 s42, s41, 10
s_add_u32 s42, s42, s33
buffer_load_dwordx4 v[176:179], v7, s[52:55], s42 offen sc1
s_add_u32 s42, s42, 57344
buffer_load_dwordx4 v[180:183], v7, s[52:55], s42 offen sc1
s_add_u32 s42, s42, 57344
buffer_load_dwordx4 v[184:187], v7, s[52:55], s42 offen sc1
s_add_u32 s42, s42, 57344
buffer_load_dwordx4 v[188:191], v7, s[52:55], s42 offen sc1
s_waitcnt vmcnt(40)
s_mov_b32 s28, 0
GV_6:
v_max3_u32 v14, v96, v97, v98
v_max3_u32 v15, v99, v100, v101
v_max3_u32 v14, v14, v102, v103
v_max3_u32 v15, v15, v104, v105
v_max3_u32 v14, v14, v106, v107
v_max3_u32 v15, v15, v108, v109
v_max3_u32 v14, v14, v110, v111
v_max_u32 v14, v14, v15
v_cmp_eq_u32 vcc, -1, v14
s_nop 1
s_cbranch_vccz GD_6
s_add_u32 s28, s28, 1
s_cmp_gt_u32 s28, 20000
s_cbranch_scc1 GD_6
s_add_u32 s41, s40, 6
s_cmp_ge_u32 s41, 14
s_cselect_b32 s42, 14, 0
s_sub_u32 s41, s41, s42
s_lshl_b32 s42, s41, 10
s_add_u32 s42, s42, s33
buffer_load_dwordx4 v[96:99], v7, s[52:55], s42 offen sc1
s_add_u32 s42, s42, 57344
buffer_load_dwordx4 v[100:103], v7, s[52:55], s42 offen sc1
s_add_u32 s42, s42, 57344
buffer_load_dwordx4 v[104:107], v7, s[52:55], s42 offen sc1
s_add_u32 s42, s42, 57344
buffer_load_dwordx4 v[108:111], v7, s[52:55], s42 offen sc1
s_waitcnt vmcnt(0)
s_branch GV_6
GD_6:
ds_read_b64_tr_b16 v[80:81], v10 offset:0
ds_read_b64_tr_b16 v[82:83], v10 offset:1024
ds_read_b64_tr_b16 v[84:85], v11 offset:0
ds_read_b64_tr_b16 v[86:87], v11 offset:1024
ds_read_b64_tr_b16 v[88:89], v12 offset:0
ds_read_b64_tr_b16 v[90:91], v12 offset:1024
ds_read_b64_tr_b16 v[92:93], v13 offset:0
ds_read_b64_tr_b16 v[94:95], v13 offset:1024
s_waitcnt lgkmcnt(6)
v_mfma_f32_16x16x32_bf16 v[16:19], v[80:83], v[96:99], v[16:19]
v_mfma_f32_16x16x32_bf16 v[20:23], v[80:83], v[100:103], v[20:23]
v_mfma_f32_16x16x32_bf16 v[24:27], v[80:83], v[104:107], v[24:27]
v_mfma_f32_16x16x32_bf16 v[28:31], v[80:83], v[108:111], v[28:31]
s_waitcnt lgkmcnt(4)
v_mfma_f32_16x16x32_bf16 v[32:35], v[84:87], v[96:99], v[32:35]
v_mfma_f32_16x16x32_bf16 v[36:39], v[84:87], v[100:103], v[36:39]
v_mfma_f32_16x16x32_bf16 v[40:43], v[84:87], v[104:107], v[40:43]
v_mfma_f32_16x16x32_bf16 v[44:47], v[84:87], v[108:111], v[44:47]
s_waitcnt lgkmcnt(2)
v_mfma_f32_16x16x32_bf16 v[48:51], v[88:91], v[96:99], v[48:51]
v_mfma_f32_16x16x32_bf16 v[52:55], v[88:91], v[100:103], v[52:55]
v_mfma_f32_16x16x32_bf16 v[56:59], v[88:91], v[104:107], v[56:59]
v_mfma_f32_16x16x32_bf16 v[60:63], v[88:91], v[108:111], v[60:63]
s_waitcnt lgkmcnt(0)
v_mfma_f32_16x16x32_bf16 v[64:67], v[92:95], v[96:99], v[64:67]
v_mfma_f32_16x16x32_bf16 v[68:71], v[92:95], v[100:103], v[68:71]
v_mfma_f32_16x16x32_bf16 v[72:75], v[92:95], v[104:107], v[72:75]
v_mfma_f32_16x16x32_bf16 v[76:79], v[92:95], v[108:111], v[76:79]
s_add_u32 s41, s40, 12
s_cmp_ge_u32 s41, 14
s_cselect_b32 s42, 14, 0
s_sub_u32 s41, s41, s42
s_mul_i32 s42, s41, 28672
s_add_u32 s42, s42, s32
s_add_u32 m0, s35, 0
s_nop 0
buffer_load_dwordx4 v6, s[12:15], s42 offen lds
s_add_u32 m0, s35, 1024
s_add_u32 s42, s42, 7168
buffer_load_dwordx4 v6, s[12:15], s42 offen lds
s_add_u32 m0, s35, 2048
s_add_u32 s42, s42, 7168
buffer_load_dwordx4 v6, s[12:15], s42 offen lds
s_add_u32 m0, s35, 3072
s_add_u32 s42, s42, 7168
buffer_load_dwordx4 v6, s[12:15], s42 offen lds
s_add_u32 s41, s40, 12
s_cmp_ge_u32 s41, 14
s_cselect_b32 s42, 14, 0
s_sub_u32 s41, s41, s42
s_lshl_b32 s42, s41, 10
s_add_u32 s42, s42, s33
buffer_load_dwordx4 v[96:99], v7, s[52:55], s42 offen sc1
s_add_u32 s42, s42, 57344
buffer_load_dwordx4 v[100:103], v7, s[52:55], s42 offen sc1
s_add_u32 s42, s42, 57344
buffer_load_dwordx4 v[104:107], v7, s[52:55], s42 offen sc1
s_add_u32 s42, s42, 57344
buffer_load_dwordx4 v[108:111], v7, s[52:55], s42 offen sc1
s_waitcnt vmcnt(40)
s_mov_b32 s28, 0
GV_7:
v_max3_u32 v14, v112, v113, v114
v_max3_u32 v15, v115, v116, v117
v_max3_u32 v14, v14, v118, v119
v_max3_u32 v15, v15, v120, v121
v_max3_u32 v14, v14, v122, v123
v_max3_u32 v15, v15, v124, v125
v_max3_u32 v14, v14, v126, v127
v_max_u32 v14, v14, v15
v_cmp_eq_u32 vcc, -1, v14
s_nop 1
s_cbranch_vccz GD_7
s_add_u32 s28, s28, 1
s_cmp_gt_u32 s28, 20000
s_cbranch_scc1 GD_7
s_add_u32 s41, s40, 7
s_cmp_ge_u32 s41, 14
s_cselect_b32 s42, 14, 0
s_sub_u32 s41, s41, s42
s_lshl_b32 s42, s41, 10
s_add_u32 s42, s42, s33
buffer_load_dwordx4 v[112:115], v7, s[52:55], s42 offen sc1
s_add_u32 s42, s42, 57344
buffer_load_dwordx4 v[116:119], v7, s[52:55], s42 offen sc1
s_add_u32 s42, s42, 57344
buffer_load_dwordx4 v[120:123], v7, s[52:55], s42 offen sc1
s_add_u32 s42, s42, 57344
buffer_load_dwordx4 v[124:127], v7, s[52:55], s42 offen sc1
s_waitcnt vmcnt(0)
s_branch GV_7
GD_7:
ds_read_b64_tr_b16 v[80:81], v10 offset:4096
ds_read_b64_tr_b16 v[82:83], v10 offset:5120
ds_read_b64_tr_b16 v[84:85], v11 offset:4096
ds_read_b64_tr_b16 v[86:87], v11 offset:5120
ds_read_b64_tr_b16 v[88:89], v12 offset:4096
ds_read_b64_tr_b16 v[90:91], v12 offset:5120
ds_read_b64_tr_b16 v[92:93], v13 offset:4096
ds_read_b64_tr_b16 v[94:95], v13 offset:5120
s_waitcnt lgkmcnt(6)
v_mfma_f32_16x16x32_bf16 v[16:19], v[80:83], v[112:115], v[16:19]
v_mfma_f32_16x16x32_bf16 v[20:23], v[80:83], v[116:119], v[20:23]
v_mfma_f32_16x16x32_bf16 v[24:27], v[80:83], v[120:123], v[24:27]
v_mfma_f32_16x16x32_bf16 v[28:31], v[80:83], v[124:127], v[28:31]
s_waitcnt lgkmcnt(4)
v_mfma_f32_16x16x32_bf16 v[32:35], v[84:87], v[112:115], v[32:35]
v_mfma_f32_16x16x32_bf16 v[36:39], v[84:87], v[116:119], v[36:39]
v_mfma_f32_16x16x32_bf16 v[40:43], v[84:87], v[120:123], v[40:43]
v_mfma_f32_16x16x32_bf16 v[44:47], v[84:87], v[124:127], v[44:47]
s_waitcnt lgkmcnt(2)
v_mfma_f32_16x16x32_bf16 v[48:51], v[88:91], v[112:115], v[48:51]
v_mfma_f32_16x16x32_bf16 v[52:55], v[88:91], v[116:119], v[52:55]
v_mfma_f32_16x16x32_bf16 v[56:59], v[88:91], v[120:123], v[56:59]
v_mfma_f32_16x16x32_bf16 v[60:63], v[88:91], v[124:127], v[60:63]
s_waitcnt lgkmcnt(0)
v_mfma_f32_16x16x32_bf16 v[64:67], v[92:95], v[112:115], v[64:67]
v_mfma_f32_16x16x32_bf16 v[68:71], v[92:95], v[116:119], v[68:71]
v_mfma_f32_16x16x32_bf16 v[72:75], v[92:95], v[120:123], v[72:75]
v_mfma_f32_16x16x32_bf16 v[76:79], v[92:95], v[124:127], v[76:79]
s_add_u32 s41, s40, 13
s_cmp_ge_u32 s41, 14
s_cselect_b32 s42, 14, 0
s_sub_u32 s41, s41, s42
s_mul_i32 s42, s41, 28672
s_add_u32 s42, s42, s32
s_add_u32 m0, s35, 4096
s_nop 0
buffer_load_dwordx4 v6, s[12:15], s42 offen lds
s_add_u32 m0, s35, 5120
s_add_u32 s42, s42, 7168
buffer_load_dwordx4 v6, s[12:15], s42 offen lds
s_add_u32 m0, s35, 6144
s_add_u32 s42, s42, 7168
buffer_load_dwordx4 v6, s[12:15], s42 offen lds
s_add_u32 m0, s35, 7168
s_add_u32 s42, s42, 7168
buffer_load_dwordx4 v6, s[12:15], s42 offen lds
s_add_u32 s41, s40, 13
s_cmp_ge_u32 s41, 14
s_cselect_b32 s42, 14, 0
s_sub_u32 s41, s41, s42
s_lshl_b32 s42, s41, 10
s_add_u32 s42, s42, s33
buffer_load_dwordx4 v[112:115], v7, s[52:55], s42 offen sc1
s_add_u32 s42, s42, 57344
buffer_load_dwordx4 v[116:119], v7, s[52:55], s42 offen sc1
s_add_u32 s42, s42, 57344
buffer_load_dwordx4 v[120:123], v7, s[52:55], s42 offen sc1
s_add_u32 s42, s42, 57344
buffer_load_dwordx4 v[124:127], v7, s[52:55], s42 offen sc1
s_waitcnt vmcnt(40)
s_mov_b32 s28, 0
GV_8:
v_max3_u32 v14, v128, v129, v130
v_max3_u32 v15, v131, v132, v133
v_max3_u32 v14, v14, v134, v135
v_max3_u32 v15, v15, v136, v137
v_max3_u32 v14, v14, v138, v139
v_max3_u32 v15, v15, v140, v141
v_max3_u32 v14, v14, v142, v143
v_max_u32 v14, v14, v15
v_cmp_eq_u32 vcc, -1, v14
s_nop 1
s_cbranch_vccz GD_8
s_add_u32 s28, s28, 1
s_cmp_gt_u32 s28, 20000
s_cbranch_scc1 GD_8
s_add_u32 s41, s40, 8
s_cmp_ge_u32 s41, 14
s_cselect_b32 s42, 14, 0
s_sub_u32 s41, s41, s42
s_lshl_b32 s42, s41, 10
s_add_u32 s42, s42, s33
buffer_load_dwordx4 v[128:131], v7, s[52:55], s42 offen sc1
s_add_u32 s42, s42, 57344
buffer_load_dwordx4 v[132:135], v7, s[52:55], s42 offen sc1
s_add_u32 s42, s42, 57344
buffer_load_dwordx4 v[136:139], v7, s[52:55], s42 offen sc1
s_add_u32 s42, s42, 57344
buffer_load_dwordx4 v[140:143], v7, s[52:55], s42 offen sc1
s_waitcnt vmcnt(0)
s_branch GV_8
GD_8:
ds_read_b64_tr_b16 v[80:81], v10 offset:8192
ds_read_b64_tr_b16 v[82:83], v10 offset:9216
ds_read_b64_tr_b16 v[84:85], v11 offset:8192
ds_read_b64_tr_b16 v[86:87], v11 offset:9216
ds_read_b64_tr_b16 v[88:89], v12 offset:8192
ds_read_b64_tr_b16 v[90:91], v12 offset:9216
ds_read_b64_tr_b16 v[92:93], v13 offset:8192
ds_read_b64_tr_b16 v[94:95], v13 offset:9216
s_waitcnt lgkmcnt(6)
v_mfma_f32_16x16x32_bf16 v[16:19], v[80:83], v[128:131], v[16:19]
v_mfma_f32_16x16x32_bf16 v[20:23], v[80:83], v[132:135], v[20:23]
v_mfma_f32_16x16x32_bf16 v[24:27], v[80:83], v[136:139], v[24:27]
v_mfma_f32_16x16x32_bf16 v[28:31], v[80:83], v[140:143], v[28:31]
s_waitcnt lgkmcnt(4)
v_mfma_f32_16x16x32_bf16 v[32:35], v[84:87], v[128:131], v[32:35]
v_mfma_f32_16x16x32_bf16 v[36:39], v[84:87], v[132:135], v[36:39]
v_mfma_f32_16x16x32_bf16 v[40:43], v[84:87], v[136:139], v[40:43]
v_mfma_f32_16x16x32_bf16 v[44:47], v[84:87], v[140:143], v[44:47]
s_waitcnt lgkmcnt(2)
v_mfma_f32_16x16x32_bf16 v[48:51], v[88:91], v[128:131], v[48:51]
v_mfma_f32_16x16x32_bf16 v[52:55], v[88:91], v[132:135], v[52:55]
v_mfma_f32_16x16x32_bf16 v[56:59], v[88:91], v[136:139], v[56:59]
v_mfma_f32_16x16x32_bf16 v[60:63], v[88:91], v[140:143], v[60:63]
s_waitcnt lgkmcnt(0)
v_mfma_f32_16x16x32_bf16 v[64:67], v[92:95], v[128:131], v[64:67]
v_mfma_f32_16x16x32_bf16 v[68:71], v[92:95], v[132:135], v[68:71]
v_mfma_f32_16x16x32_bf16 v[72:75], v[92:95], v[136:139], v[72:75]
v_mfma_f32_16x16x32_bf16 v[76:79], v[92:95], v[140:143], v[76:79]
s_waitcnt vmcnt(32)
s_mov_b32 s28, 0
GV_9:
v_max3_u32 v14, v144, v145, v146
v_max3_u32 v15, v147, v148, v149
v_max3_u32 v14, v14, v150, v151
v_max3_u32 v15, v15, v152, v153
v_max3_u32 v14, v14, v154, v155
v_max3_u32 v15, v15, v156, v157
v_max3_u32 v14, v14, v158, v159
v_max_u32 v14, v14, v15
v_cmp_eq_u32 vcc, -1, v14
s_nop 1
s_cbranch_vccz GD_9
s_add_u32 s28, s28, 1
s_cmp_gt_u32 s28, 20000
s_cbranch_scc1 GD_9
s_add_u32 s41, s40, 9
s_cmp_ge_u32 s41, 14
s_cselect_b32 s42, 14, 0
s_sub_u32 s41, s41, s42
s_lshl_b32 s42, s41, 10
s_add_u32 s42, s42, s33
buffer_load_dwordx4 v[144:147], v7, s[52:55], s42 offen sc1
s_add_u32 s42, s42, 57344
buffer_load_dwordx4 v[148:151], v7, s[52:55], s42 offen sc1
s_add_u32 s42, s42, 57344
buffer_load_dwordx4 v[152:155], v7, s[52:55], s42 offen sc1
s_add_u32 s42, s42, 57344
buffer_load_dwordx4 v[156:159], v7, s[52:55], s42 offen sc1
s_waitcnt vmcnt(0)
s_branch GV_9
GD_9:
ds_read_b64_tr_b16 v[80:81], v10 offset:12288
ds_read_b64_tr_b16 v[82:83], v10 offset:13312
ds_read_b64_tr_b16 v[84:85], v11 offset:12288
ds_read_b64_tr_b16 v[86:87], v11 offset:13312
ds_read_b64_tr_b16 v[88:89], v12 offset:12288
ds_read_b64_tr_b16 v[90:91], v12 offset:13312
ds_read_b64_tr_b16 v[92:93], v13 offset:12288
ds_read_b64_tr_b16 v[94:95], v13 offset:13312
s_waitcnt lgkmcnt(6)
v_mfma_f32_16x16x32_bf16 v[16:19], v[80:83], v[144:147], v[16:19]
v_mfma_f32_16x16x32_bf16 v[20:23], v[80:83], v[148:151], v[20:23]
v_mfma_f32_16x16x32_bf16 v[24:27], v[80:83], v[152:155], v[24:27]
v_mfma_f32_16x16x32_bf16 v[28:31], v[80:83], v[156:159], v[28:31]
s_waitcnt lgkmcnt(4)
v_mfma_f32_16x16x32_bf16 v[32:35], v[84:87], v[144:147], v[32:35]
v_mfma_f32_16x16x32_bf16 v[36:39], v[84:87], v[148:151], v[36:39]
v_mfma_f32_16x16x32_bf16 v[40:43], v[84:87], v[152:155], v[40:43]
v_mfma_f32_16x16x32_bf16 v[44:47], v[84:87], v[156:159], v[44:47]
s_waitcnt lgkmcnt(2)
v_mfma_f32_16x16x32_bf16 v[48:51], v[88:91], v[144:147], v[48:51]
v_mfma_f32_16x16x32_bf16 v[52:55], v[88:91], v[148:151], v[52:55]
v_mfma_f32_16x16x32_bf16 v[56:59], v[88:91], v[152:155], v[56:59]
v_mfma_f32_16x16x32_bf16 v[60:63], v[88:91], v[156:159], v[60:63]
s_waitcnt lgkmcnt(0)
v_mfma_f32_16x16x32_bf16 v[64:67], v[92:95], v[144:147], v[64:67]
v_mfma_f32_16x16x32_bf16 v[68:71], v[92:95], v[148:151], v[68:71]
v_mfma_f32_16x16x32_bf16 v[72:75], v[92:95], v[152:155], v[72:75]
v_mfma_f32_16x16x32_bf16 v[76:79], v[92:95], v[156:159], v[76:79]
s_waitcnt vmcnt(24)
s_mov_b32 s28, 0
GV_10:
v_max3_u32 v14, v160, v161, v162
v_max3_u32 v15, v163, v164, v165
v_max3_u32 v14, v14, v166, v167
v_max3_u32 v15, v15, v168, v169
v_max3_u32 v14, v14, v170, v171
v_max3_u32 v15, v15, v172, v173
v_max3_u32 v14, v14, v174, v175
v_max_u32 v14, v14, v15
v_cmp_eq_u32 vcc, -1, v14
s_nop 1
s_cbranch_vccz GD_10
s_add_u32 s28, s28, 1
s_cmp_gt_u32 s28, 20000
s_cbranch_scc1 GD_10
s_add_u32 s41, s40, 10
s_cmp_ge_u32 s41, 14
s_cselect_b32 s42, 14, 0
s_sub_u32 s41, s41, s42
s_lshl_b32 s42, s41, 10
s_add_u32 s42, s42, s33
buffer_load_dwordx4 v[160:163], v7, s[52:55], s42 offen sc1
s_add_u32 s42, s42, 57344
buffer_load_dwordx4 v[164:167], v7, s[52:55], s42 offen sc1
s_add_u32 s42, s42, 57344
buffer_load_dwordx4 v[168:171], v7, s[52:55], s42 offen sc1
s_add_u32 s42, s42, 57344
buffer_load_dwordx4 v[172:175], v7, s[52:55], s42 offen sc1
s_waitcnt vmcnt(0)
s_branch GV_10
GD_10:
ds_read_b64_tr_b16 v[80:81], v10 offset:16384
ds_read_b64_tr_b16 v[82:83], v10 offset:17408
ds_read_b64_tr_b16 v[84:85], v11 offset:16384
ds_read_b64_tr_b16 v[86:87], v11 offset:17408
ds_read_b64_tr_b16 v[88:89], v12 offset:16384
ds_read_b64_tr_b16 v[90:91], v12 offset:17408
ds_read_b64_tr_b16 v[92:93], v13 offset:16384
ds_read_b64_tr_b16 v[94:95], v13 offset:17408
s_waitcnt lgkmcnt(6)
v_mfma_f32_16x16x32_bf16 v[16:19], v[80:83], v[160:163], v[16:19]
v_mfma_f32_16x16x32_bf16 v[20:23], v[80:83], v[164:167], v[20:23]
v_mfma_f32_16x16x32_bf16 v[24:27], v[80:83], v[168:171], v[24:27]
v_mfma_f32_16x16x32_bf16 v[28:31], v[80:83], v[172:175], v[28:31]
s_waitcnt lgkmcnt(4)
v_mfma_f32_16x16x32_bf16 v[32:35], v[84:87], v[160:163], v[32:35]
v_mfma_f32_16x16x32_bf16 v[36:39], v[84:87], v[164:167], v[36:39]
v_mfma_f32_16x16x32_bf16 v[40:43], v[84:87], v[168:171], v[40:43]
v_mfma_f32_16x16x32_bf16 v[44:47], v[84:87], v[172:175], v[44:47]
s_waitcnt lgkmcnt(2)
v_mfma_f32_16x16x32_bf16 v[48:51], v[88:91], v[160:163], v[48:51]
v_mfma_f32_16x16x32_bf16 v[52:55], v[88:91], v[164:167], v[52:55]
v_mfma_f32_16x16x32_bf16 v[56:59], v[88:91], v[168:171], v[56:59]
v_mfma_f32_16x16x32_bf16 v[60:63], v[88:91], v[172:175], v[60:63]
s_waitcnt lgkmcnt(0)
v_mfma_f32_16x16x32_bf16 v[64:67], v[92:95], v[160:163], v[64:67]
v_mfma_f32_16x16x32_bf16 v[68:71], v[92:95], v[164:167], v[68:71]
v_mfma_f32_16x16x32_bf16 v[72:75], v[92:95], v[168:171], v[72:75]
v_mfma_f32_16x16x32_bf16 v[76:79], v[92:95], v[172:175], v[76:79]
s_waitcnt vmcnt(16)
s_mov_b32 s28, 0
GV_11:
v_max3_u32 v14, v176, v177, v178
v_max3_u32 v15, v179, v180, v181
v_max3_u32 v14, v14, v182, v183
v_max3_u32 v15, v15, v184, v185
v_max3_u32 v14, v14, v186, v187
v_max3_u32 v15, v15, v188, v189
v_max3_u32 v14, v14, v190, v191
v_max_u32 v14, v14, v15
v_cmp_eq_u32 vcc, -1, v14
s_nop 1
s_cbranch_vccz GD_11
s_add_u32 s28, s28, 1
s_cmp_gt_u32 s28, 20000
s_cbranch_scc1 GD_11
s_add_u32 s41, s40, 11
s_cmp_ge_u32 s41, 14
s_cselect_b32 s42, 14, 0
s_sub_u32 s41, s41, s42
s_lshl_b32 s42, s41, 10
s_add_u32 s42, s42, s33
buffer_load_dwordx4 v[176:179], v7, s[52:55], s42 offen sc1
s_add_u32 s42, s42, 57344
buffer_load_dwordx4 v[180:183], v7, s[52:55], s42 offen sc1
s_add_u32 s42, s42, 57344
buffer_load_dwordx4 v[184:187], v7, s[52:55], s42 offen sc1
s_add_u32 s42, s42, 57344
buffer_load_dwordx4 v[188:191], v7, s[52:55], s42 offen sc1
s_waitcnt vmcnt(0)
s_branch GV_11
GD_11:
ds_read_b64_tr_b16 v[80:81], v10 offset:20480
ds_read_b64_tr_b16 v[82:83], v10 offset:21504
ds_read_b64_tr_b16 v[84:85], v11 offset:20480
ds_read_b64_tr_b16 v[86:87], v11 offset:21504
ds_read_b64_tr_b16 v[88:89], v12 offset:20480
ds_read_b64_tr_b16 v[90:91], v12 offset:21504
ds_read_b64_tr_b16 v[92:93], v13 offset:20480
ds_read_b64_tr_b16 v[94:95], v13 offset:21504
s_waitcnt lgkmcnt(6)
v_mfma_f32_16x16x32_bf16 v[16:19], v[80:83], v[176:179], v[16:19]
v_mfma_f32_16x16x32_bf16 v[20:23], v[80:83], v[180:183], v[20:23]
v_mfma_f32_16x16x32_bf16 v[24:27], v[80:83], v[184:187], v[24:27]
v_mfma_f32_16x16x32_bf16 v[28:31], v[80:83], v[188:191], v[28:31]
s_waitcnt lgkmcnt(4)
v_mfma_f32_16x16x32_bf16 v[32:35], v[84:87], v[176:179], v[32:35]
v_mfma_f32_16x16x32_bf16 v[36:39], v[84:87], v[180:183], v[36:39]
v_mfma_f32_16x16x32_bf16 v[40:43], v[84:87], v[184:187], v[40:43]
v_mfma_f32_16x16x32_bf16 v[44:47], v[84:87], v[188:191], v[44:47]
s_waitcnt lgkmcnt(2)
v_mfma_f32_16x16x32_bf16 v[48:51], v[88:91], v[176:179], v[48:51]
v_mfma_f32_16x16x32_bf16 v[52:55], v[88:91], v[180:183], v[52:55]
v_mfma_f32_16x16x32_bf16 v[56:59], v[88:91], v[184:187], v[56:59]
v_mfma_f32_16x16x32_bf16 v[60:63], v[88:91], v[188:191], v[60:63]
s_waitcnt lgkmcnt(0)
v_mfma_f32_16x16x32_bf16 v[64:67], v[92:95], v[176:179], v[64:67]
v_mfma_f32_16x16x32_bf16 v[68:71], v[92:95], v[180:183], v[68:71]
v_mfma_f32_16x16x32_bf16 v[72:75], v[92:95], v[184:187], v[72:75]
v_mfma_f32_16x16x32_bf16 v[76:79], v[92:95], v[188:191], v[76:79]
s_waitcnt vmcnt(8)
s_mov_b32 s28, 0
GV_12:
v_max3_u32 v14, v96, v97, v98
v_max3_u32 v15, v99, v100, v101
v_max3_u32 v14, v14, v102, v103
v_max3_u32 v15, v15, v104, v105
v_max3_u32 v14, v14, v106, v107
v_max3_u32 v15, v15, v108, v109
v_max3_u32 v14, v14, v110, v111
v_max_u32 v14, v14, v15
v_cmp_eq_u32 vcc, -1, v14
s_nop 1
s_cbranch_vccz GD_12
s_add_u32 s28, s28, 1
s_cmp_gt_u32 s28, 20000
s_cbranch_scc1 GD_12
s_add_u32 s41, s40, 12
s_cmp_ge_u32 s41, 14
s_cselect_b32 s42, 14, 0
s_sub_u32 s41, s41, s42
s_lshl_b32 s42, s41, 10
s_add_u32 s42, s42, s33
buffer_load_dwordx4 v[96:99], v7, s[52:55], s42 offen sc1
s_add_u32 s42, s42, 57344
buffer_load_dwordx4 v[100:103], v7, s[52:55], s42 offen sc1
s_add_u32 s42, s42, 57344
buffer_load_dwordx4 v[104:107], v7, s[52:55], s42 offen sc1
s_add_u32 s42, s42, 57344
buffer_load_dwordx4 v[108:111], v7, s[52:55], s42 offen sc1
s_waitcnt vmcnt(0)
s_branch GV_12
GD_12:
ds_read_b64_tr_b16 v[80:81], v10 offset:0
ds_read_b64_tr_b16 v[82:83], v10 offset:1024
ds_read_b64_tr_b16 v[84:85], v11 offset:0
ds_read_b64_tr_b16 v[86:87], v11 offset:1024
ds_read_b64_tr_b16 v[88:89], v12 offset:0
ds_read_b64_tr_b16 v[90:91], v12 offset:1024
ds_read_b64_tr_b16 v[92:93], v13 offset:0
ds_read_b64_tr_b16 v[94:95], v13 offset:1024
s_waitcnt lgkmcnt(6)
v_mfma_f32_16x16x32_bf16 v[16:19], v[80:83], v[96:99], v[16:19]
v_mfma_f32_16x16x32_bf16 v[20:23], v[80:83], v[100:103], v[20:23]
v_mfma_f32_16x16x32_bf16 v[24:27], v[80:83], v[104:107], v[24:27]
v_mfma_f32_16x16x32_bf16 v[28:31], v[80:83], v[108:111], v[28:31]
s_waitcnt lgkmcnt(4)
v_mfma_f32_16x16x32_bf16 v[32:35], v[84:87], v[96:99], v[32:35]
v_mfma_f32_16x16x32_bf16 v[36:39], v[84:87], v[100:103], v[36:39]
v_mfma_f32_16x16x32_bf16 v[40:43], v[84:87], v[104:107], v[40:43]
v_mfma_f32_16x16x32_bf16 v[44:47], v[84:87], v[108:111], v[44:47]
s_waitcnt lgkmcnt(2)
v_mfma_f32_16x16x32_bf16 v[48:51], v[88:91], v[96:99], v[48:51]
v_mfma_f32_16x16x32_bf16 v[52:55], v[88:91], v[100:103], v[52:55]
v_mfma_f32_16x16x32_bf16 v[56:59], v[88:91], v[104:107], v[56:59]
v_mfma_f32_16x16x32_bf16 v[60:63], v[88:91], v[108:111], v[60:63]
s_waitcnt lgkmcnt(0)
v_mfma_f32_16x16x32_bf16 v[64:67], v[92:95], v[96:99], v[64:67]
v_mfma_f32_16x16x32_bf16 v[68:71], v[92:95], v[100:103], v[68:71]
v_mfma_f32_16x16x32_bf16 v[72:75], v[92:95], v[104:107], v[72:75]
v_mfma_f32_16x16x32_bf16 v[76:79], v[92:95], v[108:111], v[76:79]
s_waitcnt vmcnt(0)
s_mov_b32 s28, 0
GV_13:
v_max3_u32 v14, v112, v113, v114
v_max3_u32 v15, v115, v116, v117
v_max3_u32 v14, v14, v118, v119
v_max3_u32 v15, v15, v120, v121
v_max3_u32 v14, v14, v122, v123
v_max3_u32 v15, v15, v124, v125
v_max3_u32 v14, v14, v126, v127
v_max_u32 v14, v14, v15
v_cmp_eq_u32 vcc, -1, v14
s_nop 1
s_cbranch_vccz GD_13
s_add_u32 s28, s28, 1
s_cmp_gt_u32 s28, 20000
s_cbranch_scc1 GD_13
s_add_u32 s41, s40, 13
s_cmp_ge_u32 s41, 14
s_cselect_b32 s42, 14, 0
s_sub_u32 s41, s41, s42
s_lshl_b32 s42, s41, 10
s_add_u32 s42, s42, s33
buffer_load_dwordx4 v[112:115], v7, s[52:55], s42 offen sc1
s_add_u32 s42, s42, 57344
buffer_load_dwordx4 v[116:119], v7, s[52:55], s42 offen sc1
s_add_u32 s42, s42, 57344
buffer_load_dwordx4 v[120:123], v7, s[52:55], s42 offen sc1
s_add_u32 s42, s42, 57344
buffer_load_dwordx4 v[124:127], v7, s[52:55], s42 offen sc1
s_waitcnt vmcnt(0)
s_branch GV_13
GD_13:
ds_read_b64_tr_b16 v[80:81], v10 offset:4096
ds_read_b64_tr_b16 v[82:83], v10 offset:5120
ds_read_b64_tr_b16 v[84:85], v11 offset:4096
ds_read_b64_tr_b16 v[86:87], v11 offset:5120
ds_read_b64_tr_b16 v[88:89], v12 offset:4096
ds_read_b64_tr_b16 v[90:91], v12 offset:5120
ds_read_b64_tr_b16 v[92:93], v13 offset:4096
ds_read_b64_tr_b16 v[94:95], v13 offset:5120
s_waitcnt lgkmcnt(6)
v_mfma_f32_16x16x32_bf16 v[16:19], v[80:83], v[112:115], v[16:19]
v_mfma_f32_16x16x32_bf16 v[20:23], v[80:83], v[116:119], v[20:23]
v_mfma_f32_16x16x32_bf16 v[24:27], v[80:83], v[120:123], v[24:27]
v_mfma_f32_16x16x32_bf16 v[28:31], v[80:83], v[124:127], v[28:31]
s_waitcnt lgkmcnt(4)
v_mfma_f32_16x16x32_bf16 v[32:35], v[84:87], v[112:115], v[32:35]
v_mfma_f32_16x16x32_bf16 v[36:39], v[84:87], v[116:119], v[36:39]
v_mfma_f32_16x16x32_bf16 v[40:43], v[84:87], v[120:123], v[40:43]
v_mfma_f32_16x16x32_bf16 v[44:47], v[84:87], v[124:127], v[44:47]
s_waitcnt lgkmcnt(2)
v_mfma_f32_16x16x32_bf16 v[48:51], v[88:91], v[112:115], v[48:51]
v_mfma_f32_16x16x32_bf16 v[52:55], v[88:91], v[116:119], v[52:55]
v_mfma_f32_16x16x32_bf16 v[56:59], v[88:91], v[120:123], v[56:59]
v_mfma_f32_16x16x32_bf16 v[60:63], v[88:91], v[124:127], v[60:63]
s_waitcnt lgkmcnt(0)
v_mfma_f32_16x16x32_bf16 v[64:67], v[92:95], v[112:115], v[64:67]
v_mfma_f32_16x16x32_bf16 v[68:71], v[92:95], v[116:119], v[68:71]
v_mfma_f32_16x16x32_bf16 v[72:75], v[92:95], v[120:123], v[72:75]
v_mfma_f32_16x16x32_bf16 v[76:79], v[92:95], v[124:127], v[76:79]
s_barrier
s_lshl_b32 s36, s31, 14
v_add_u32 v8, s36, v7
v_add_u32 v8, 0, v8
s_cmp_eq_u32 s31, 0
s_cbranch_scc1 P4_W0
ds_write_b128 v8, v[16:19] offset:0
ds_write_b128 v8, v[32:35] offset:1024
ds_write_b128 v8, v[48:51] offset:2048
ds_write_b128 v8, v[64:67] offset:3072
P4_W0:
s_cmp_eq_u32 s31, 1
s_cbranch_scc1 P4_W1
ds_write_b128 v8, v[20:23] offset:4096
ds_write_b128 v8, v[36:39] offset:5120
ds_write_b128 v8, v[52:55] offset:6144
ds_write_b128 v8, v[68:71] offset:7168
P4_W1:
s_cmp_eq_u32 s31, 2
s_cbranch_scc1 P4_W2
ds_write_b128 v8, v[24:27] offset:8192
ds_write_b128 v8, v[40:43] offset:9216
ds_write_b128 v8, v[56:59] offset:10240
ds_write_b128 v8, v[72:75] offset:11264
P4_W2:
s_cmp_eq_u32 s31, 3
s_cbranch_scc1 P4_W3
ds_write_b128 v8, v[28:31] offset:12288
ds_write_b128 v8, v[44:47] offset:13312
ds_write_b128 v8, v[60:63] offset:14336
ds_write_b128 v8, v[76:79] offset:15360
P4_W3:
s_cmp_lg_u32 s31, 0
s_cbranch_scc1 P4_M0
v_mov_b32 v96, v16
v_mov_b32 v97, v17
v_mov_b32 v98, v18
v_mov_b32 v99, v19
v_mov_b32 v100, v32
v_mov_b32 v101, v33
v_mov_b32 v102, v34
v_mov_b32 v103, v35
v_mov_b32 v104, v48
v_mov_b32 v105, v49
v_mov_b32 v106, v50
v_mov_b32 v107, v51
v_mov_b32 v108, v64
v_mov_b32 v109, v65
v_mov_b32 v110, v66
v_mov_b32 v111, v67
P4_M0:
s_cmp_lg_u32 s31, 1
s_cbranch_scc1 P4_M1
v_mov_b32 v96, v20
v_mov_b32 v97, v21
v_mov_b32 v98, v22
v_mov_b32 v99, v23
v_mov_b32 v100, v36
v_mov_b32 v101, v37
v_mov_b32 v102, v38
v_mov_b32 v103, v39
v_mov_b32 v104, v52
v_mov_b32 v105, v53
v_mov_b32 v106, v54
v_mov_b32 v107, v55
v_mov_b32 v108, v68
v_mov_b32 v109, v69
v_mov_b32 v110, v70
v_mov_b32 v111, v71
P4_M1:
s_cmp_lg_u32 s31, 2
s_cbranch_scc1 P4_M2
v_mov_b32 v96, v24
v_mov_b32 v97, v25
v_mov_b32 v98, v26
v_mov_b32 v99, v27
v_mov_b32 v100, v40
v_mov_b32 v101, v41
v_mov_b32 v102, v42
v_mov_b32 v103, v43
v_mov_b32 v104, v56
v_mov_b32 v105, v57
v_mov_b32 v106, v58
v_mov_b32 v107, v59
v_mov_b32 v108, v72
v_mov_b32 v109, v73
v_mov_b32 v110, v74
v_mov_b32 v111, v75
P4_M2:
s_cmp_lg_u32 s31, 3
s_cbranch_scc1 P4_M3
v_mov_b32 v96, v28
v_mov_b32 v97, v29
v_mov_b32 v98, v30
v_mov_b32 v99, v31
v_mov_b32 v100, v44
v_mov_b32 v101, v45
v_mov_b32 v102, v46
v_mov_b32 v103, v47
v_mov_b32 v104, v60
v_mov_b32 v105, v61
v_mov_b32 v106, v62
v_mov_b32 v107, v63
v_mov_b32 v108, v76
v_mov_b32 v109, v77
v_mov_b32 v110, v78
v_mov_b32 v111, v79
P4_M3:
s_lshl_b32 s37, s31, 12
v_add_u32 v8, s37, v7
v_add_u32 v8, 0, v8
v_lshl_add_u32 v5, v2, 2, v3
v_lshlrev_b32 v5, 7, v5
v_lshl_add_u32 v5, v4, 3, v5
s_lshl_b32 s36, s31, 5
s_add_u32 s36, s36, 126800
v_add_u32 v5, s36, v5
v_and_b32 v9, 15, v1
v_mul_u32_u24 v9, 896, v9
v_lshl_add_u32 v9, v2, 3, v9
s_lshl_b32 s38, s20, 6
s_lshl_b32 s37, s31, 4
s_add_u32 s38, s38, s37
s_mul_i32 s38, s38, 896
s_lshl_b32 s37, s21, 7
s_add_u32 s38, s38, s37
s_waitcnt lgkmcnt(0)
s_barrier
s_add_u32 s36, s31, 1
s_and_b32 s36, s36, 3
s_lshl_b32 s36, s36, 14
v_add_u32 v10, s36, v8
ds_read_b128 v[112:115], v10 offset:0
ds_read_b128 v[116:119], v10 offset:1024
ds_read_b128 v[120:123], v10 offset:2048
ds_read_b128 v[124:127], v10 offset:3072
s_add_u32 s36, s31, 2
s_and_b32 s36, s36, 3
s_lshl_b32 s36, s36, 14
v_add_u32 v10, s36, v8
ds_read_b128 v[128:131], v10 offset:0
ds_read_b128 v[132:135], v10 offset:1024
ds_read_b128 v[136:139], v10 offset:2048
ds_read_b128 v[140:143], v10 offset:3072
s_add_u32 s36, s31, 3
s_and_b32 s36, s36, 3
s_lshl_b32 s36, s36, 14
v_add_u32 v10, s36, v8
ds_read_b128 v[144:147], v10 offset:0
ds_read_b128 v[148:151], v10 offset:1024
ds_read_b128 v[152:155], v10 offset:2048
ds_read_b128 v[156:159], v10 offset:3072
ds_read_b64_tr_b16 v[160:161], v5 offset:0
ds_read_b64_tr_b16 v[162:163], v5 offset:2048
ds_read_b64_tr_b16 v[164:165], v5 offset:4096
ds_read_b64_tr_b16 v[166:167], v5 offset:6144
s_waitcnt lgkmcnt(0)
v_pk_add_f32 v[96:97], v[96:97], v[112:113]
v_pk_add_f32 v[98:99], v[98:99], v[114:115]
v_pk_add_f32 v[96:97], v[96:97], v[128:129]
v_pk_add_f32 v[98:99], v[98:99], v[130:131]
v_pk_add_f32 v[96:97], v[96:97], v[144:145]
v_pk_add_f32 v[98:99], v[98:99], v[146:147]
v_pk_add_f32 v[100:101], v[100:101], v[116:117]
v_pk_add_f32 v[102:103], v[102:103], v[118:119]
v_pk_add_f32 v[100:101], v[100:101], v[132:133]
v_pk_add_f32 v[102:103], v[102:103], v[134:135]
v_pk_add_f32 v[100:101], v[100:101], v[148:149]
v_pk_add_f32 v[102:103], v[102:103], v[150:151]
v_pk_add_f32 v[104:105], v[104:105], v[120:121]
v_pk_add_f32 v[106:107], v[106:107], v[122:123]
v_pk_add_f32 v[104:105], v[104:105], v[136:137]
v_pk_add_f32 v[106:107], v[106:107], v[138:139]
v_pk_add_f32 v[104:105], v[104:105], v[152:153]
v_pk_add_f32 v[106:107], v[106:107], v[154:155]
v_pk_add_f32 v[108:109], v[108:109], v[124:125]
v_pk_add_f32 v[110:111], v[110:111], v[126:127]
v_pk_add_f32 v[108:109], v[108:109], v[140:141]
v_pk_add_f32 v[110:111], v[110:111], v[142:143]
v_pk_add_f32 v[108:109], v[108:109], v[156:157]
v_pk_add_f32 v[110:111], v[110:111], v[158:159]
v_cvt_pk_bf16_f32 v96, v96, v97
v_cvt_pk_bf16_f32 v98, v98, v99
v_and_b32 v97, 0xffff0000, v96
v_lshlrev_b32 v96, 16, v96
v_and_b32 v99, 0xffff0000, v98
v_lshlrev_b32 v98, 16, v98
v_lshlrev_b32 v170, 16, v160
v_and_b32 v171, 0xffff0000, v160
v_lshlrev_b32 v172, 16, v161
v_and_b32 v173, 0xffff0000, v161
v_pk_add_f32 v[96:97], v[96:97], v[170:171]
v_pk_add_f32 v[98:99], v[98:99], v[172:173]
v_cvt_pk_bf16_f32 v96, v96, v97
v_cvt_pk_bf16_f32 v97, v98, v99
buffer_store_dwordx2 v[96:97], v9, s[16:19], s38 offen offset:0
v_cvt_pk_bf16_f32 v100, v100, v101
v_cvt_pk_bf16_f32 v102, v102, v103
v_and_b32 v101, 0xffff0000, v100
v_lshlrev_b32 v100, 16, v100
v_and_b32 v103, 0xffff0000, v102
v_lshlrev_b32 v102, 16, v102
v_lshlrev_b32 v174, 16, v162
v_and_b32 v175, 0xffff0000, v162
v_lshlrev_b32 v176, 16, v163
v_and_b32 v177, 0xffff0000, v163
v_pk_add_f32 v[100:101], v[100:101], v[174:175]
v_pk_add_f32 v[102:103], v[102:103], v[176:177]
v_cvt_pk_bf16_f32 v100, v100, v101
v_cvt_pk_bf16_f32 v101, v102, v103
buffer_store_dwordx2 v[100:101], v9, s[16:19], s38 offen offset:32
v_cvt_pk_bf16_f32 v104, v104, v105
v_cvt_pk_bf16_f32 v106, v106, v107
v_and_b32 v105, 0xffff0000, v104
v_lshlrev_b32 v104, 16, v104
v_and_b32 v107, 0xffff0000, v106
v_lshlrev_b32 v106, 16, v106
v_lshlrev_b32 v170, 16, v164
v_and_b32 v171, 0xffff0000, v164
v_lshlrev_b32 v172, 16, v165
v_and_b32 v173, 0xffff0000, v165
v_pk_add_f32 v[104:105], v[104:105], v[170:171]
v_pk_add_f32 v[106:107], v[106:107], v[172:173]
v_cvt_pk_bf16_f32 v104, v104, v105
v_cvt_pk_bf16_f32 v105, v106, v107
buffer_store_dwordx2 v[104:105], v9, s[16:19], s38 offen offset:64
v_cvt_pk_bf16_f32 v108, v108, v109
v_cvt_pk_bf16_f32 v110, v110, v111
v_and_b32 v109, 0xffff0000, v108
v_lshlrev_b32 v108, 16, v108
v_and_b32 v111, 0xffff0000, v110
v_lshlrev_b32 v110, 16, v110
v_lshlrev_b32 v174, 16, v166
v_and_b32 v175, 0xffff0000, v166
v_lshlrev_b32 v176, 16, v167
v_and_b32 v177, 0xffff0000, v167
v_pk_add_f32 v[108:109], v[108:109], v[174:175]
v_pk_add_f32 v[110:111], v[110:111], v[176:177]
v_cvt_pk_bf16_f32 v108, v108, v109
v_cvt_pk_bf16_f32 v109, v110, v111
buffer_store_dwordx2 v[108:109], v9, s[16:19], s38 offen offset:96
M_FIN:
M_END:
s_endpgm
M_CODE_END:

.section .rodata,"a"
.p2align 6
.amdhsa_kernel sequential_preLN__ssm_conv_s4__glu_gated_bilinear__prompt_kernel
  .amdhsa_next_free_vgpr 256
  .amdhsa_next_free_sgpr 102
  .amdhsa_accum_offset 256
  .amdhsa_group_segment_fixed_size 0
  .amdhsa_kernarg_size 128
  .amdhsa_user_sgpr_count 2
  .amdhsa_user_sgpr_kernarg_segment_ptr 1
  .amdhsa_system_sgpr_workgroup_id_x 1
.end_amdhsa_kernel
```
